```python
import torch

def _softmax(x, axis=-1):
    return torch.softmax(x, dim=axis)
def _gelu(x):
    return torch.nn.functional.gelu(x, approximate="tanh")
def _silu(x):
    return torch.nn.functional.silu(x)
def _sigmoid(x):
    return torch.sigmoid(x)
def _layernorm(x, axis=-1, eps=1e-5):
    m = x.mean(dim=axis, keepdim=True)
    v = x.var(dim=axis, keepdim=True, unbiased=False)
    return (x - m) / torch.sqrt(v + eps)
def _scatter_add(tgt, idx, src, axis=0):
    return tgt.clone().index_add_(axis, idx, src)
def _segment_sum(src, seg, n):
    out = torch.zeros((n,) + src.shape[1:], dtype=src.dtype)
    return out.index_add_(0, seg, src)
def _pad(x, pw):
    flat = tuple(v for pair in reversed(pw) for v in pair)
    return torch.nn.functional.pad(x, flat)

kernel_name = 'concat_heads__compressed_kv_cla__sliding_block__prompt'

def setup_inputs():

    _w = (lambda a: (lambda t: t.to(torch.bfloat16) if t.is_floating_point() else t)(torch.as_tensor(a)))
    def _A_setup():
        B, H, Sq, Sk, D, M = 1, 16, 2048, 2048, 256, 448
        Dc = 4 * D
        return {
            "x": _w((lambda *s: torch.randn(*s, dtype=torch.bfloat16) * 0.2)(B, Sq, M)),
            "c_kv": _w((lambda *s: torch.randn(*s, dtype=torch.bfloat16) * 1.6)(B, Sk, Dc)),
            "w_q": _w((lambda *s: torch.randn(*s, dtype=torch.bfloat16) * 3.2)(M, H, D) * (M ** -0.5)),
            "w_uk": _w((lambda *s: torch.randn(*s, dtype=torch.bfloat16) * 3.2)(Dc, H, D) * (Dc ** -0.5)),
            "w_uv": _w((lambda *s: torch.randn(*s, dtype=torch.bfloat16) * 1.6)(Dc, H, D) * (Dc ** -0.5)),
            "w_o": _w((lambda *s: torch.randn(*s, dtype=torch.bfloat16) * 1.6)(H, D, M) * ((H * D) ** -0.5)),
        }
    _A_in = _A_setup()

    def _B_setup():
        B, S, D = 1, 2048, 448
        return {
            "x": _w((lambda *s: torch.randn(*s, dtype=torch.bfloat16) * 0.4)(B, S, D)),
            "wqkv": _w((lambda *s: torch.randn(*s, dtype=torch.bfloat16) * 0.4)(D, 3 * D)),
            "wo": _w((lambda *s: torch.randn(*s, dtype=torch.bfloat16) * 0.05)(D, D)),
        }
    _B_in = _B_setup()

    return {
        "A_x": _A_in["x"],
        "A_c_kv": _A_in["c_kv"],
        "A_w_q": _A_in["w_q"],
        "A_w_uk": _A_in["w_uk"],
        "A_w_uv": _A_in["w_uv"],
        "A_w_o": _A_in["w_o"],
        "B_x": _B_in["x"],
        "B_wqkv": _B_in["wqkv"],
        "B_wo": _B_in["wo"],
    }

def reference(A_x, A_c_kv, A_w_q, A_w_uk, A_w_uv, A_w_o, B_x, B_wqkv, B_wo):
    def _A_ref(x, c_kv, w_q, w_uk, w_uv, w_o):
        B, Sq, M = x.shape[0], x.shape[1], x.shape[2]
        Sk = c_kv.shape[1]
        H, D = w_q.shape[1], w_q.shape[2]
        q = torch.einsum("bqm,mhd->bhqd", x, w_q)
        k = torch.einsum("bkc,chd->bhkd", c_kv, w_uk)
        v = torch.einsum("bkc,chd->bhkd", c_kv, w_uv)
        scores = torch.einsum("bhqd,bhkd->bhqk", q, k) * (D ** -0.5)
        off = Sk - Sq
        qi = torch.arange(Sq)[:, None]
        kj = torch.arange(Sk)[None, :]
        cmask = kj <= (qi + off)
        scores = torch.where(cmask[None, None], scores, -1e9)
        p = _softmax(scores, axis=-1)
        ctx = torch.einsum("bhqk,bhkd->bhqd", p, v)
        return torch.einsum("bhqd,hdm->bqm", ctx, w_o)

    def _B_ref(x, wqkv, wo):
        B, S, D = x.shape
        H = 16; Dh = D // H; W = 256
        qkv = (lambda x, *d: x.permute(*d))((x @ wqkv).reshape(B, S, 3, H, Dh), 2, 0, 3, 1, 4)
        q, k, v = qkv[0], qkv[1], qkv[2]
        scores = torch.einsum("bhqd,bhkd->bhqk", q, k) * (Dh ** -0.5)
        idx = torch.arange(S)
        mask = (idx[:, None] - idx[None, :] >= 0) & (idx[:, None] - idx[None, :] < W)
        scores = torch.where(mask[None, None], scores, -1e9)
        p = _softmax(scores, axis=-1)
        o = torch.einsum("bhqk,bhkd->bhqd", p, v)
        return (lambda x, *d: x.permute(*d))(o, 0, 2, 1, 3).reshape(B, S, D) @ wo

    a = _A_ref(A_x, A_c_kv, A_w_q, A_w_uk, A_w_uv, A_w_o)
    b = _B_ref(B_x, B_wqkv, B_wo)
    return torch.concatenate([a, b], axis=-1)
```

```asm
; @launch kernel=proj_kernel grid=(256,1,1) block=(512,1,1) lds=163840
; @launch kernel=attn_kernel grid=(256,1,1) block=(256,1,1) lds=163840
.amdgcn_target "amdgcn-amd-amdhsa--gfx950"
.text
.globl proj_kernel
.p2align 8
.type proj_kernel,@function
proj_kernel:
    s_cmp_ge_u32 s2, 256
    s_cbranch_scc1 proj_kernel_end
    s_load_dwordx4 s[80:83], s[0:1], 0
    s_load_dwordx4 s[84:87], s[0:1], 16
    s_load_dwordx2 s[88:89], s[0:1], 32
    s_load_dwordx4 s[92:95], s[0:1], 48
    s_load_dwordx4 s[4:7], s[0:1], 80
    s_getpc_b64 s[40:41]
proj_kernel_c0_pc:
    v_lshlrev_b32 v250, 6, v0
    v_min_u32 v250, proj_kernel_F0_0-proj_kernel_c0_pc-4, v250
    v_mov_b32 v249, s41
    v_add_co_u32 v248, vcc, s40, v250
    s_nop 1
    v_addc_co_u32 v249, vcc, 0, v249, vcc
    v_cmp_gt_u32 vcc, 128, v0
    s_and_saveexec_b64 s[42:43], vcc
    s_cbranch_execz proj_kernel_c0_skip
    global_load_dword v251, v[248:249], off
proj_kernel_c0_skip:
    s_mov_b64 exec, s[42:43]
    v_and_b32 v244, 63, v0
    v_lshrrev_b32 v240, 6, v0
    s_and_b32 s50, s2, 7
    v_readfirstlane_b32 s20, v240
    s_lshr_b32 s49, s2, 3
    s_cmp_lt_u32 s49, 8
    s_cbranch_scc1 proj_kernel_ra0
    s_cmp_lt_u32 s49, 16
    s_cbranch_scc1 proj_kernel_ra1
    s_cmp_lt_u32 s49, 22
    s_cbranch_scc1 proj_kernel_ra2
    s_and_b32 s65, s49, 7
    s_lshr_b32 s41, s49, 3
    s_and_b32 s42, s41, 1
    s_lshl_b32 s40, s50, 1
    s_add_u32 s42, s42, s40
    s_lshr_b32 s62, s41, 1
    s_lshl_b32 s64, s62, 4
    s_add_u32 s64, s64, s42
    s_add_u32 s64, s64, 16
    s_mov_b32 s55, 2048
    s_mov_b32 s59, 8192
    s_mov_b32 s60, 0
    s_mov_b32 s61, 32
    s_mov_b32 s63, 0
    s_mov_b32 s54, 4194304
    s_mov_b32 s58, 8388608
    s_lshl_b32 s45, s42, 9
    s_branch proj_kernel_rae
proj_kernel_ra0:
    s_and_b32 s65, s49, 7
    s_lshr_b32 s41, s49, 3
    s_and_b32 s42, s41, 1
    s_lshl_b32 s40, s50, 1
    s_add_u32 s42, s42, s40
    s_lshr_b32 s62, s41, 1
    s_lshl_b32 s64, s62, 4
    s_add_u32 s64, s64, s42
    s_add_u32 s64, s64, 16
    s_mov_b32 s55, 2048
    s_mov_b32 s59, 8192
    s_mov_b32 s60, 0
    s_mov_b32 s61, 32
    s_mov_b32 s63, 0
    s_mov_b32 s54, 4194304
    s_mov_b32 s58, 8388608
    s_lshl_b32 s45, s42, 9
    s_branch proj_kernel_rae
proj_kernel_ra1:
    s_and_b32 s65, s49, 7
    s_lshr_b32 s41, s49, 3
    s_lshl_b32 s42, s50, 1
    s_add_u32 s42, s42, s41
    s_mov_b32 s62, 0
    s_mov_b32 s64, s42
    s_mov_b32 s55, 896
    s_mov_b32 s59, 8192
    s_mov_b32 s60, 0
    s_mov_b32 s61, 14
    s_mov_b32 s63, 0x3db8aa3b
    s_mov_b32 s54, 1835008
    s_mov_b32 s58, 3670016
    s_lshl_b32 s45, s42, 9
    s_branch proj_kernel_rae
proj_kernel_ra2:
    s_mov_b32 s65, s50
    s_sub_u32 s41, s49, 16
    s_lshr_b32 s42, s41, 1
    s_cmp_eq_u32 s42, 2
    s_cselect_b32 s62, 1, 0
    s_cmp_eq_u32 s42, 0
    s_cselect_b32 s63, 0x3e8b97f6, 0
    s_add_u32 s64, s41, 48
    s_mov_b32 s55, 896
    s_mov_b32 s59, 2688
    s_mov_b32 s60, 1
    s_mov_b32 s61, 14
    s_mov_b32 s54, 1835008
    s_mov_b32 s58, 1204224
    s_mul_i32 s45, s41, 448
proj_kernel_rae:
    s_mov_b32 s11, 0x20000
    s_mov_b32 s15, 0x20000
    s_mov_b32 s18, 1048576
    s_mov_b32 s19, 0x20000
    s_lshl_b32 s32, s20, 11
    s_add_u32 s33, s32, 65536
    s_cmp_eq_u32 s61, 32
    s_cbranch_scc0 proj_kernel_tab_1_7
    s_lshr_b32 s36, s49, 3
    s_add_u32 s36, s36, s65
    s_and_b32 s36, s36, 3
    s_lshl_b32 s36, s36, 2
    s_lshr_b32 s36, 0x32103210, s36
    s_and_b32 s36, s36, 0xffff
    s_add_u32 s37, s36, 0x4444
    s_lshl_b32 s37, s37, 16
    s_add_u32 s96, s36, s37
    s_add_u32 s97, s96, 0x88888888
    s_branch proj_kernel_tab_1_e
proj_kernel_tab_1_7:
    s_lshr_b32 s36, s49, 3
    s_lshl_b32 s36, s36, 2
    s_add_u32 s36, s36, s65
    s_sub_u32 s37, s49, 16
    s_cmp_eq_u32 s60, 1
    s_cselect_b32 s36, s37, s36
    s_cmp_ge_u32 s36, 7
    s_cselect_b32 s37, 7, 0
    s_sub_u32 s36, s36, s37
    s_lshl_b32 s36, s36, 2
    s_mov_b32 s96, 0x06543210
    s_mov_b32 s97, 0x00654321
    s_lshr_b64 s[96:97], s[96:97], s36
proj_kernel_tab_1_e:
    s_mov_b64 s[98:99], s[96:97]
    s_lshr_b32 s36, s20, 1
    s_lshl_b32 s36, s36, 2
    s_and_b32 s37, s20, 1
    s_add_u32 s36, s36, s37
    s_lshl_b32 s36, s36, 3
    v_lshrrev_b32 v240, 3, v244
    v_add_u32 v240, s36, v240
    v_mul_lo_u32 v240, v240, s55
    v_lshrrev_b32 v241, 4, v244
    v_and_b32 v242, 7, v244
    v_xor_b32 v241, v241, v242
    s_lshl_b32 s37, s55, 4
    v_lshl_add_u32 v224, v241, 4, v240
    v_xor_b32 v225, 64, v224
    v_add_u32 v225, s37, v225
    s_waitcnt lgkmcnt(0)
    s_cmp_lt_u32 s49, 16
    s_cselect_b32 s86, s86, s88
    s_cselect_b32 s87, s87, s89
    s_cmp_lt_u32 s49, 8
    s_cbranch_scc1 proj_kernel_rb0
    s_cmp_lt_u32 s49, 16
    s_cbranch_scc1 proj_kernel_rb1
    s_cmp_lt_u32 s49, 22
    s_cbranch_scc1 proj_kernel_rb2
    s_mul_i32 s40, s65, s55
    s_lshl_b32 s40, s40, 8
    s_add_u32 s52, s82, s40
    s_addc_u32 s53, s83, 0
    s_sub_u32 s54, s54, s40
    s_add_u32 s56, s86, s45
    s_addc_u32 s57, s87, 0
    s_sub_u32 s58, s58, s45
    s_branch proj_kernel_rbe
proj_kernel_rb0:
    s_mul_i32 s40, s65, s55
    s_lshl_b32 s40, s40, 8
    s_add_u32 s52, s82, s40
    s_addc_u32 s53, s83, 0
    s_sub_u32 s54, s54, s40
    s_add_u32 s56, s86, s45
    s_addc_u32 s57, s87, 0
    s_sub_u32 s58, s58, s45
    s_mov_b64 s[66:67], s[80:81]
    s_mov_b64 s[70:71], s[84:85]
    s_branch proj_kernel_rbe
proj_kernel_rb1:
    s_mul_i32 s40, s65, s55
    s_lshl_b32 s40, s40, 8
    s_add_u32 s52, s80, s40
    s_addc_u32 s53, s81, 0
    s_sub_u32 s54, s54, s40
    s_add_u32 s56, s84, s45
    s_addc_u32 s57, s85, 0
    s_sub_u32 s58, s58, s45
    s_mov_b64 s[66:67], s[82:83]
    s_mov_b64 s[70:71], s[86:87]
    s_branch proj_kernel_rbe
proj_kernel_rb2:
    s_mul_i32 s40, s65, s55
    s_lshl_b32 s40, s40, 8
    s_add_u32 s52, s92, s40
    s_addc_u32 s53, s93, 0
    s_sub_u32 s54, s54, s40
    s_add_u32 s56, s94, s45
    s_addc_u32 s57, s95, 0
    s_sub_u32 s58, s58, s45
    s_mov_b64 s[66:67], s[82:83]
    s_mov_b64 s[70:71], s[86:87]
proj_kernel_rbe:
    s_cmp_lt_u32 s2, 75
    s_cselect_b32 s90, s80, s84
    s_cselect_b32 s91, s81, s85
    s_mov_b32 s8, s52
    s_mov_b32 s9, s53
    s_mov_b32 s10, s54
    s_lshl_b32 s34, s55, 7
    s_lshr_b32 s43, s61, 1
    s_add_u32 s28, s33, 0
    s_and_b32 s25, s96, 15
    s_lshr_b64 s[96:97], s[96:97], 4
    s_lshl_b32 s25, s25, 7
    s_add_u32 s40, s25, s34
    s_add_u32 m0, s28, 0
    s_nop 0
    buffer_load_dwordx4 v224, s[8:11], s25 offen  lds
    s_add_u32 m0, s28, 1024
    s_nop 0
    buffer_load_dwordx4 v225, s[8:11], s25 offen  lds
    s_add_u32 s28, s33, 0
    s_add_u32 s40, s25, s34
    s_add_u32 m0, s28, 16384
    s_nop 0
    buffer_load_dwordx4 v224, s[8:11], s40 offen  lds
    s_add_u32 m0, s28, 17408
    s_nop 0
    buffer_load_dwordx4 v225, s[8:11], s40 offen  lds
    s_mov_b32 s12, s56
    s_mov_b32 s13, s57
    s_mov_b32 s14, s58
    s_lshl_b32 s35, s59, 5
    s_mov_b32 s44, s61
    s_lshl_b32 s36, s20, 2
    s_add_u32 s36, s36, 0
    v_lshrrev_b32 v240, 5, v244
    v_add_u32 v240, s36, v240
    v_and_b32 v241, 3, v240
    v_bfe_u32 v242, v240, 3, 1
    v_lshl_or_b32 v241, v242, 2, v241
    v_lshlrev_b32 v241, 1, v241
    v_and_b32 v242, 31, v244
    v_xor_b32 v241, v241, v242
    v_mul_lo_u32 v240, v240, s59
    v_lshrrev_b32 v242, 2, v241
    v_lshlrev_b32 v242, 3, v242
    v_mul_lo_u32 v242, v242, s60
    v_lshl_add_u32 v241, v241, 4, v240
    v_sub_u32 v226, v241, v242
    s_lshl_b32 s36, s20, 2
    s_add_u32 s36, s36, 2
    v_lshrrev_b32 v240, 5, v244
    v_add_u32 v240, s36, v240
    v_and_b32 v241, 3, v240
    v_bfe_u32 v242, v240, 3, 1
    v_lshl_or_b32 v241, v242, 2, v241
    v_lshlrev_b32 v241, 1, v241
    v_and_b32 v242, 31, v244
    v_xor_b32 v241, v241, v242
    v_mul_lo_u32 v240, v240, s59
    v_lshrrev_b32 v242, 2, v241
    v_lshlrev_b32 v242, 3, v242
    v_mul_lo_u32 v242, v242, s60
    v_lshl_add_u32 v241, v241, 4, v240
    v_sub_u32 v227, v241, v242
    s_and_b32 s94, s98, 15
    s_lshr_b64 s[98:99], s[98:99], 4
    s_mul_i32 s94, s94, s35
    s_lshl_b32 s26, s94, 1
    s_add_u32 m0, s32, 0
    s_nop 0
    buffer_load_dwordx4 v226, s[12:15], s26 offen  lds
    s_add_u32 m0, s32, 1024
    s_nop 0
    buffer_load_dwordx4 v227, s[12:15], s26 offen  lds
    s_add_u32 s28, s33, 32768
    s_and_b32 s25, s96, 15
    s_lshr_b64 s[96:97], s[96:97], 4
    s_lshl_b32 s25, s25, 7
    s_add_u32 s40, s25, s34
    s_add_u32 m0, s28, 0
    s_nop 0
    buffer_load_dwordx4 v224, s[8:11], s25 offen  lds
    s_add_u32 m0, s28, 1024
    s_nop 0
    buffer_load_dwordx4 v225, s[8:11], s25 offen  lds
    s_add_u32 s26, s26, s35
    s_add_u32 m0, s32, 16384
    s_nop 0
    buffer_load_dwordx4 v226, s[12:15], s26 offen  lds
    s_add_u32 m0, s32, 17408
    s_nop 0
    buffer_load_dwordx4 v227, s[12:15], s26 offen  lds
    s_add_u32 s28, s33, 32768
    s_add_u32 s40, s25, s34
    s_add_u32 m0, s28, 16384
    s_nop 0
    buffer_load_dwordx4 v224, s[8:11], s40 offen  lds
    s_add_u32 m0, s28, 17408
    s_nop 0
    buffer_load_dwordx4 v225, s[8:11], s40 offen  lds
    s_and_b32 s94, s98, 15
    s_lshr_b64 s[98:99], s[98:99], 4
    s_mul_i32 s94, s94, s35
    s_lshl_b32 s26, s94, 1
    s_add_u32 m0, s32, 32768
    s_nop 0
    buffer_load_dwordx4 v226, s[12:15], s26 offen  lds
    s_add_u32 m0, s32, 33792
    s_nop 0
    buffer_load_dwordx4 v227, s[12:15], s26 offen  lds
    s_add_u32 s28, s33, 65536
    s_and_b32 s25, s96, 15
    s_lshr_b64 s[96:97], s[96:97], 4
    s_lshl_b32 s25, s25, 7
    s_add_u32 s40, s25, s34
    s_add_u32 m0, s28, 0
    s_nop 0
    buffer_load_dwordx4 v224, s[8:11], s25 offen  lds
    s_add_u32 m0, s28, 1024
    s_nop 0
    buffer_load_dwordx4 v225, s[8:11], s25 offen  lds
    s_add_u32 s26, s26, s35
    s_add_u32 m0, s32, 49152
    s_nop 0
    buffer_load_dwordx4 v226, s[12:15], s26 offen  lds
    s_add_u32 m0, s32, 50176
    s_nop 0
    buffer_load_dwordx4 v227, s[12:15], s26 offen  lds
    s_cmp_lt_u32 s49, 8
    s_cbranch_scc1 proj_kernel_rc0
    s_cmp_lt_u32 s49, 16
    s_cbranch_scc1 proj_kernel_rc1
    s_cmp_lt_u32 s49, 22
    s_cbranch_scc1 proj_kernel_rc2
    s_mov_b32 s66, 0
    s_mov_b32 s67, 0
    s_mov_b32 s68, 0
    s_mov_b32 s69, 0
    s_mov_b32 s70, 0
    s_mov_b32 s71, 0
    s_mov_b32 s72, 0
    s_mov_b32 s73, 0
    s_mov_b32 s74, 0
    s_mov_b32 s75, 0
    s_mov_b32 s76, 0
    s_mov_b32 s77, 0
    s_mov_b32 s78, 0
    s_mov_b32 s79, 0
    s_branch proj_kernel_rce
proj_kernel_rc0:
    s_and_b32 s79, s49, 7
    s_lshr_b32 s41, s49, 3
    s_lshl_b32 s42, s50, 1
    s_add_u32 s42, s42, s41
    s_mov_b32 s76, 0
    s_mov_b32 s78, s42
    s_mov_b32 s69, 896
    s_mov_b32 s73, 8192
    s_mov_b32 s74, 0
    s_mov_b32 s75, 14
    s_mov_b32 s77, 0x3db8aa3b
    s_mov_b32 s68, 1835008
    s_mov_b32 s72, 3670016
    s_lshl_b32 s47, s42, 9
    s_mul_i32 s40, s79, s69
    s_lshl_b32 s40, s40, 8
    s_add_u32 s66, s66, s40
    s_addc_u32 s67, s67, 0
    s_sub_u32 s68, s68, s40
    s_add_u32 s70, s70, s47
    s_addc_u32 s71, s71, 0
    s_sub_u32 s72, s72, s47
    s_branch proj_kernel_rce
proj_kernel_rc1:
    s_and_b32 s79, s49, 7
    s_lshr_b32 s41, s49, 3
    s_and_b32 s42, s41, 1
    s_lshl_b32 s40, s50, 1
    s_add_u32 s42, s42, s40
    s_lshr_b32 s76, s41, 1
    s_lshl_b32 s78, s76, 4
    s_add_u32 s78, s78, s42
    s_add_u32 s78, s78, 16
    s_mov_b32 s69, 2048
    s_mov_b32 s73, 8192
    s_mov_b32 s74, 0
    s_mov_b32 s75, 32
    s_mov_b32 s77, 0
    s_mov_b32 s68, 4194304
    s_mov_b32 s72, 8388608
    s_lshl_b32 s47, s42, 9
    s_mul_i32 s40, s79, s69
    s_lshl_b32 s40, s40, 8
    s_add_u32 s66, s66, s40
    s_addc_u32 s67, s67, 0
    s_sub_u32 s68, s68, s40
    s_add_u32 s70, s70, s47
    s_addc_u32 s71, s71, 0
    s_sub_u32 s72, s72, s47
    s_branch proj_kernel_rce
proj_kernel_rc2:
    s_and_b32 s79, s49, 7
    s_lshr_b32 s41, s49, 3
    s_and_b32 s42, s41, 1
    s_lshl_b32 s40, s50, 1
    s_add_u32 s42, s42, s40
    s_lshr_b32 s76, s41, 1
    s_lshl_b32 s78, s76, 4
    s_add_u32 s78, s78, s42
    s_add_u32 s78, s78, 16
    s_mov_b32 s69, 2048
    s_mov_b32 s73, 8192
    s_mov_b32 s74, 0
    s_mov_b32 s75, 32
    s_mov_b32 s77, 0
    s_mov_b32 s68, 4194304
    s_mov_b32 s72, 8388608
    s_lshl_b32 s47, s42, 9
    s_mul_i32 s40, s79, s69
    s_lshl_b32 s40, s40, 8
    s_add_u32 s66, s66, s40
    s_addc_u32 s67, s67, 0
    s_sub_u32 s68, s68, s40
    s_add_u32 s70, s70, s47
    s_addc_u32 s71, s71, 0
    s_sub_u32 s72, s72, s47
proj_kernel_rce:
    s_cmp_eq_u32 s20, 0
    s_cbranch_scc0 proj_kernel_nz
    s_lshl_b32 s36, s2, 8
    s_add_u32 s36, s36, 132120576
    s_add_u32 s38, s6, s36
    s_addc_u32 s39, s7, 0
    v_lshlrev_b32 v240, 2, v244
    v_mov_b32 v241, 0
    global_store_dword v240, v241, s[38:39]
proj_kernel_nz:
    s_cmp_eq_u32 s20, 5
    s_cbranch_scc0 proj_kernel_pft
    s_cmp_lt_u32 s2, 225
    s_cbranch_scc0 proj_kernel_pft
    s_mov_b64 s[88:89], s[90:91]
    s_mov_b32 s91, 0x20000
    s_mov_b32 s90, 3670016
    s_sub_u32 s92, s2, 75
    s_cmp_lt_u32 s2, 75
    s_cselect_b32 s90, 1835008, s90
    s_cselect_b32 s92, s2, s92
    s_mul_i32 s92, s92, 24576
    v_lshlrev_b32 v245, 7, v244
    buffer_load_dword v246, v245, s[88:91], s92 offen
    s_add_u32 s92, s92, 8192
    buffer_load_dword v246, v245, s[88:91], s92 offen
    s_add_u32 s92, s92, 8192
    buffer_load_dword v246, v245, s[88:91], s92 offen
    s_add_u32 s92, s92, 8192
proj_kernel_pft:
    s_cmp_eq_u32 s20, 6
    s_cbranch_scc0 proj_kernel_cpf1
    s_getpc_b64 s[36:37]
proj_kernel_c1_pc:
    s_add_u32 s36, s36, proj_kernel_F0_0-proj_kernel_c1_pc
    s_addc_u32 s37, s37, (proj_kernel_F0_0-proj_kernel_c1_pc)>>32
    s_lshl_b32 s38, s49, 12
    s_cmp_ge_u32 s38, proj_kernel_end-proj_kernel_F0_0
    s_cbranch_scc1 proj_kernel_c1_skip
    v_lshl_add_u32 v250, v244, 6, s38
    v_min_u32 v250, proj_kernel_end-proj_kernel_F0_0-4, v250
    v_mov_b32 v249, s37
    v_add_co_u32 v248, vcc, s36, v250
    s_nop 1
    v_addc_co_u32 v249, vcc, 0, v249, vcc
    global_load_dword v251, v[248:249], off
proj_kernel_c1_skip:
proj_kernel_cpf1:
    s_mov_b32 s41, 2
    s_mov_b32 s42, 4
    s_mov_b32 s27, 65536
    s_mov_b32 s45, 0
    s_mov_b32 s46, 0
    s_mov_b32 s47, 0
    s_mov_b32 s48, 0
    s_mov_b32 s95, 0
    s_mov_b32 s21, s61
    s_mov_b32 s22, s62
    s_mov_b32 s23, s63
    s_mov_b32 s24, s65
    s_lshl_b32 s36, s64, 20
    s_add_u32 s16, s6, s36
    s_addc_u32 s17, s7, 0
    s_mov_b32 s54, s60
    s_cmp_lg_u32 s75, 0
    s_cselect_b32 s55, 1, 0
    s_cmp_eq_u32 s54, 1
    s_cselect_b32 s55, 0, s55
    s_cmp_eq_u32 s75, 32
    s_cbranch_scc0 proj_kernel_tab_2_7
    s_lshr_b32 s36, s49, 3
    s_add_u32 s36, s36, s79
    s_and_b32 s36, s36, 3
    s_lshl_b32 s36, s36, 2
    s_lshr_b32 s36, 0x32103210, s36
    s_and_b32 s36, s36, 0xffff
    s_add_u32 s37, s36, 0x4444
    s_lshl_b32 s37, s37, 16
    s_add_u32 s52, s36, s37
    s_add_u32 s53, s52, 0x88888888
    s_branch proj_kernel_tab_2_e
proj_kernel_tab_2_7:
    s_lshr_b32 s36, s49, 3
    s_lshl_b32 s36, s36, 2
    s_add_u32 s36, s36, s79
    s_sub_u32 s37, s49, 16
    s_cmp_eq_u32 s74, 1
    s_cselect_b32 s36, s37, s36
    s_cmp_ge_u32 s36, 7
    s_cselect_b32 s37, 7, 0
    s_sub_u32 s36, s36, s37
    s_lshl_b32 s36, s36, 2
    s_mov_b32 s52, 0x06543210
    s_mov_b32 s53, 0x00654321
    s_lshr_b64 s[52:53], s[52:53], s36
proj_kernel_tab_2_e:
    s_lshr_b32 s36, s20, 1
    s_lshl_b32 s36, s36, 2
    s_and_b32 s37, s20, 1
    s_add_u32 s36, s36, s37
    s_lshl_b32 s36, s36, 3
    v_lshrrev_b32 v240, 3, v244
    v_add_u32 v240, s36, v240
    v_mul_lo_u32 v240, v240, s69
    v_lshrrev_b32 v241, 4, v244
    v_and_b32 v242, 7, v244
    v_xor_b32 v241, v241, v242
    s_lshl_b32 s37, s69, 4
    v_lshl_add_u32 v228, v241, 4, v240
    v_xor_b32 v229, 64, v228
    v_add_u32 v229, s37, v229
    s_lshl_b32 s36, s20, 2
    s_add_u32 s36, s36, 0
    v_lshrrev_b32 v240, 5, v244
    v_add_u32 v240, s36, v240
    v_and_b32 v241, 3, v240
    v_bfe_u32 v242, v240, 3, 1
    v_lshl_or_b32 v241, v242, 2, v241
    v_lshlrev_b32 v241, 1, v241
    v_and_b32 v242, 31, v244
    v_xor_b32 v241, v241, v242
    v_mul_lo_u32 v240, v240, s73
    v_lshrrev_b32 v242, 2, v241
    v_lshlrev_b32 v242, 3, v242
    v_mul_lo_u32 v242, v242, s74
    v_lshl_add_u32 v241, v241, 4, v240
    v_sub_u32 v230, v241, v242
    s_lshl_b32 s36, s20, 2
    s_add_u32 s36, s36, 2
    v_lshrrev_b32 v240, 5, v244
    v_add_u32 v240, s36, v240
    v_and_b32 v241, 3, v240
    v_bfe_u32 v242, v240, 3, 1
    v_lshl_or_b32 v241, v242, 2, v241
    v_lshlrev_b32 v241, 1, v241
    v_and_b32 v242, 31, v244
    v_xor_b32 v241, v241, v242
    v_mul_lo_u32 v240, v240, s73
    v_lshrrev_b32 v242, 2, v241
    v_lshlrev_b32 v242, 3, v242
    v_mul_lo_u32 v242, v242, s74
    v_lshl_add_u32 v241, v241, 4, v240
    v_sub_u32 v231, v241, v242
    s_and_b32 s36, s20, 1
    s_lshr_b32 s37, s20, 1
    v_and_b32 v240, 15, v244
    v_lshrrev_b32 v241, 1, v240
    v_lshrrev_b32 v242, 4, v244
    v_xor_b32 v241, v241, v242
    v_lshlrev_b32 v241, 4, v241
    v_lshl_add_u32 v240, v240, 7, v241
    s_lshl_b32 s38, s36, 14
    v_add_u32 v232, s38, v240
    v_xor_b32 v233, 64, v232
    v_bfe_u32 v240, v244, 2, 2
    v_lshrrev_b32 v241, 4, v244
    v_lshl_add_u32 v242, v241, 3, v240
    v_and_b32 v241, 1, v241
    v_lshl_or_b32 v240, v241, 2, v240
    v_and_b32 v241, 3, v244
    v_lshlrev_b32 v241, 3, v241
    v_lshl_add_u32 v242, v242, 9, v241
    s_lshl_b32 s38, s37, 2
    s_add_u32 s39, s38, 0
    v_xor_b32 v241, s39, v240
    v_lshl_add_u32 v235, v241, 5, v242
    s_add_u32 s39, s38, 1
    v_xor_b32 v241, s39, v240
    v_lshl_add_u32 v236, v241, 5, v242
    s_add_u32 s39, s38, 2
    v_xor_b32 v241, s39, v240
    v_lshl_add_u32 v237, v241, 5, v242
    s_add_u32 s39, s38, 3
    v_xor_b32 v241, s39, v240
    v_lshl_add_u32 v238, v241, 5, v242
    v_mov_b32 v0, 0
    v_mov_b32 v1, 0
    v_mov_b32 v2, 0
    v_mov_b32 v3, 0
    v_mov_b32 v4, 0
    v_mov_b32 v5, 0
    v_mov_b32 v6, 0
    v_mov_b32 v7, 0
    v_mov_b32 v8, 0
    v_mov_b32 v9, 0
    v_mov_b32 v10, 0
    v_mov_b32 v11, 0
    v_mov_b32 v12, 0
    v_mov_b32 v13, 0
    v_mov_b32 v14, 0
    v_mov_b32 v15, 0
    v_mov_b32 v16, 0
    v_mov_b32 v17, 0
    v_mov_b32 v18, 0
    v_mov_b32 v19, 0
    v_mov_b32 v20, 0
    v_mov_b32 v21, 0
    v_mov_b32 v22, 0
    v_mov_b32 v23, 0
    v_mov_b32 v24, 0
    v_mov_b32 v25, 0
    v_mov_b32 v26, 0
    v_mov_b32 v27, 0
    v_mov_b32 v28, 0
    v_mov_b32 v29, 0
    v_mov_b32 v30, 0
    v_mov_b32 v31, 0
    v_mov_b32 v32, 0
    v_mov_b32 v33, 0
    v_mov_b32 v34, 0
    v_mov_b32 v35, 0
    v_mov_b32 v36, 0
    v_mov_b32 v37, 0
    v_mov_b32 v38, 0
    v_mov_b32 v39, 0
    v_mov_b32 v40, 0
    v_mov_b32 v41, 0
    v_mov_b32 v42, 0
    v_mov_b32 v43, 0
    v_mov_b32 v44, 0
    v_mov_b32 v45, 0
    v_mov_b32 v46, 0
    v_mov_b32 v47, 0
    v_mov_b32 v48, 0
    v_mov_b32 v49, 0
    v_mov_b32 v50, 0
    v_mov_b32 v51, 0
    v_mov_b32 v52, 0
    v_mov_b32 v53, 0
    v_mov_b32 v54, 0
    v_mov_b32 v55, 0
    v_mov_b32 v56, 0
    v_mov_b32 v57, 0
    v_mov_b32 v58, 0
    v_mov_b32 v59, 0
    v_mov_b32 v60, 0
    v_mov_b32 v61, 0
    v_mov_b32 v62, 0
    v_mov_b32 v63, 0
    v_mov_b32 v64, 0
    v_mov_b32 v65, 0
    v_mov_b32 v66, 0
    v_mov_b32 v67, 0
    v_mov_b32 v68, 0
    v_mov_b32 v69, 0
    v_mov_b32 v70, 0
    v_mov_b32 v71, 0
    v_mov_b32 v72, 0
    v_mov_b32 v73, 0
    v_mov_b32 v74, 0
    v_mov_b32 v75, 0
    v_mov_b32 v76, 0
    v_mov_b32 v77, 0
    v_mov_b32 v78, 0
    v_mov_b32 v79, 0
    v_mov_b32 v80, 0
    v_mov_b32 v81, 0
    v_mov_b32 v82, 0
    v_mov_b32 v83, 0
    v_mov_b32 v84, 0
    v_mov_b32 v85, 0
    v_mov_b32 v86, 0
    v_mov_b32 v87, 0
    v_mov_b32 v88, 0
    v_mov_b32 v89, 0
    v_mov_b32 v90, 0
    v_mov_b32 v91, 0
    v_mov_b32 v92, 0
    v_mov_b32 v93, 0
    v_mov_b32 v94, 0
    v_mov_b32 v95, 0
    v_mov_b32 v96, 0
    v_mov_b32 v97, 0
    v_mov_b32 v98, 0
    v_mov_b32 v99, 0
    v_mov_b32 v100, 0
    v_mov_b32 v101, 0
    v_mov_b32 v102, 0
    v_mov_b32 v103, 0
    v_mov_b32 v104, 0
    v_mov_b32 v105, 0
    v_mov_b32 v106, 0
    v_mov_b32 v107, 0
    v_mov_b32 v108, 0
    v_mov_b32 v109, 0
    v_mov_b32 v110, 0
    v_mov_b32 v111, 0
    v_mov_b32 v112, 0
    v_mov_b32 v113, 0
    v_mov_b32 v114, 0
    v_mov_b32 v115, 0
    v_mov_b32 v116, 0
    v_mov_b32 v117, 0
    v_mov_b32 v118, 0
    v_mov_b32 v119, 0
    v_mov_b32 v120, 0
    v_mov_b32 v121, 0
    v_mov_b32 v122, 0
    v_mov_b32 v123, 0
    v_mov_b32 v124, 0
    v_mov_b32 v125, 0
    v_mov_b32 v126, 0
    v_mov_b32 v127, 0
    s_waitcnt vmcnt(12)
    s_barrier
    v_add_u32 v234, s27, v232
    ds_read_b64_tr_b16 v[192:193], v235 offset:0
    ds_read_b64_tr_b16 v[194:195], v235 offset:2048
    ds_read_b128 v[128:131], v234 offset:0
    ds_read_b128 v[132:135], v234 offset:2048
    ds_read_b128 v[136:139], v234 offset:4096
    ds_read_b128 v[140:143], v234 offset:6144
    ds_read_b128 v[144:147], v234 offset:8192
    ds_read_b128 v[148:151], v234 offset:10240
    ds_read_b128 v[152:155], v234 offset:12288
    ds_read_b128 v[156:159], v234 offset:14336
    ds_read_b64_tr_b16 v[196:197], v236 offset:0
    ds_read_b64_tr_b16 v[198:199], v236 offset:2048
    ds_read_b64_tr_b16 v[200:201], v237 offset:0
    ds_read_b64_tr_b16 v[202:203], v237 offset:2048
    ds_read_b64_tr_b16 v[204:205], v238 offset:0
    ds_read_b64_tr_b16 v[206:207], v238 offset:2048
    s_mov_b32 s29, 0
    s_mov_b32 s51, 0
    s_sub_u32 s3, s21, 6
    s_cmp_eq_u32 s22, 1
    s_cbranch_scc1 proj_kernel_F1_0
    s_branch proj_kernel_F0_0
proj_kernel_F0_0:
    s_waitcnt lgkmcnt(0)
    s_waitcnt vmcnt(8)
    s_barrier
    v_mfma_f32_16x16x32_bf16 v[0:3], v[192:195], v[128:131], v[0:3]
    s_add_u32 s40, s25, s34
    v_add_u32 v234, s27, v233
    v_mfma_f32_16x16x32_bf16 v[4:7], v[192:195], v[132:135], v[4:7]
    s_and_b32 s94, s98, 15
    v_mfma_f32_16x16x32_bf16 v[8:11], v[192:195], v[136:139], v[8:11]
    s_lshr_b64 s[98:99], s[98:99], 4
    v_mfma_f32_16x16x32_bf16 v[12:15], v[192:195], v[140:143], v[12:15]
    s_mul_i32 s94, s94, s35
    v_mfma_f32_16x16x32_bf16 v[16:19], v[192:195], v[144:147], v[16:19]
    s_lshl_b32 s26, s94, 1
    v_mfma_f32_16x16x32_bf16 v[20:23], v[192:195], v[148:151], v[20:23]
    s_add_u32 m0, s32, 0
    v_mfma_f32_16x16x32_bf16 v[24:27], v[192:195], v[152:155], v[24:27]
    ds_read_b64_tr_b16 v[208:209], v235 offset:16384
    v_mfma_f32_16x16x32_bf16 v[28:31], v[192:195], v[156:159], v[28:31]
    buffer_load_dwordx4 v226, s[12:15], s26 offen  lds
    v_mfma_f32_16x16x32_bf16 v[32:35], v[196:199], v[128:131], v[32:35]
    s_add_u32 m0, s32, 1024
    v_mfma_f32_16x16x32_bf16 v[36:39], v[196:199], v[132:135], v[36:39]
    ds_read_b64_tr_b16 v[210:211], v235 offset:18432
    buffer_load_dwordx4 v227, s[12:15], s26 offen  lds
    v_mfma_f32_16x16x32_bf16 v[40:43], v[196:199], v[136:139], v[40:43]
    s_add_u32 m0, s28, 16384
    v_mfma_f32_16x16x32_bf16 v[44:47], v[196:199], v[140:143], v[44:47]
    ds_read_b128 v[160:163], v234 offset:0
    v_mfma_f32_16x16x32_bf16 v[48:51], v[196:199], v[144:147], v[48:51]
    buffer_load_dwordx4 v224, s[8:11], s40 offen  lds
    v_mfma_f32_16x16x32_bf16 v[52:55], v[196:199], v[148:151], v[52:55]
    s_add_u32 m0, s28, 17408
    v_mfma_f32_16x16x32_bf16 v[56:59], v[196:199], v[152:155], v[56:59]
    ds_read_b128 v[164:167], v234 offset:2048
    v_mfma_f32_16x16x32_bf16 v[60:63], v[196:199], v[156:159], v[60:63]
    buffer_load_dwordx4 v225, s[8:11], s40 offen  lds
    v_mfma_f32_16x16x32_bf16 v[64:67], v[200:203], v[128:131], v[64:67]
    s_add_u32 s42, s42, 1
    v_mfma_f32_16x16x32_bf16 v[68:71], v[200:203], v[132:135], v[68:71]
    ds_read_b128 v[168:171], v234 offset:4096
    v_mfma_f32_16x16x32_bf16 v[72:75], v[200:203], v[136:139], v[72:75]
    ds_read_b128 v[172:175], v234 offset:6144
    ds_read_b128 v[176:179], v234 offset:8192
    v_mfma_f32_16x16x32_bf16 v[76:79], v[200:203], v[140:143], v[76:79]
    ds_read_b128 v[180:183], v234 offset:10240
    v_mfma_f32_16x16x32_bf16 v[80:83], v[200:203], v[144:147], v[80:83]
    ds_read_b128 v[184:187], v234 offset:12288
    v_mfma_f32_16x16x32_bf16 v[84:87], v[200:203], v[148:151], v[84:87]
    ds_read_b128 v[188:191], v234 offset:14336
    v_mfma_f32_16x16x32_bf16 v[88:91], v[200:203], v[152:155], v[88:91]
    ds_read_b64_tr_b16 v[212:213], v236 offset:16384
    v_mfma_f32_16x16x32_bf16 v[92:95], v[200:203], v[156:159], v[92:95]
    ds_read_b64_tr_b16 v[214:215], v236 offset:18432
    v_mfma_f32_16x16x32_bf16 v[96:99], v[204:207], v[128:131], v[96:99]
    ds_read_b64_tr_b16 v[216:217], v237 offset:16384
    v_mfma_f32_16x16x32_bf16 v[100:103], v[204:207], v[132:135], v[100:103]
    ds_read_b64_tr_b16 v[218:219], v237 offset:18432
    v_mfma_f32_16x16x32_bf16 v[104:107], v[204:207], v[136:139], v[104:107]
    ds_read_b64_tr_b16 v[220:221], v238 offset:16384
    v_mfma_f32_16x16x32_bf16 v[108:111], v[204:207], v[140:143], v[108:111]
    ds_read_b64_tr_b16 v[222:223], v238 offset:18432
    v_mfma_f32_16x16x32_bf16 v[112:115], v[204:207], v[144:147], v[112:115]
    v_mfma_f32_16x16x32_bf16 v[116:119], v[204:207], v[148:151], v[116:119]
    v_mfma_f32_16x16x32_bf16 v[120:123], v[204:207], v[152:155], v[120:123]
    v_mfma_f32_16x16x32_bf16 v[124:127], v[204:207], v[156:159], v[124:127]
proj_kernel_F0_1:
    s_waitcnt lgkmcnt(0)
    s_waitcnt vmcnt(8)
    s_barrier
    v_mfma_f32_16x16x32_bf16 v[0:3], v[208:211], v[160:163], v[0:3]
    s_sub_u32 s28, s27, 65536
    s_add_u32 s28, s28, s33
    v_mfma_f32_16x16x32_bf16 v[4:7], v[208:211], v[164:167], v[4:7]
    s_add_u32 s27, s27, 32768
    v_mfma_f32_16x16x32_bf16 v[8:11], v[208:211], v[168:171], v[8:11]
    s_cmp_eq_u32 s27, 163840
    s_cselect_b32 s27, 65536, s27
    v_mfma_f32_16x16x32_bf16 v[12:15], v[208:211], v[172:175], v[12:15]
    s_add_u32 s41, s41, 1
    v_mfma_f32_16x16x32_bf16 v[16:19], v[208:211], v[176:179], v[16:19]
    s_and_b32 s25, s96, 15
    s_lshr_b64 s[96:97], s[96:97], 4
    v_mfma_f32_16x16x32_bf16 v[20:23], v[208:211], v[180:183], v[20:23]
    s_lshl_b32 s25, s25, 7
    v_mfma_f32_16x16x32_bf16 v[24:27], v[208:211], v[184:187], v[24:27]
    v_add_u32 v234, s27, v232
    v_mfma_f32_16x16x32_bf16 v[28:31], v[208:211], v[188:191], v[28:31]
    s_add_u32 s26, s26, s35
    v_mfma_f32_16x16x32_bf16 v[32:35], v[212:215], v[160:163], v[32:35]
    s_add_u32 m0, s32, 16384
    ds_read_b64_tr_b16 v[192:193], v235 offset:32768
    v_mfma_f32_16x16x32_bf16 v[36:39], v[212:215], v[164:167], v[36:39]
    buffer_load_dwordx4 v226, s[12:15], s26 offen  lds
    v_mfma_f32_16x16x32_bf16 v[40:43], v[212:215], v[168:171], v[40:43]
    s_add_u32 m0, s32, 17408
    v_mfma_f32_16x16x32_bf16 v[44:47], v[212:215], v[172:175], v[44:47]
    ds_read_b64_tr_b16 v[194:195], v235 offset:34816
    v_mfma_f32_16x16x32_bf16 v[48:51], v[212:215], v[176:179], v[48:51]
    buffer_load_dwordx4 v227, s[12:15], s26 offen  lds
    s_add_u32 m0, s28, 0
    v_mfma_f32_16x16x32_bf16 v[52:55], v[212:215], v[180:183], v[52:55]
    ds_read_b128 v[128:131], v234 offset:0
    v_mfma_f32_16x16x32_bf16 v[56:59], v[212:215], v[184:187], v[56:59]
    buffer_load_dwordx4 v224, s[8:11], s25 offen  lds
    v_mfma_f32_16x16x32_bf16 v[60:63], v[212:215], v[188:191], v[60:63]
    s_add_u32 m0, s28, 1024
    v_mfma_f32_16x16x32_bf16 v[64:67], v[216:219], v[160:163], v[64:67]
    ds_read_b128 v[132:135], v234 offset:2048
    buffer_load_dwordx4 v225, s[8:11], s25 offen  lds
    v_mfma_f32_16x16x32_bf16 v[68:71], v[216:219], v[164:167], v[68:71]
    s_add_u32 s42, s42, 1
    v_mfma_f32_16x16x32_bf16 v[72:75], v[216:219], v[168:171], v[72:75]
    ds_read_b128 v[136:139], v234 offset:4096
    v_mfma_f32_16x16x32_bf16 v[76:79], v[216:219], v[172:175], v[76:79]
    ds_read_b128 v[140:143], v234 offset:6144
    v_mfma_f32_16x16x32_bf16 v[80:83], v[216:219], v[176:179], v[80:83]
    ds_read_b128 v[144:147], v234 offset:8192
    ds_read_b128 v[148:151], v234 offset:10240
    v_mfma_f32_16x16x32_bf16 v[84:87], v[216:219], v[180:183], v[84:87]
    ds_read_b128 v[152:155], v234 offset:12288
    v_mfma_f32_16x16x32_bf16 v[88:91], v[216:219], v[184:187], v[88:91]
    ds_read_b128 v[156:159], v234 offset:14336
    v_mfma_f32_16x16x32_bf16 v[92:95], v[216:219], v[188:191], v[92:95]
    ds_read_b64_tr_b16 v[196:197], v236 offset:32768
    v_mfma_f32_16x16x32_bf16 v[96:99], v[220:223], v[160:163], v[96:99]
    ds_read_b64_tr_b16 v[198:199], v236 offset:34816
    ds_read_b64_tr_b16 v[200:201], v237 offset:32768
    v_mfma_f32_16x16x32_bf16 v[100:103], v[220:223], v[164:167], v[100:103]
    ds_read_b64_tr_b16 v[202:203], v237 offset:34816
    v_mfma_f32_16x16x32_bf16 v[104:107], v[220:223], v[168:171], v[104:107]
    ds_read_b64_tr_b16 v[204:205], v238 offset:32768
    v_mfma_f32_16x16x32_bf16 v[108:111], v[220:223], v[172:175], v[108:111]
    ds_read_b64_tr_b16 v[206:207], v238 offset:34816
    v_mfma_f32_16x16x32_bf16 v[112:115], v[220:223], v[176:179], v[112:115]
    v_mfma_f32_16x16x32_bf16 v[116:119], v[220:223], v[180:183], v[116:119]
    v_mfma_f32_16x16x32_bf16 v[120:123], v[220:223], v[184:187], v[120:123]
    v_mfma_f32_16x16x32_bf16 v[124:127], v[220:223], v[188:191], v[124:127]
    s_add_u32 s29, s29, 2
    s_cmp_lt_u32 s29, s3
    s_cbranch_scc0 proj_kernel_D0_2
proj_kernel_F0_2:
    s_waitcnt lgkmcnt(0)
    s_waitcnt vmcnt(8)
    s_barrier
    v_mfma_f32_16x16x32_bf16 v[0:3], v[192:195], v[128:131], v[0:3]
    s_add_u32 s40, s25, s34
    v_add_u32 v234, s27, v233
    v_mfma_f32_16x16x32_bf16 v[4:7], v[192:195], v[132:135], v[4:7]
    s_and_b32 s94, s98, 15
    v_mfma_f32_16x16x32_bf16 v[8:11], v[192:195], v[136:139], v[8:11]
    s_lshr_b64 s[98:99], s[98:99], 4
    v_mfma_f32_16x16x32_bf16 v[12:15], v[192:195], v[140:143], v[12:15]
    s_mul_i32 s94, s94, s35
    v_mfma_f32_16x16x32_bf16 v[16:19], v[192:195], v[144:147], v[16:19]
    s_lshl_b32 s26, s94, 1
    v_mfma_f32_16x16x32_bf16 v[20:23], v[192:195], v[148:151], v[20:23]
    s_add_u32 m0, s32, 32768
    v_mfma_f32_16x16x32_bf16 v[24:27], v[192:195], v[152:155], v[24:27]
    ds_read_b64_tr_b16 v[208:209], v235 offset:49152
    v_mfma_f32_16x16x32_bf16 v[28:31], v[192:195], v[156:159], v[28:31]
    buffer_load_dwordx4 v226, s[12:15], s26 offen  lds
    v_mfma_f32_16x16x32_bf16 v[32:35], v[196:199], v[128:131], v[32:35]
    s_add_u32 m0, s32, 33792
    v_mfma_f32_16x16x32_bf16 v[36:39], v[196:199], v[132:135], v[36:39]
    ds_read_b64_tr_b16 v[210:211], v235 offset:51200
    buffer_load_dwordx4 v227, s[12:15], s26 offen  lds
    v_mfma_f32_16x16x32_bf16 v[40:43], v[196:199], v[136:139], v[40:43]
    s_add_u32 m0, s28, 16384
    v_mfma_f32_16x16x32_bf16 v[44:47], v[196:199], v[140:143], v[44:47]
    ds_read_b128 v[160:163], v234 offset:0
    v_mfma_f32_16x16x32_bf16 v[48:51], v[196:199], v[144:147], v[48:51]
    buffer_load_dwordx4 v224, s[8:11], s40 offen  lds
    v_mfma_f32_16x16x32_bf16 v[52:55], v[196:199], v[148:151], v[52:55]
    s_add_u32 m0, s28, 17408
    v_mfma_f32_16x16x32_bf16 v[56:59], v[196:199], v[152:155], v[56:59]
    ds_read_b128 v[164:167], v234 offset:2048
    v_mfma_f32_16x16x32_bf16 v[60:63], v[196:199], v[156:159], v[60:63]
    buffer_load_dwordx4 v225, s[8:11], s40 offen  lds
    v_mfma_f32_16x16x32_bf16 v[64:67], v[200:203], v[128:131], v[64:67]
    s_add_u32 s42, s42, 1
    v_mfma_f32_16x16x32_bf16 v[68:71], v[200:203], v[132:135], v[68:71]
    ds_read_b128 v[168:171], v234 offset:4096
    v_mfma_f32_16x16x32_bf16 v[72:75], v[200:203], v[136:139], v[72:75]
    ds_read_b128 v[172:175], v234 offset:6144
    ds_read_b128 v[176:179], v234 offset:8192
    v_mfma_f32_16x16x32_bf16 v[76:79], v[200:203], v[140:143], v[76:79]
    ds_read_b128 v[180:183], v234 offset:10240
    v_mfma_f32_16x16x32_bf16 v[80:83], v[200:203], v[144:147], v[80:83]
    ds_read_b128 v[184:187], v234 offset:12288
    v_mfma_f32_16x16x32_bf16 v[84:87], v[200:203], v[148:151], v[84:87]
    ds_read_b128 v[188:191], v234 offset:14336
    v_mfma_f32_16x16x32_bf16 v[88:91], v[200:203], v[152:155], v[88:91]
    ds_read_b64_tr_b16 v[212:213], v236 offset:49152
    v_mfma_f32_16x16x32_bf16 v[92:95], v[200:203], v[156:159], v[92:95]
    ds_read_b64_tr_b16 v[214:215], v236 offset:51200
    v_mfma_f32_16x16x32_bf16 v[96:99], v[204:207], v[128:131], v[96:99]
    ds_read_b64_tr_b16 v[216:217], v237 offset:49152
    v_mfma_f32_16x16x32_bf16 v[100:103], v[204:207], v[132:135], v[100:103]
    ds_read_b64_tr_b16 v[218:219], v237 offset:51200
    v_mfma_f32_16x16x32_bf16 v[104:107], v[204:207], v[136:139], v[104:107]
    ds_read_b64_tr_b16 v[220:221], v238 offset:49152
    v_mfma_f32_16x16x32_bf16 v[108:111], v[204:207], v[140:143], v[108:111]
    ds_read_b64_tr_b16 v[222:223], v238 offset:51200
    v_mfma_f32_16x16x32_bf16 v[112:115], v[204:207], v[144:147], v[112:115]
    v_mfma_f32_16x16x32_bf16 v[116:119], v[204:207], v[148:151], v[116:119]
    v_mfma_f32_16x16x32_bf16 v[120:123], v[204:207], v[152:155], v[120:123]
    v_mfma_f32_16x16x32_bf16 v[124:127], v[204:207], v[156:159], v[124:127]
proj_kernel_F0_3:
    s_waitcnt lgkmcnt(0)
    s_waitcnt vmcnt(8)
    s_barrier
    v_mfma_f32_16x16x32_bf16 v[0:3], v[208:211], v[160:163], v[0:3]
    s_sub_u32 s28, s27, 65536
    s_add_u32 s28, s28, s33
    v_mfma_f32_16x16x32_bf16 v[4:7], v[208:211], v[164:167], v[4:7]
    s_add_u32 s27, s27, 32768
    v_mfma_f32_16x16x32_bf16 v[8:11], v[208:211], v[168:171], v[8:11]
    s_cmp_eq_u32 s27, 163840
    s_cselect_b32 s27, 65536, s27
    v_mfma_f32_16x16x32_bf16 v[12:15], v[208:211], v[172:175], v[12:15]
    s_add_u32 s41, s41, 1
    v_mfma_f32_16x16x32_bf16 v[16:19], v[208:211], v[176:179], v[16:19]
    s_and_b32 s25, s96, 15
    s_lshr_b64 s[96:97], s[96:97], 4
    v_mfma_f32_16x16x32_bf16 v[20:23], v[208:211], v[180:183], v[20:23]
    s_lshl_b32 s25, s25, 7
    v_mfma_f32_16x16x32_bf16 v[24:27], v[208:211], v[184:187], v[24:27]
    v_add_u32 v234, s27, v232
    v_mfma_f32_16x16x32_bf16 v[28:31], v[208:211], v[188:191], v[28:31]
    s_add_u32 s26, s26, s35
    v_mfma_f32_16x16x32_bf16 v[32:35], v[212:215], v[160:163], v[32:35]
    s_add_u32 m0, s32, 49152
    ds_read_b64_tr_b16 v[192:193], v235 offset:0
    v_mfma_f32_16x16x32_bf16 v[36:39], v[212:215], v[164:167], v[36:39]
    buffer_load_dwordx4 v226, s[12:15], s26 offen  lds
    v_mfma_f32_16x16x32_bf16 v[40:43], v[212:215], v[168:171], v[40:43]
    s_add_u32 m0, s32, 50176
    v_mfma_f32_16x16x32_bf16 v[44:47], v[212:215], v[172:175], v[44:47]
    ds_read_b64_tr_b16 v[194:195], v235 offset:2048
    v_mfma_f32_16x16x32_bf16 v[48:51], v[212:215], v[176:179], v[48:51]
    buffer_load_dwordx4 v227, s[12:15], s26 offen  lds
    s_add_u32 m0, s28, 0
    v_mfma_f32_16x16x32_bf16 v[52:55], v[212:215], v[180:183], v[52:55]
    ds_read_b128 v[128:131], v234 offset:0
    v_mfma_f32_16x16x32_bf16 v[56:59], v[212:215], v[184:187], v[56:59]
    buffer_load_dwordx4 v224, s[8:11], s25 offen  lds
    v_mfma_f32_16x16x32_bf16 v[60:63], v[212:215], v[188:191], v[60:63]
    s_add_u32 m0, s28, 1024
    v_mfma_f32_16x16x32_bf16 v[64:67], v[216:219], v[160:163], v[64:67]
    ds_read_b128 v[132:135], v234 offset:2048
    buffer_load_dwordx4 v225, s[8:11], s25 offen  lds
    v_mfma_f32_16x16x32_bf16 v[68:71], v[216:219], v[164:167], v[68:71]
    s_add_u32 s42, s42, 1
    v_mfma_f32_16x16x32_bf16 v[72:75], v[216:219], v[168:171], v[72:75]
    ds_read_b128 v[136:139], v234 offset:4096
    v_mfma_f32_16x16x32_bf16 v[76:79], v[216:219], v[172:175], v[76:79]
    ds_read_b128 v[140:143], v234 offset:6144
    v_mfma_f32_16x16x32_bf16 v[80:83], v[216:219], v[176:179], v[80:83]
    ds_read_b128 v[144:147], v234 offset:8192
    ds_read_b128 v[148:151], v234 offset:10240
    v_mfma_f32_16x16x32_bf16 v[84:87], v[216:219], v[180:183], v[84:87]
    ds_read_b128 v[152:155], v234 offset:12288
    v_mfma_f32_16x16x32_bf16 v[88:91], v[216:219], v[184:187], v[88:91]
    ds_read_b128 v[156:159], v234 offset:14336
    v_mfma_f32_16x16x32_bf16 v[92:95], v[216:219], v[188:191], v[92:95]
    ds_read_b64_tr_b16 v[196:197], v236 offset:0
    v_mfma_f32_16x16x32_bf16 v[96:99], v[220:223], v[160:163], v[96:99]
    ds_read_b64_tr_b16 v[198:199], v236 offset:2048
    ds_read_b64_tr_b16 v[200:201], v237 offset:0
    v_mfma_f32_16x16x32_bf16 v[100:103], v[220:223], v[164:167], v[100:103]
    ds_read_b64_tr_b16 v[202:203], v237 offset:2048
    v_mfma_f32_16x16x32_bf16 v[104:107], v[220:223], v[168:171], v[104:107]
    ds_read_b64_tr_b16 v[204:205], v238 offset:0
    v_mfma_f32_16x16x32_bf16 v[108:111], v[220:223], v[172:175], v[108:111]
    ds_read_b64_tr_b16 v[206:207], v238 offset:2048
    v_mfma_f32_16x16x32_bf16 v[112:115], v[220:223], v[176:179], v[112:115]
    v_mfma_f32_16x16x32_bf16 v[116:119], v[220:223], v[180:183], v[116:119]
    v_mfma_f32_16x16x32_bf16 v[120:123], v[220:223], v[184:187], v[120:123]
    v_mfma_f32_16x16x32_bf16 v[124:127], v[220:223], v[188:191], v[124:127]
    s_add_u32 s29, s29, 2
    s_cmp_lt_u32 s29, s3
    s_cbranch_scc1 proj_kernel_F0_0
    s_branch proj_kernel_D0_0
proj_kernel_S0_0:
    s_waitcnt lgkmcnt(0)
    s_cmp_lg_u32 s45, 0
    s_cbranch_scc1 proj_kernel_S0_0_rlx
    s_waitcnt vmcnt(8)
    s_barrier
proj_kernel_S0_0_join:
    v_mfma_f32_16x16x32_bf16 v[0:3], v[192:195], v[128:131], v[0:3]
    s_add_u32 s40, s25, s34
    v_add_u32 v234, s27, v233
    v_mfma_f32_16x16x32_bf16 v[4:7], v[192:195], v[132:135], v[4:7]
    s_cmp_eq_u32 s42, s44
    s_cbranch_scc1 proj_kernel_S0_0_wsw
proj_kernel_S0_0_wswr:
    v_mfma_f32_16x16x32_bf16 v[8:11], v[192:195], v[136:139], v[8:11]
    s_and_b32 s94, s98, 15
    v_mfma_f32_16x16x32_bf16 v[12:15], v[192:195], v[140:143], v[12:15]
    s_lshr_b64 s[98:99], s[98:99], 4
    v_mfma_f32_16x16x32_bf16 v[16:19], v[192:195], v[144:147], v[16:19]
    s_mul_i32 s94, s94, s35
    v_mfma_f32_16x16x32_bf16 v[20:23], v[192:195], v[148:151], v[20:23]
    s_lshl_b32 s26, s94, 1
    v_mfma_f32_16x16x32_bf16 v[24:27], v[192:195], v[152:155], v[24:27]
    s_add_u32 m0, s32, 0
    v_mfma_f32_16x16x32_bf16 v[28:31], v[192:195], v[156:159], v[28:31]
    ds_read_b64_tr_b16 v[208:209], v235 offset:16384
    buffer_load_dwordx4 v226, s[12:15], s26 offen  lds
    v_mfma_f32_16x16x32_bf16 v[32:35], v[196:199], v[128:131], v[32:35]
    s_add_u32 m0, s32, 1024
    v_mfma_f32_16x16x32_bf16 v[36:39], v[196:199], v[132:135], v[36:39]
    ds_read_b64_tr_b16 v[210:211], v235 offset:18432
    v_mfma_f32_16x16x32_bf16 v[40:43], v[196:199], v[136:139], v[40:43]
    buffer_load_dwordx4 v227, s[12:15], s26 offen  lds
    v_mfma_f32_16x16x32_bf16 v[44:47], v[196:199], v[140:143], v[44:47]
    s_add_u32 m0, s28, 16384
    v_mfma_f32_16x16x32_bf16 v[48:51], v[196:199], v[144:147], v[48:51]
    ds_read_b128 v[160:163], v234 offset:0
    v_mfma_f32_16x16x32_bf16 v[52:55], v[196:199], v[148:151], v[52:55]
    buffer_load_dwordx4 v224, s[8:11], s40 offen  lds
    v_mfma_f32_16x16x32_bf16 v[56:59], v[196:199], v[152:155], v[56:59]
    s_add_u32 m0, s28, 17408
    ds_read_b128 v[164:167], v234 offset:2048
    v_mfma_f32_16x16x32_bf16 v[60:63], v[196:199], v[156:159], v[60:63]
    buffer_load_dwordx4 v225, s[8:11], s40 offen  lds
    v_mfma_f32_16x16x32_bf16 v[64:67], v[200:203], v[128:131], v[64:67]
    s_add_u32 s42, s42, 1
    v_mfma_f32_16x16x32_bf16 v[68:71], v[200:203], v[132:135], v[68:71]
    ds_read_b128 v[168:171], v234 offset:4096
    v_mfma_f32_16x16x32_bf16 v[72:75], v[200:203], v[136:139], v[72:75]
    ds_read_b128 v[172:175], v234 offset:6144
    v_mfma_f32_16x16x32_bf16 v[76:79], v[200:203], v[140:143], v[76:79]
    ds_read_b128 v[176:179], v234 offset:8192
    v_mfma_f32_16x16x32_bf16 v[80:83], v[200:203], v[144:147], v[80:83]
    ds_read_b128 v[180:183], v234 offset:10240
    v_mfma_f32_16x16x32_bf16 v[84:87], v[200:203], v[148:151], v[84:87]
    ds_read_b128 v[184:187], v234 offset:12288
    ds_read_b128 v[188:191], v234 offset:14336
    v_mfma_f32_16x16x32_bf16 v[88:91], v[200:203], v[152:155], v[88:91]
    ds_read_b64_tr_b16 v[212:213], v236 offset:16384
    v_mfma_f32_16x16x32_bf16 v[92:95], v[200:203], v[156:159], v[92:95]
    ds_read_b64_tr_b16 v[214:215], v236 offset:18432
    v_mfma_f32_16x16x32_bf16 v[96:99], v[204:207], v[128:131], v[96:99]
    ds_read_b64_tr_b16 v[216:217], v237 offset:16384
    v_mfma_f32_16x16x32_bf16 v[100:103], v[204:207], v[132:135], v[100:103]
    ds_read_b64_tr_b16 v[218:219], v237 offset:18432
    v_mfma_f32_16x16x32_bf16 v[104:107], v[204:207], v[136:139], v[104:107]
    ds_read_b64_tr_b16 v[220:221], v238 offset:16384
    v_mfma_f32_16x16x32_bf16 v[108:111], v[204:207], v[140:143], v[108:111]
    ds_read_b64_tr_b16 v[222:223], v238 offset:18432
    v_mfma_f32_16x16x32_bf16 v[112:115], v[204:207], v[144:147], v[112:115]
    v_mfma_f32_16x16x32_bf16 v[116:119], v[204:207], v[148:151], v[116:119]
    v_mfma_f32_16x16x32_bf16 v[120:123], v[204:207], v[152:155], v[120:123]
    v_mfma_f32_16x16x32_bf16 v[124:127], v[204:207], v[156:159], v[124:127]
proj_kernel_S0_1:
    s_waitcnt lgkmcnt(0)
    s_cmp_lg_u32 s45, 0
    s_cbranch_scc1 proj_kernel_S0_1_rlx
    s_waitcnt vmcnt(8)
    s_barrier
proj_kernel_S0_1_join:
    v_mfma_f32_16x16x32_bf16 v[0:3], v[208:211], v[160:163], v[0:3]
    s_sub_u32 s28, s27, 65536
    s_add_u32 s28, s28, s33
    v_mfma_f32_16x16x32_bf16 v[4:7], v[208:211], v[164:167], v[4:7]
    s_add_u32 s27, s27, 32768
    v_mfma_f32_16x16x32_bf16 v[8:11], v[208:211], v[168:171], v[8:11]
    s_cmp_eq_u32 s27, 163840
    s_cselect_b32 s27, 65536, s27
    v_mfma_f32_16x16x32_bf16 v[12:15], v[208:211], v[172:175], v[12:15]
    s_add_u32 s41, s41, 1
    s_cmp_eq_u32 s41, s43
    s_cbranch_scc1 proj_kernel_S0_1_tsw
proj_kernel_S0_1_tswr:
    v_mfma_f32_16x16x32_bf16 v[16:19], v[208:211], v[176:179], v[16:19]
    s_and_b32 s25, s96, 15
    v_mfma_f32_16x16x32_bf16 v[20:23], v[208:211], v[180:183], v[20:23]
    s_lshr_b64 s[96:97], s[96:97], 4
    v_mfma_f32_16x16x32_bf16 v[24:27], v[208:211], v[184:187], v[24:27]
    s_lshl_b32 s25, s25, 7
    v_add_u32 v234, s27, v232
    v_mfma_f32_16x16x32_bf16 v[28:31], v[208:211], v[188:191], v[28:31]
    s_cmp_eq_u32 s42, s44
    s_cbranch_scc1 proj_kernel_S0_1_wsw
proj_kernel_S0_1_wswr:
    v_mfma_f32_16x16x32_bf16 v[32:35], v[212:215], v[160:163], v[32:35]
    s_add_u32 s26, s26, s35
    v_mfma_f32_16x16x32_bf16 v[36:39], v[212:215], v[164:167], v[36:39]
    s_add_u32 m0, s32, 16384
    ds_read_b64_tr_b16 v[192:193], v235 offset:32768
    v_mfma_f32_16x16x32_bf16 v[40:43], v[212:215], v[168:171], v[40:43]
    buffer_load_dwordx4 v226, s[12:15], s26 offen  lds
    v_mfma_f32_16x16x32_bf16 v[44:47], v[212:215], v[172:175], v[44:47]
    s_add_u32 m0, s32, 17408
    v_mfma_f32_16x16x32_bf16 v[48:51], v[212:215], v[176:179], v[48:51]
    ds_read_b64_tr_b16 v[194:195], v235 offset:34816
    buffer_load_dwordx4 v227, s[12:15], s26 offen  lds
    v_mfma_f32_16x16x32_bf16 v[52:55], v[212:215], v[180:183], v[52:55]
    s_add_u32 m0, s28, 0
    v_mfma_f32_16x16x32_bf16 v[56:59], v[212:215], v[184:187], v[56:59]
    ds_read_b128 v[128:131], v234 offset:0
    v_mfma_f32_16x16x32_bf16 v[60:63], v[212:215], v[188:191], v[60:63]
    buffer_load_dwordx4 v224, s[8:11], s25 offen  lds
    s_add_u32 m0, s28, 1024
    v_mfma_f32_16x16x32_bf16 v[64:67], v[216:219], v[160:163], v[64:67]
    ds_read_b128 v[132:135], v234 offset:2048
    v_mfma_f32_16x16x32_bf16 v[68:71], v[216:219], v[164:167], v[68:71]
    buffer_load_dwordx4 v225, s[8:11], s25 offen  lds
    v_mfma_f32_16x16x32_bf16 v[72:75], v[216:219], v[168:171], v[72:75]
    s_add_u32 s42, s42, 1
    ds_read_b128 v[136:139], v234 offset:4096
    v_mfma_f32_16x16x32_bf16 v[76:79], v[216:219], v[172:175], v[76:79]
    ds_read_b128 v[140:143], v234 offset:6144
    v_mfma_f32_16x16x32_bf16 v[80:83], v[216:219], v[176:179], v[80:83]
    ds_read_b128 v[144:147], v234 offset:8192
    v_mfma_f32_16x16x32_bf16 v[84:87], v[216:219], v[180:183], v[84:87]
    ds_read_b128 v[148:151], v234 offset:10240
    ds_read_b128 v[152:155], v234 offset:12288
    v_mfma_f32_16x16x32_bf16 v[88:91], v[216:219], v[184:187], v[88:91]
    ds_read_b128 v[156:159], v234 offset:14336
    v_mfma_f32_16x16x32_bf16 v[92:95], v[216:219], v[188:191], v[92:95]
    ds_read_b64_tr_b16 v[196:197], v236 offset:32768
    v_mfma_f32_16x16x32_bf16 v[96:99], v[220:223], v[160:163], v[96:99]
    ds_read_b64_tr_b16 v[198:199], v236 offset:34816
    ds_read_b64_tr_b16 v[200:201], v237 offset:32768
    v_mfma_f32_16x16x32_bf16 v[100:103], v[220:223], v[164:167], v[100:103]
    ds_read_b64_tr_b16 v[202:203], v237 offset:34816
    v_mfma_f32_16x16x32_bf16 v[104:107], v[220:223], v[168:171], v[104:107]
    ds_read_b64_tr_b16 v[204:205], v238 offset:32768
    v_mfma_f32_16x16x32_bf16 v[108:111], v[220:223], v[172:175], v[108:111]
    ds_read_b64_tr_b16 v[206:207], v238 offset:34816
    v_mfma_f32_16x16x32_bf16 v[112:115], v[220:223], v[176:179], v[112:115]
    v_mfma_f32_16x16x32_bf16 v[116:119], v[220:223], v[180:183], v[116:119]
    v_mfma_f32_16x16x32_bf16 v[120:123], v[220:223], v[184:187], v[120:123]
    v_mfma_f32_16x16x32_bf16 v[124:127], v[220:223], v[188:191], v[124:127]
    s_add_u32 s29, s29, 2
    s_cmp_ge_u32 s29, s21
    s_cbranch_scc1 proj_kernel_epi0_2
    s_branch proj_kernel_D0_2
proj_kernel_S0_2:
    s_waitcnt lgkmcnt(0)
    s_cmp_lg_u32 s45, 0
    s_cbranch_scc1 proj_kernel_S0_2_rlx
    s_waitcnt vmcnt(8)
    s_barrier
proj_kernel_S0_2_join:
    v_mfma_f32_16x16x32_bf16 v[0:3], v[192:195], v[128:131], v[0:3]
    s_add_u32 s40, s25, s34
    v_add_u32 v234, s27, v233
    v_mfma_f32_16x16x32_bf16 v[4:7], v[192:195], v[132:135], v[4:7]
    s_cmp_eq_u32 s42, s44
    s_cbranch_scc1 proj_kernel_S0_2_wsw
proj_kernel_S0_2_wswr:
    v_mfma_f32_16x16x32_bf16 v[8:11], v[192:195], v[136:139], v[8:11]
    s_and_b32 s94, s98, 15
    v_mfma_f32_16x16x32_bf16 v[12:15], v[192:195], v[140:143], v[12:15]
    s_lshr_b64 s[98:99], s[98:99], 4
    v_mfma_f32_16x16x32_bf16 v[16:19], v[192:195], v[144:147], v[16:19]
    s_mul_i32 s94, s94, s35
    v_mfma_f32_16x16x32_bf16 v[20:23], v[192:195], v[148:151], v[20:23]
    s_lshl_b32 s26, s94, 1
    v_mfma_f32_16x16x32_bf16 v[24:27], v[192:195], v[152:155], v[24:27]
    s_add_u32 m0, s32, 32768
    v_mfma_f32_16x16x32_bf16 v[28:31], v[192:195], v[156:159], v[28:31]
    ds_read_b64_tr_b16 v[208:209], v235 offset:49152
    buffer_load_dwordx4 v226, s[12:15], s26 offen  lds
    v_mfma_f32_16x16x32_bf16 v[32:35], v[196:199], v[128:131], v[32:35]
    s_add_u32 m0, s32, 33792
    v_mfma_f32_16x16x32_bf16 v[36:39], v[196:199], v[132:135], v[36:39]
    ds_read_b64_tr_b16 v[210:211], v235 offset:51200
    v_mfma_f32_16x16x32_bf16 v[40:43], v[196:199], v[136:139], v[40:43]
    buffer_load_dwordx4 v227, s[12:15], s26 offen  lds
    v_mfma_f32_16x16x32_bf16 v[44:47], v[196:199], v[140:143], v[44:47]
    s_add_u32 m0, s28, 16384
    v_mfma_f32_16x16x32_bf16 v[48:51], v[196:199], v[144:147], v[48:51]
    ds_read_b128 v[160:163], v234 offset:0
    v_mfma_f32_16x16x32_bf16 v[52:55], v[196:199], v[148:151], v[52:55]
    buffer_load_dwordx4 v224, s[8:11], s40 offen  lds
    v_mfma_f32_16x16x32_bf16 v[56:59], v[196:199], v[152:155], v[56:59]
    s_add_u32 m0, s28, 17408
    ds_read_b128 v[164:167], v234 offset:2048
    v_mfma_f32_16x16x32_bf16 v[60:63], v[196:199], v[156:159], v[60:63]
    buffer_load_dwordx4 v225, s[8:11], s40 offen  lds
    v_mfma_f32_16x16x32_bf16 v[64:67], v[200:203], v[128:131], v[64:67]
    s_add_u32 s42, s42, 1
    v_mfma_f32_16x16x32_bf16 v[68:71], v[200:203], v[132:135], v[68:71]
    ds_read_b128 v[168:171], v234 offset:4096
    v_mfma_f32_16x16x32_bf16 v[72:75], v[200:203], v[136:139], v[72:75]
    ds_read_b128 v[172:175], v234 offset:6144
    v_mfma_f32_16x16x32_bf16 v[76:79], v[200:203], v[140:143], v[76:79]
    ds_read_b128 v[176:179], v234 offset:8192
    v_mfma_f32_16x16x32_bf16 v[80:83], v[200:203], v[144:147], v[80:83]
    ds_read_b128 v[180:183], v234 offset:10240
    v_mfma_f32_16x16x32_bf16 v[84:87], v[200:203], v[148:151], v[84:87]
    ds_read_b128 v[184:187], v234 offset:12288
    ds_read_b128 v[188:191], v234 offset:14336
    v_mfma_f32_16x16x32_bf16 v[88:91], v[200:203], v[152:155], v[88:91]
    ds_read_b64_tr_b16 v[212:213], v236 offset:49152
    v_mfma_f32_16x16x32_bf16 v[92:95], v[200:203], v[156:159], v[92:95]
    ds_read_b64_tr_b16 v[214:215], v236 offset:51200
    v_mfma_f32_16x16x32_bf16 v[96:99], v[204:207], v[128:131], v[96:99]
    ds_read_b64_tr_b16 v[216:217], v237 offset:49152
    v_mfma_f32_16x16x32_bf16 v[100:103], v[204:207], v[132:135], v[100:103]
    ds_read_b64_tr_b16 v[218:219], v237 offset:51200
    v_mfma_f32_16x16x32_bf16 v[104:107], v[204:207], v[136:139], v[104:107]
    ds_read_b64_tr_b16 v[220:221], v238 offset:49152
    v_mfma_f32_16x16x32_bf16 v[108:111], v[204:207], v[140:143], v[108:111]
    ds_read_b64_tr_b16 v[222:223], v238 offset:51200
    v_mfma_f32_16x16x32_bf16 v[112:115], v[204:207], v[144:147], v[112:115]
    v_mfma_f32_16x16x32_bf16 v[116:119], v[204:207], v[148:151], v[116:119]
    v_mfma_f32_16x16x32_bf16 v[120:123], v[204:207], v[152:155], v[120:123]
    v_mfma_f32_16x16x32_bf16 v[124:127], v[204:207], v[156:159], v[124:127]
proj_kernel_S0_3:
    s_waitcnt lgkmcnt(0)
    s_cmp_lg_u32 s45, 0
    s_cbranch_scc1 proj_kernel_S0_3_rlx
    s_waitcnt vmcnt(8)
    s_barrier
proj_kernel_S0_3_join:
    v_mfma_f32_16x16x32_bf16 v[0:3], v[208:211], v[160:163], v[0:3]
    s_sub_u32 s28, s27, 65536
    s_add_u32 s28, s28, s33
    v_mfma_f32_16x16x32_bf16 v[4:7], v[208:211], v[164:167], v[4:7]
    s_add_u32 s27, s27, 32768
    v_mfma_f32_16x16x32_bf16 v[8:11], v[208:211], v[168:171], v[8:11]
    s_cmp_eq_u32 s27, 163840
    s_cselect_b32 s27, 65536, s27
    v_mfma_f32_16x16x32_bf16 v[12:15], v[208:211], v[172:175], v[12:15]
    s_add_u32 s41, s41, 1
    s_cmp_eq_u32 s41, s43
    s_cbranch_scc1 proj_kernel_S0_3_tsw
proj_kernel_S0_3_tswr:
    v_mfma_f32_16x16x32_bf16 v[16:19], v[208:211], v[176:179], v[16:19]
    s_and_b32 s25, s96, 15
    v_mfma_f32_16x16x32_bf16 v[20:23], v[208:211], v[180:183], v[20:23]
    s_lshr_b64 s[96:97], s[96:97], 4
    v_mfma_f32_16x16x32_bf16 v[24:27], v[208:211], v[184:187], v[24:27]
    s_lshl_b32 s25, s25, 7
    v_add_u32 v234, s27, v232
    v_mfma_f32_16x16x32_bf16 v[28:31], v[208:211], v[188:191], v[28:31]
    s_cmp_eq_u32 s42, s44
    s_cbranch_scc1 proj_kernel_S0_3_wsw
proj_kernel_S0_3_wswr:
    v_mfma_f32_16x16x32_bf16 v[32:35], v[212:215], v[160:163], v[32:35]
    s_add_u32 s26, s26, s35
    v_mfma_f32_16x16x32_bf16 v[36:39], v[212:215], v[164:167], v[36:39]
    s_add_u32 m0, s32, 49152
    ds_read_b64_tr_b16 v[192:193], v235 offset:0
    v_mfma_f32_16x16x32_bf16 v[40:43], v[212:215], v[168:171], v[40:43]
    buffer_load_dwordx4 v226, s[12:15], s26 offen  lds
    v_mfma_f32_16x16x32_bf16 v[44:47], v[212:215], v[172:175], v[44:47]
    s_add_u32 m0, s32, 50176
    v_mfma_f32_16x16x32_bf16 v[48:51], v[212:215], v[176:179], v[48:51]
    ds_read_b64_tr_b16 v[194:195], v235 offset:2048
    buffer_load_dwordx4 v227, s[12:15], s26 offen  lds
    v_mfma_f32_16x16x32_bf16 v[52:55], v[212:215], v[180:183], v[52:55]
    s_add_u32 m0, s28, 0
    v_mfma_f32_16x16x32_bf16 v[56:59], v[212:215], v[184:187], v[56:59]
    ds_read_b128 v[128:131], v234 offset:0
    v_mfma_f32_16x16x32_bf16 v[60:63], v[212:215], v[188:191], v[60:63]
    buffer_load_dwordx4 v224, s[8:11], s25 offen  lds
    s_add_u32 m0, s28, 1024
    v_mfma_f32_16x16x32_bf16 v[64:67], v[216:219], v[160:163], v[64:67]
    ds_read_b128 v[132:135], v234 offset:2048
    v_mfma_f32_16x16x32_bf16 v[68:71], v[216:219], v[164:167], v[68:71]
    buffer_load_dwordx4 v225, s[8:11], s25 offen  lds
    v_mfma_f32_16x16x32_bf16 v[72:75], v[216:219], v[168:171], v[72:75]
    s_add_u32 s42, s42, 1
    ds_read_b128 v[136:139], v234 offset:4096
    v_mfma_f32_16x16x32_bf16 v[76:79], v[216:219], v[172:175], v[76:79]
    ds_read_b128 v[140:143], v234 offset:6144
    v_mfma_f32_16x16x32_bf16 v[80:83], v[216:219], v[176:179], v[80:83]
    ds_read_b128 v[144:147], v234 offset:8192
    v_mfma_f32_16x16x32_bf16 v[84:87], v[216:219], v[180:183], v[84:87]
    ds_read_b128 v[148:151], v234 offset:10240
    ds_read_b128 v[152:155], v234 offset:12288
    v_mfma_f32_16x16x32_bf16 v[88:91], v[216:219], v[184:187], v[88:91]
    ds_read_b128 v[156:159], v234 offset:14336
    v_mfma_f32_16x16x32_bf16 v[92:95], v[216:219], v[188:191], v[92:95]
    ds_read_b64_tr_b16 v[196:197], v236 offset:0
    v_mfma_f32_16x16x32_bf16 v[96:99], v[220:223], v[160:163], v[96:99]
    ds_read_b64_tr_b16 v[198:199], v236 offset:2048
    ds_read_b64_tr_b16 v[200:201], v237 offset:0
    v_mfma_f32_16x16x32_bf16 v[100:103], v[220:223], v[164:167], v[100:103]
    ds_read_b64_tr_b16 v[202:203], v237 offset:2048
    v_mfma_f32_16x16x32_bf16 v[104:107], v[220:223], v[168:171], v[104:107]
    ds_read_b64_tr_b16 v[204:205], v238 offset:0
    v_mfma_f32_16x16x32_bf16 v[108:111], v[220:223], v[172:175], v[108:111]
    ds_read_b64_tr_b16 v[206:207], v238 offset:2048
    v_mfma_f32_16x16x32_bf16 v[112:115], v[220:223], v[176:179], v[112:115]
    v_mfma_f32_16x16x32_bf16 v[116:119], v[220:223], v[180:183], v[116:119]
    v_mfma_f32_16x16x32_bf16 v[120:123], v[220:223], v[184:187], v[120:123]
    v_mfma_f32_16x16x32_bf16 v[124:127], v[220:223], v[188:191], v[124:127]
    s_add_u32 s29, s29, 2
    s_cmp_ge_u32 s29, s21
    s_cbranch_scc1 proj_kernel_epi0_0
    s_branch proj_kernel_D0_0
proj_kernel_D0_0:
    s_cmp_eq_u32 s95, 0
    s_cbranch_scc0 proj_kernel_D0_0_n
    s_cmp_ge_u32 s29, 12
    s_cbranch_scc0 proj_kernel_D0_0_n
    s_mov_b32 s95, 1
    s_sub_u32 s3, s21, 6
    s_cmp_eq_u32 s20, 5
    s_cbranch_scc0 proj_kernel_D0_0_n
proj_kernel_D0_0_n:
    s_cmp_lt_u32 s29, s51
    s_cbranch_scc1 proj_kernel_S0_0
    s_cmp_lt_u32 s29, s3
    s_cbranch_scc1 proj_kernel_F0_0
    s_branch proj_kernel_S0_0
proj_kernel_D0_2:
    s_cmp_eq_u32 s95, 0
    s_cbranch_scc0 proj_kernel_D0_2_n
    s_cmp_ge_u32 s29, 12
    s_cbranch_scc0 proj_kernel_D0_2_n
    s_mov_b32 s95, 1
    s_sub_u32 s3, s21, 6
    s_cmp_eq_u32 s20, 5
    s_cbranch_scc0 proj_kernel_D0_2_n
proj_kernel_D0_2_n:
    s_cmp_lt_u32 s29, s51
    s_cbranch_scc1 proj_kernel_S0_2
    s_cmp_lt_u32 s29, s3
    s_cbranch_scc1 proj_kernel_F0_2
    s_branch proj_kernel_S0_2
proj_kernel_epi0_0:
    s_mov_b32 s39, 0
    s_branch proj_kernel_epi0
proj_kernel_epi0_2:
    s_mov_b32 s39, 2
proj_kernel_epi0:
    s_mov_b32 s29, s39
    s_nop 7
    s_nop 7
    s_and_b32 s36, s20, 1
    s_lshr_b32 s37, s20, 1
    s_lshl_b32 s38, s24, 3
    s_lshl_b32 s36, s36, 2
    s_add_u32 s38, s38, s36
    s_lshl_b32 s38, s38, 14
    v_and_b32 v240, 15, v244
    v_lshrrev_b32 v241, 4, v244
    v_lshrrev_b32 v242, 1, v241
    v_and_b32 v241, 1, v241
    s_cmp_eq_u32 s23, 0
    s_cbranch_scc1 proj_kernel_noscale
    v_mul_f32 v0, s23, v0
    v_mul_f32 v1, s23, v1
    v_mul_f32 v2, s23, v2
    v_mul_f32 v3, s23, v3
    v_mul_f32 v4, s23, v4
    v_mul_f32 v5, s23, v5
    v_mul_f32 v6, s23, v6
    v_mul_f32 v7, s23, v7
    v_mul_f32 v8, s23, v8
    v_mul_f32 v9, s23, v9
    v_mul_f32 v10, s23, v10
    v_mul_f32 v11, s23, v11
    v_mul_f32 v12, s23, v12
    v_mul_f32 v13, s23, v13
    v_mul_f32 v14, s23, v14
    v_mul_f32 v15, s23, v15
    v_mul_f32 v16, s23, v16
    v_mul_f32 v17, s23, v17
    v_mul_f32 v18, s23, v18
    v_mul_f32 v19, s23, v19
    v_mul_f32 v20, s23, v20
    v_mul_f32 v21, s23, v21
    v_mul_f32 v22, s23, v22
    v_mul_f32 v23, s23, v23
    v_mul_f32 v24, s23, v24
    v_mul_f32 v25, s23, v25
    v_mul_f32 v26, s23, v26
    v_mul_f32 v27, s23, v27
    v_mul_f32 v28, s23, v28
    v_mul_f32 v29, s23, v29
    v_mul_f32 v30, s23, v30
    v_mul_f32 v31, s23, v31
    v_mul_f32 v32, s23, v32
    v_mul_f32 v33, s23, v33
    v_mul_f32 v34, s23, v34
    v_mul_f32 v35, s23, v35
    v_mul_f32 v36, s23, v36
    v_mul_f32 v37, s23, v37
    v_mul_f32 v38, s23, v38
    v_mul_f32 v39, s23, v39
    v_mul_f32 v40, s23, v40
    v_mul_f32 v41, s23, v41
    v_mul_f32 v42, s23, v42
    v_mul_f32 v43, s23, v43
    v_mul_f32 v44, s23, v44
    v_mul_f32 v45, s23, v45
    v_mul_f32 v46, s23, v46
    v_mul_f32 v47, s23, v47
    v_mul_f32 v48, s23, v48
    v_mul_f32 v49, s23, v49
    v_mul_f32 v50, s23, v50
    v_mul_f32 v51, s23, v51
    v_mul_f32 v52, s23, v52
    v_mul_f32 v53, s23, v53
    v_mul_f32 v54, s23, v54
    v_mul_f32 v55, s23, v55
    v_mul_f32 v56, s23, v56
    v_mul_f32 v57, s23, v57
    v_mul_f32 v58, s23, v58
    v_mul_f32 v59, s23, v59
    v_mul_f32 v60, s23, v60
    v_mul_f32 v61, s23, v61
    v_mul_f32 v62, s23, v62
    v_mul_f32 v63, s23, v63
    v_mul_f32 v64, s23, v64
    v_mul_f32 v65, s23, v65
    v_mul_f32 v66, s23, v66
    v_mul_f32 v67, s23, v67
    v_mul_f32 v68, s23, v68
    v_mul_f32 v69, s23, v69
    v_mul_f32 v70, s23, v70
    v_mul_f32 v71, s23, v71
    v_mul_f32 v72, s23, v72
    v_mul_f32 v73, s23, v73
    v_mul_f32 v74, s23, v74
    v_mul_f32 v75, s23, v75
    v_mul_f32 v76, s23, v76
    v_mul_f32 v77, s23, v77
    v_mul_f32 v78, s23, v78
    v_mul_f32 v79, s23, v79
    v_mul_f32 v80, s23, v80
    v_mul_f32 v81, s23, v81
    v_mul_f32 v82, s23, v82
    v_mul_f32 v83, s23, v83
    v_mul_f32 v84, s23, v84
    v_mul_f32 v85, s23, v85
    v_mul_f32 v86, s23, v86
    v_mul_f32 v87, s23, v87
    v_mul_f32 v88, s23, v88
    v_mul_f32 v89, s23, v89
    v_mul_f32 v90, s23, v90
    v_mul_f32 v91, s23, v91
    v_mul_f32 v92, s23, v92
    v_mul_f32 v93, s23, v93
    v_mul_f32 v94, s23, v94
    v_mul_f32 v95, s23, v95
    v_mul_f32 v96, s23, v96
    v_mul_f32 v97, s23, v97
    v_mul_f32 v98, s23, v98
    v_mul_f32 v99, s23, v99
    v_mul_f32 v100, s23, v100
    v_mul_f32 v101, s23, v101
    v_mul_f32 v102, s23, v102
    v_mul_f32 v103, s23, v103
    v_mul_f32 v104, s23, v104
    v_mul_f32 v105, s23, v105
    v_mul_f32 v106, s23, v106
    v_mul_f32 v107, s23, v107
    v_mul_f32 v108, s23, v108
    v_mul_f32 v109, s23, v109
    v_mul_f32 v110, s23, v110
    v_mul_f32 v111, s23, v111
    v_mul_f32 v112, s23, v112
    v_mul_f32 v113, s23, v113
    v_mul_f32 v114, s23, v114
    v_mul_f32 v115, s23, v115
    v_mul_f32 v116, s23, v116
    v_mul_f32 v117, s23, v117
    v_mul_f32 v118, s23, v118
    v_mul_f32 v119, s23, v119
    v_mul_f32 v120, s23, v120
    v_mul_f32 v121, s23, v121
    v_mul_f32 v122, s23, v122
    v_mul_f32 v123, s23, v123
    v_mul_f32 v124, s23, v124
    v_mul_f32 v125, s23, v125
    v_mul_f32 v126, s23, v126
    v_mul_f32 v127, s23, v127
proj_kernel_noscale:
    v_lshlrev_b32 v242, 10, v242
    v_lshl_add_u32 v242, v241, 9, v242
    v_and_b32 v241, 7, v240
    v_lshrrev_b32 v240, 3, v240
    v_lshl_add_u32 v241, v240, 4, v241
    v_lshl_add_u32 v239, v241, 4, v242
    s_lshl_b32 s37, s37, 12
    s_add_u32 s38, s38, s37
    s_cmp_eq_u32 s55, 1
    s_cbranch_scc0 proj_kernel_st0_1
    v_cvt_pk_bf16_f32 v160, v0, v1
    v_cvt_pk_bf16_f32 v161, v2, v3
    v_cvt_pk_bf16_f32 v162, v32, v33
    v_cvt_pk_bf16_f32 v163, v34, v35
    buffer_store_dwordx4 v[160:163], v239, s[16:19], s38 offen offset:0 sc1
    v_cvt_pk_bf16_f32 v164, v64, v65
    v_cvt_pk_bf16_f32 v165, v66, v67
    v_cvt_pk_bf16_f32 v166, v96, v97
    v_cvt_pk_bf16_f32 v167, v98, v99
    buffer_store_dwordx4 v[164:167], v239, s[16:19], s38 offen offset:2048 sc1
    v_cvt_pk_bf16_f32 v168, v4, v5
    v_cvt_pk_bf16_f32 v169, v6, v7
    v_cvt_pk_bf16_f32 v170, v36, v37
    v_cvt_pk_bf16_f32 v171, v38, v39
    buffer_store_dwordx4 v[168:171], v239, s[16:19], s38 offen offset:128 sc1
    v_cvt_pk_bf16_f32 v172, v68, v69
    v_cvt_pk_bf16_f32 v173, v70, v71
    v_cvt_pk_bf16_f32 v174, v100, v101
    v_cvt_pk_bf16_f32 v175, v102, v103
    buffer_store_dwordx4 v[172:175], v239, s[16:19], s38 offen offset:2176 sc1
    s_add_u32 s38, s38, 16384
    v_cvt_pk_bf16_f32 v160, v8, v9
    v_cvt_pk_bf16_f32 v161, v10, v11
    v_cvt_pk_bf16_f32 v162, v40, v41
    v_cvt_pk_bf16_f32 v163, v42, v43
    buffer_store_dwordx4 v[160:163], v239, s[16:19], s38 offen offset:0 sc1
    v_cvt_pk_bf16_f32 v164, v72, v73
    v_cvt_pk_bf16_f32 v165, v74, v75
    v_cvt_pk_bf16_f32 v166, v104, v105
    v_cvt_pk_bf16_f32 v167, v106, v107
    buffer_store_dwordx4 v[164:167], v239, s[16:19], s38 offen offset:2048 sc1
    v_cvt_pk_bf16_f32 v168, v12, v13
    v_cvt_pk_bf16_f32 v169, v14, v15
    v_cvt_pk_bf16_f32 v170, v44, v45
    v_cvt_pk_bf16_f32 v171, v46, v47
    buffer_store_dwordx4 v[168:171], v239, s[16:19], s38 offen offset:128 sc1
    v_cvt_pk_bf16_f32 v172, v76, v77
    v_cvt_pk_bf16_f32 v173, v78, v79
    v_cvt_pk_bf16_f32 v174, v108, v109
    v_cvt_pk_bf16_f32 v175, v110, v111
    buffer_store_dwordx4 v[172:175], v239, s[16:19], s38 offen offset:2176 sc1
    s_add_u32 s38, s38, 16384
    v_cvt_pk_bf16_f32 v160, v16, v17
    v_cvt_pk_bf16_f32 v161, v18, v19
    v_cvt_pk_bf16_f32 v162, v48, v49
    v_cvt_pk_bf16_f32 v163, v50, v51
    buffer_store_dwordx4 v[160:163], v239, s[16:19], s38 offen offset:0 sc1
    v_cvt_pk_bf16_f32 v164, v80, v81
    v_cvt_pk_bf16_f32 v165, v82, v83
    v_cvt_pk_bf16_f32 v166, v112, v113
    v_cvt_pk_bf16_f32 v167, v114, v115
    buffer_store_dwordx4 v[164:167], v239, s[16:19], s38 offen offset:2048 sc1
    v_cvt_pk_bf16_f32 v168, v20, v21
    v_cvt_pk_bf16_f32 v169, v22, v23
    v_cvt_pk_bf16_f32 v170, v52, v53
    v_cvt_pk_bf16_f32 v171, v54, v55
    buffer_store_dwordx4 v[168:171], v239, s[16:19], s38 offen offset:128 sc1
    v_cvt_pk_bf16_f32 v172, v84, v85
    v_cvt_pk_bf16_f32 v173, v86, v87
    v_cvt_pk_bf16_f32 v174, v116, v117
    v_cvt_pk_bf16_f32 v175, v118, v119
    buffer_store_dwordx4 v[172:175], v239, s[16:19], s38 offen offset:2176 sc1
    s_add_u32 s38, s38, 16384
    v_cvt_pk_bf16_f32 v160, v24, v25
    v_cvt_pk_bf16_f32 v161, v26, v27
    v_cvt_pk_bf16_f32 v162, v56, v57
    v_cvt_pk_bf16_f32 v163, v58, v59
    buffer_store_dwordx4 v[160:163], v239, s[16:19], s38 offen offset:0 sc1
    v_cvt_pk_bf16_f32 v164, v88, v89
    v_cvt_pk_bf16_f32 v165, v90, v91
    v_cvt_pk_bf16_f32 v166, v120, v121
    v_cvt_pk_bf16_f32 v167, v122, v123
    buffer_store_dwordx4 v[164:167], v239, s[16:19], s38 offen offset:2048 sc1
    v_cvt_pk_bf16_f32 v168, v28, v29
    v_cvt_pk_bf16_f32 v169, v30, v31
    v_cvt_pk_bf16_f32 v170, v60, v61
    v_cvt_pk_bf16_f32 v171, v62, v63
    buffer_store_dwordx4 v[168:171], v239, s[16:19], s38 offen offset:128 sc1
    v_cvt_pk_bf16_f32 v172, v92, v93
    v_cvt_pk_bf16_f32 v173, v94, v95
    v_cvt_pk_bf16_f32 v174, v124, v125
    v_cvt_pk_bf16_f32 v175, v126, v127
    buffer_store_dwordx4 v[172:175], v239, s[16:19], s38 offen offset:2176 sc1
    s_add_u32 s38, s38, 16384
    s_branch proj_kernel_next
proj_kernel_st0_1:
    v_cvt_pk_bf16_f32 v160, v0, v1
    v_cvt_pk_bf16_f32 v161, v2, v3
    v_cvt_pk_bf16_f32 v162, v32, v33
    v_cvt_pk_bf16_f32 v163, v34, v35
    buffer_store_dwordx4 v[160:163], v239, s[16:19], s38 offen offset:0 sc1
    v_cvt_pk_bf16_f32 v164, v64, v65
    v_cvt_pk_bf16_f32 v165, v66, v67
    v_cvt_pk_bf16_f32 v166, v96, v97
    v_cvt_pk_bf16_f32 v167, v98, v99
    buffer_store_dwordx4 v[164:167], v239, s[16:19], s38 offen offset:2048 sc1
    v_cvt_pk_bf16_f32 v168, v4, v5
    v_cvt_pk_bf16_f32 v169, v6, v7
    v_cvt_pk_bf16_f32 v170, v36, v37
    v_cvt_pk_bf16_f32 v171, v38, v39
    buffer_store_dwordx4 v[168:171], v239, s[16:19], s38 offen offset:128 sc1
    v_cvt_pk_bf16_f32 v172, v68, v69
    v_cvt_pk_bf16_f32 v173, v70, v71
    v_cvt_pk_bf16_f32 v174, v100, v101
    v_cvt_pk_bf16_f32 v175, v102, v103
    buffer_store_dwordx4 v[172:175], v239, s[16:19], s38 offen offset:2176 sc1
    s_add_u32 s38, s38, 16384
    v_cvt_pk_bf16_f32 v160, v8, v9
    v_cvt_pk_bf16_f32 v161, v10, v11
    v_cvt_pk_bf16_f32 v162, v40, v41
    v_cvt_pk_bf16_f32 v163, v42, v43
    buffer_store_dwordx4 v[160:163], v239, s[16:19], s38 offen offset:0 sc1
    v_cvt_pk_bf16_f32 v164, v72, v73
    v_cvt_pk_bf16_f32 v165, v74, v75
    v_cvt_pk_bf16_f32 v166, v104, v105
    v_cvt_pk_bf16_f32 v167, v106, v107
    buffer_store_dwordx4 v[164:167], v239, s[16:19], s38 offen offset:2048 sc1
    v_cvt_pk_bf16_f32 v168, v12, v13
    v_cvt_pk_bf16_f32 v169, v14, v15
    v_cvt_pk_bf16_f32 v170, v44, v45
    v_cvt_pk_bf16_f32 v171, v46, v47
    buffer_store_dwordx4 v[168:171], v239, s[16:19], s38 offen offset:128 sc1
    v_cvt_pk_bf16_f32 v172, v76, v77
    v_cvt_pk_bf16_f32 v173, v78, v79
    v_cvt_pk_bf16_f32 v174, v108, v109
    v_cvt_pk_bf16_f32 v175, v110, v111
    buffer_store_dwordx4 v[172:175], v239, s[16:19], s38 offen offset:2176 sc1
    s_add_u32 s38, s38, 16384
    v_cvt_pk_bf16_f32 v160, v16, v17
    v_cvt_pk_bf16_f32 v161, v18, v19
    v_cvt_pk_bf16_f32 v162, v48, v49
    v_cvt_pk_bf16_f32 v163, v50, v51
    buffer_store_dwordx4 v[160:163], v239, s[16:19], s38 offen offset:0 sc1
    v_cvt_pk_bf16_f32 v164, v80, v81
    v_cvt_pk_bf16_f32 v165, v82, v83
    v_cvt_pk_bf16_f32 v166, v112, v113
    v_cvt_pk_bf16_f32 v167, v114, v115
    buffer_store_dwordx4 v[164:167], v239, s[16:19], s38 offen offset:2048 sc1
    v_cvt_pk_bf16_f32 v168, v20, v21
    v_cvt_pk_bf16_f32 v169, v22, v23
    v_cvt_pk_bf16_f32 v170, v52, v53
    v_cvt_pk_bf16_f32 v171, v54, v55
    buffer_store_dwordx4 v[168:171], v239, s[16:19], s38 offen offset:128 sc1
    v_cvt_pk_bf16_f32 v172, v84, v85
    v_cvt_pk_bf16_f32 v173, v86, v87
    v_cvt_pk_bf16_f32 v174, v116, v117
    v_cvt_pk_bf16_f32 v175, v118, v119
    buffer_store_dwordx4 v[172:175], v239, s[16:19], s38 offen offset:2176 sc1
    s_add_u32 s38, s38, 16384
    v_cvt_pk_bf16_f32 v160, v24, v25
    v_cvt_pk_bf16_f32 v161, v26, v27
    v_cvt_pk_bf16_f32 v162, v56, v57
    v_cvt_pk_bf16_f32 v163, v58, v59
    buffer_store_dwordx4 v[160:163], v239, s[16:19], s38 offen offset:0 sc1
    v_cvt_pk_bf16_f32 v164, v88, v89
    v_cvt_pk_bf16_f32 v165, v90, v91
    v_cvt_pk_bf16_f32 v166, v120, v121
    v_cvt_pk_bf16_f32 v167, v122, v123
    buffer_store_dwordx4 v[164:167], v239, s[16:19], s38 offen offset:2048 sc1
    v_cvt_pk_bf16_f32 v168, v28, v29
    v_cvt_pk_bf16_f32 v169, v30, v31
    v_cvt_pk_bf16_f32 v170, v60, v61
    v_cvt_pk_bf16_f32 v171, v62, v63
    buffer_store_dwordx4 v[168:171], v239, s[16:19], s38 offen offset:128 sc1
    v_cvt_pk_bf16_f32 v172, v92, v93
    v_cvt_pk_bf16_f32 v173, v94, v95
    v_cvt_pk_bf16_f32 v174, v124, v125
    v_cvt_pk_bf16_f32 v175, v126, v127
    buffer_store_dwordx4 v[172:175], v239, s[16:19], s38 offen offset:2176 sc1
    s_add_u32 s38, s38, 16384
    s_branch proj_kernel_next
proj_kernel_F1_0:
    s_waitcnt lgkmcnt(0)
    s_waitcnt vmcnt(8)
    s_barrier
    v_mfma_f32_16x16x32_bf16 v[0:3], v[128:131], v[192:195], v[0:3]
    s_add_u32 s40, s25, s34
    v_add_u32 v234, s27, v233
    v_mfma_f32_16x16x32_bf16 v[4:7], v[132:135], v[192:195], v[4:7]
    s_and_b32 s94, s98, 15
    v_mfma_f32_16x16x32_bf16 v[8:11], v[136:139], v[192:195], v[8:11]
    s_lshr_b64 s[98:99], s[98:99], 4
    v_mfma_f32_16x16x32_bf16 v[12:15], v[140:143], v[192:195], v[12:15]
    s_mul_i32 s94, s94, s35
    v_mfma_f32_16x16x32_bf16 v[16:19], v[144:147], v[192:195], v[16:19]
    s_lshl_b32 s26, s94, 1
    v_mfma_f32_16x16x32_bf16 v[20:23], v[148:151], v[192:195], v[20:23]
    s_add_u32 m0, s32, 0
    v_mfma_f32_16x16x32_bf16 v[24:27], v[152:155], v[192:195], v[24:27]
    ds_read_b64_tr_b16 v[208:209], v235 offset:16384
    v_mfma_f32_16x16x32_bf16 v[28:31], v[156:159], v[192:195], v[28:31]
    buffer_load_dwordx4 v226, s[12:15], s26 offen  lds
    v_mfma_f32_16x16x32_bf16 v[32:35], v[128:131], v[196:199], v[32:35]
    s_add_u32 m0, s32, 1024
    v_mfma_f32_16x16x32_bf16 v[36:39], v[132:135], v[196:199], v[36:39]
    ds_read_b64_tr_b16 v[210:211], v235 offset:18432
    buffer_load_dwordx4 v227, s[12:15], s26 offen  lds
    v_mfma_f32_16x16x32_bf16 v[40:43], v[136:139], v[196:199], v[40:43]
    s_add_u32 m0, s28, 16384
    v_mfma_f32_16x16x32_bf16 v[44:47], v[140:143], v[196:199], v[44:47]
    ds_read_b128 v[160:163], v234 offset:0
    v_mfma_f32_16x16x32_bf16 v[48:51], v[144:147], v[196:199], v[48:51]
    buffer_load_dwordx4 v224, s[8:11], s40 offen  lds
    v_mfma_f32_16x16x32_bf16 v[52:55], v[148:151], v[196:199], v[52:55]
    s_add_u32 m0, s28, 17408
    v_mfma_f32_16x16x32_bf16 v[56:59], v[152:155], v[196:199], v[56:59]
    ds_read_b128 v[164:167], v234 offset:2048
    v_mfma_f32_16x16x32_bf16 v[60:63], v[156:159], v[196:199], v[60:63]
    buffer_load_dwordx4 v225, s[8:11], s40 offen  lds
    v_mfma_f32_16x16x32_bf16 v[64:67], v[128:131], v[200:203], v[64:67]
    s_add_u32 s42, s42, 1
    v_mfma_f32_16x16x32_bf16 v[68:71], v[132:135], v[200:203], v[68:71]
    ds_read_b128 v[168:171], v234 offset:4096
    v_mfma_f32_16x16x32_bf16 v[72:75], v[136:139], v[200:203], v[72:75]
    ds_read_b128 v[172:175], v234 offset:6144
    ds_read_b128 v[176:179], v234 offset:8192
    v_mfma_f32_16x16x32_bf16 v[76:79], v[140:143], v[200:203], v[76:79]
    ds_read_b128 v[180:183], v234 offset:10240
    v_mfma_f32_16x16x32_bf16 v[80:83], v[144:147], v[200:203], v[80:83]
    ds_read_b128 v[184:187], v234 offset:12288
    v_mfma_f32_16x16x32_bf16 v[84:87], v[148:151], v[200:203], v[84:87]
    ds_read_b128 v[188:191], v234 offset:14336
    v_mfma_f32_16x16x32_bf16 v[88:91], v[152:155], v[200:203], v[88:91]
    ds_read_b64_tr_b16 v[212:213], v236 offset:16384
    v_mfma_f32_16x16x32_bf16 v[92:95], v[156:159], v[200:203], v[92:95]
    ds_read_b64_tr_b16 v[214:215], v236 offset:18432
    v_mfma_f32_16x16x32_bf16 v[96:99], v[128:131], v[204:207], v[96:99]
    ds_read_b64_tr_b16 v[216:217], v237 offset:16384
    v_mfma_f32_16x16x32_bf16 v[100:103], v[132:135], v[204:207], v[100:103]
    ds_read_b64_tr_b16 v[218:219], v237 offset:18432
    v_mfma_f32_16x16x32_bf16 v[104:107], v[136:139], v[204:207], v[104:107]
    ds_read_b64_tr_b16 v[220:221], v238 offset:16384
    v_mfma_f32_16x16x32_bf16 v[108:111], v[140:143], v[204:207], v[108:111]
    ds_read_b64_tr_b16 v[222:223], v238 offset:18432
    v_mfma_f32_16x16x32_bf16 v[112:115], v[144:147], v[204:207], v[112:115]
    v_mfma_f32_16x16x32_bf16 v[116:119], v[148:151], v[204:207], v[116:119]
    v_mfma_f32_16x16x32_bf16 v[120:123], v[152:155], v[204:207], v[120:123]
    v_mfma_f32_16x16x32_bf16 v[124:127], v[156:159], v[204:207], v[124:127]
proj_kernel_F1_1:
    s_waitcnt lgkmcnt(0)
    s_waitcnt vmcnt(8)
    s_barrier
    v_mfma_f32_16x16x32_bf16 v[0:3], v[160:163], v[208:211], v[0:3]
    s_sub_u32 s28, s27, 65536
    s_add_u32 s28, s28, s33
    v_mfma_f32_16x16x32_bf16 v[4:7], v[164:167], v[208:211], v[4:7]
    s_add_u32 s27, s27, 32768
    v_mfma_f32_16x16x32_bf16 v[8:11], v[168:171], v[208:211], v[8:11]
    s_cmp_eq_u32 s27, 163840
    s_cselect_b32 s27, 65536, s27
    v_mfma_f32_16x16x32_bf16 v[12:15], v[172:175], v[208:211], v[12:15]
    s_add_u32 s41, s41, 1
    v_mfma_f32_16x16x32_bf16 v[16:19], v[176:179], v[208:211], v[16:19]
    s_and_b32 s25, s96, 15
    s_lshr_b64 s[96:97], s[96:97], 4
    v_mfma_f32_16x16x32_bf16 v[20:23], v[180:183], v[208:211], v[20:23]
    s_lshl_b32 s25, s25, 7
    v_mfma_f32_16x16x32_bf16 v[24:27], v[184:187], v[208:211], v[24:27]
    v_add_u32 v234, s27, v232
    v_mfma_f32_16x16x32_bf16 v[28:31], v[188:191], v[208:211], v[28:31]
    s_add_u32 s26, s26, s35
    v_mfma_f32_16x16x32_bf16 v[32:35], v[160:163], v[212:215], v[32:35]
    s_add_u32 m0, s32, 16384
    ds_read_b64_tr_b16 v[192:193], v235 offset:32768
    v_mfma_f32_16x16x32_bf16 v[36:39], v[164:167], v[212:215], v[36:39]
    buffer_load_dwordx4 v226, s[12:15], s26 offen  lds
    v_mfma_f32_16x16x32_bf16 v[40:43], v[168:171], v[212:215], v[40:43]
    s_add_u32 m0, s32, 17408
    v_mfma_f32_16x16x32_bf16 v[44:47], v[172:175], v[212:215], v[44:47]
    ds_read_b64_tr_b16 v[194:195], v235 offset:34816
    v_mfma_f32_16x16x32_bf16 v[48:51], v[176:179], v[212:215], v[48:51]
    buffer_load_dwordx4 v227, s[12:15], s26 offen  lds
    s_add_u32 m0, s28, 0
    v_mfma_f32_16x16x32_bf16 v[52:55], v[180:183], v[212:215], v[52:55]
    ds_read_b128 v[128:131], v234 offset:0
    v_mfma_f32_16x16x32_bf16 v[56:59], v[184:187], v[212:215], v[56:59]
    buffer_load_dwordx4 v224, s[8:11], s25 offen  lds
    v_mfma_f32_16x16x32_bf16 v[60:63], v[188:191], v[212:215], v[60:63]
    s_add_u32 m0, s28, 1024
    v_mfma_f32_16x16x32_bf16 v[64:67], v[160:163], v[216:219], v[64:67]
    ds_read_b128 v[132:135], v234 offset:2048
    buffer_load_dwordx4 v225, s[8:11], s25 offen  lds
    v_mfma_f32_16x16x32_bf16 v[68:71], v[164:167], v[216:219], v[68:71]
    s_add_u32 s42, s42, 1
    v_mfma_f32_16x16x32_bf16 v[72:75], v[168:171], v[216:219], v[72:75]
    ds_read_b128 v[136:139], v234 offset:4096
    v_mfma_f32_16x16x32_bf16 v[76:79], v[172:175], v[216:219], v[76:79]
    ds_read_b128 v[140:143], v234 offset:6144
    v_mfma_f32_16x16x32_bf16 v[80:83], v[176:179], v[216:219], v[80:83]
    ds_read_b128 v[144:147], v234 offset:8192
    ds_read_b128 v[148:151], v234 offset:10240
    v_mfma_f32_16x16x32_bf16 v[84:87], v[180:183], v[216:219], v[84:87]
    ds_read_b128 v[152:155], v234 offset:12288
    v_mfma_f32_16x16x32_bf16 v[88:91], v[184:187], v[216:219], v[88:91]
    ds_read_b128 v[156:159], v234 offset:14336
    v_mfma_f32_16x16x32_bf16 v[92:95], v[188:191], v[216:219], v[92:95]
    ds_read_b64_tr_b16 v[196:197], v236 offset:32768
    v_mfma_f32_16x16x32_bf16 v[96:99], v[160:163], v[220:223], v[96:99]
    ds_read_b64_tr_b16 v[198:199], v236 offset:34816
    ds_read_b64_tr_b16 v[200:201], v237 offset:32768
    v_mfma_f32_16x16x32_bf16 v[100:103], v[164:167], v[220:223], v[100:103]
    ds_read_b64_tr_b16 v[202:203], v237 offset:34816
    v_mfma_f32_16x16x32_bf16 v[104:107], v[168:171], v[220:223], v[104:107]
    ds_read_b64_tr_b16 v[204:205], v238 offset:32768
    v_mfma_f32_16x16x32_bf16 v[108:111], v[172:175], v[220:223], v[108:111]
    ds_read_b64_tr_b16 v[206:207], v238 offset:34816
    v_mfma_f32_16x16x32_bf16 v[112:115], v[176:179], v[220:223], v[112:115]
    v_mfma_f32_16x16x32_bf16 v[116:119], v[180:183], v[220:223], v[116:119]
    v_mfma_f32_16x16x32_bf16 v[120:123], v[184:187], v[220:223], v[120:123]
    v_mfma_f32_16x16x32_bf16 v[124:127], v[188:191], v[220:223], v[124:127]
    s_add_u32 s29, s29, 2
    s_cmp_lt_u32 s29, s3
    s_cbranch_scc0 proj_kernel_D1_2
proj_kernel_F1_2:
    s_waitcnt lgkmcnt(0)
    s_waitcnt vmcnt(8)
    s_barrier
    v_mfma_f32_16x16x32_bf16 v[0:3], v[128:131], v[192:195], v[0:3]
    s_add_u32 s40, s25, s34
    v_add_u32 v234, s27, v233
    v_mfma_f32_16x16x32_bf16 v[4:7], v[132:135], v[192:195], v[4:7]
    s_and_b32 s94, s98, 15
    v_mfma_f32_16x16x32_bf16 v[8:11], v[136:139], v[192:195], v[8:11]
    s_lshr_b64 s[98:99], s[98:99], 4
    v_mfma_f32_16x16x32_bf16 v[12:15], v[140:143], v[192:195], v[12:15]
    s_mul_i32 s94, s94, s35
    v_mfma_f32_16x16x32_bf16 v[16:19], v[144:147], v[192:195], v[16:19]
    s_lshl_b32 s26, s94, 1
    v_mfma_f32_16x16x32_bf16 v[20:23], v[148:151], v[192:195], v[20:23]
    s_add_u32 m0, s32, 32768
    v_mfma_f32_16x16x32_bf16 v[24:27], v[152:155], v[192:195], v[24:27]
    ds_read_b64_tr_b16 v[208:209], v235 offset:49152
    v_mfma_f32_16x16x32_bf16 v[28:31], v[156:159], v[192:195], v[28:31]
    buffer_load_dwordx4 v226, s[12:15], s26 offen  lds
    v_mfma_f32_16x16x32_bf16 v[32:35], v[128:131], v[196:199], v[32:35]
    s_add_u32 m0, s32, 33792
    v_mfma_f32_16x16x32_bf16 v[36:39], v[132:135], v[196:199], v[36:39]
    ds_read_b64_tr_b16 v[210:211], v235 offset:51200
    buffer_load_dwordx4 v227, s[12:15], s26 offen  lds
    v_mfma_f32_16x16x32_bf16 v[40:43], v[136:139], v[196:199], v[40:43]
    s_add_u32 m0, s28, 16384
    v_mfma_f32_16x16x32_bf16 v[44:47], v[140:143], v[196:199], v[44:47]
    ds_read_b128 v[160:163], v234 offset:0
    v_mfma_f32_16x16x32_bf16 v[48:51], v[144:147], v[196:199], v[48:51]
    buffer_load_dwordx4 v224, s[8:11], s40 offen  lds
    v_mfma_f32_16x16x32_bf16 v[52:55], v[148:151], v[196:199], v[52:55]
    s_add_u32 m0, s28, 17408
    v_mfma_f32_16x16x32_bf16 v[56:59], v[152:155], v[196:199], v[56:59]
    ds_read_b128 v[164:167], v234 offset:2048
    v_mfma_f32_16x16x32_bf16 v[60:63], v[156:159], v[196:199], v[60:63]
    buffer_load_dwordx4 v225, s[8:11], s40 offen  lds
    v_mfma_f32_16x16x32_bf16 v[64:67], v[128:131], v[200:203], v[64:67]
    s_add_u32 s42, s42, 1
    v_mfma_f32_16x16x32_bf16 v[68:71], v[132:135], v[200:203], v[68:71]
    ds_read_b128 v[168:171], v234 offset:4096
    v_mfma_f32_16x16x32_bf16 v[72:75], v[136:139], v[200:203], v[72:75]
    ds_read_b128 v[172:175], v234 offset:6144
    ds_read_b128 v[176:179], v234 offset:8192
    v_mfma_f32_16x16x32_bf16 v[76:79], v[140:143], v[200:203], v[76:79]
    ds_read_b128 v[180:183], v234 offset:10240
    v_mfma_f32_16x16x32_bf16 v[80:83], v[144:147], v[200:203], v[80:83]
    ds_read_b128 v[184:187], v234 offset:12288
    v_mfma_f32_16x16x32_bf16 v[84:87], v[148:151], v[200:203], v[84:87]
    ds_read_b128 v[188:191], v234 offset:14336
    v_mfma_f32_16x16x32_bf16 v[88:91], v[152:155], v[200:203], v[88:91]
    ds_read_b64_tr_b16 v[212:213], v236 offset:49152
    v_mfma_f32_16x16x32_bf16 v[92:95], v[156:159], v[200:203], v[92:95]
    ds_read_b64_tr_b16 v[214:215], v236 offset:51200
    v_mfma_f32_16x16x32_bf16 v[96:99], v[128:131], v[204:207], v[96:99]
    ds_read_b64_tr_b16 v[216:217], v237 offset:49152
    v_mfma_f32_16x16x32_bf16 v[100:103], v[132:135], v[204:207], v[100:103]
    ds_read_b64_tr_b16 v[218:219], v237 offset:51200
    v_mfma_f32_16x16x32_bf16 v[104:107], v[136:139], v[204:207], v[104:107]
    ds_read_b64_tr_b16 v[220:221], v238 offset:49152
    v_mfma_f32_16x16x32_bf16 v[108:111], v[140:143], v[204:207], v[108:111]
    ds_read_b64_tr_b16 v[222:223], v238 offset:51200
    v_mfma_f32_16x16x32_bf16 v[112:115], v[144:147], v[204:207], v[112:115]
    v_mfma_f32_16x16x32_bf16 v[116:119], v[148:151], v[204:207], v[116:119]
    v_mfma_f32_16x16x32_bf16 v[120:123], v[152:155], v[204:207], v[120:123]
    v_mfma_f32_16x16x32_bf16 v[124:127], v[156:159], v[204:207], v[124:127]
proj_kernel_F1_3:
    s_waitcnt lgkmcnt(0)
    s_waitcnt vmcnt(8)
    s_barrier
    v_mfma_f32_16x16x32_bf16 v[0:3], v[160:163], v[208:211], v[0:3]
    s_sub_u32 s28, s27, 65536
    s_add_u32 s28, s28, s33
    v_mfma_f32_16x16x32_bf16 v[4:7], v[164:167], v[208:211], v[4:7]
    s_add_u32 s27, s27, 32768
    v_mfma_f32_16x16x32_bf16 v[8:11], v[168:171], v[208:211], v[8:11]
    s_cmp_eq_u32 s27, 163840
    s_cselect_b32 s27, 65536, s27
    v_mfma_f32_16x16x32_bf16 v[12:15], v[172:175], v[208:211], v[12:15]
    s_add_u32 s41, s41, 1
    v_mfma_f32_16x16x32_bf16 v[16:19], v[176:179], v[208:211], v[16:19]
    s_and_b32 s25, s96, 15
    s_lshr_b64 s[96:97], s[96:97], 4
    v_mfma_f32_16x16x32_bf16 v[20:23], v[180:183], v[208:211], v[20:23]
    s_lshl_b32 s25, s25, 7
    v_mfma_f32_16x16x32_bf16 v[24:27], v[184:187], v[208:211], v[24:27]
    v_add_u32 v234, s27, v232
    v_mfma_f32_16x16x32_bf16 v[28:31], v[188:191], v[208:211], v[28:31]
    s_add_u32 s26, s26, s35
    v_mfma_f32_16x16x32_bf16 v[32:35], v[160:163], v[212:215], v[32:35]
    s_add_u32 m0, s32, 49152
    ds_read_b64_tr_b16 v[192:193], v235 offset:0
    v_mfma_f32_16x16x32_bf16 v[36:39], v[164:167], v[212:215], v[36:39]
    buffer_load_dwordx4 v226, s[12:15], s26 offen  lds
    v_mfma_f32_16x16x32_bf16 v[40:43], v[168:171], v[212:215], v[40:43]
    s_add_u32 m0, s32, 50176
    v_mfma_f32_16x16x32_bf16 v[44:47], v[172:175], v[212:215], v[44:47]
    ds_read_b64_tr_b16 v[194:195], v235 offset:2048
    v_mfma_f32_16x16x32_bf16 v[48:51], v[176:179], v[212:215], v[48:51]
    buffer_load_dwordx4 v227, s[12:15], s26 offen  lds
    s_add_u32 m0, s28, 0
    v_mfma_f32_16x16x32_bf16 v[52:55], v[180:183], v[212:215], v[52:55]
    ds_read_b128 v[128:131], v234 offset:0
    v_mfma_f32_16x16x32_bf16 v[56:59], v[184:187], v[212:215], v[56:59]
    buffer_load_dwordx4 v224, s[8:11], s25 offen  lds
    v_mfma_f32_16x16x32_bf16 v[60:63], v[188:191], v[212:215], v[60:63]
    s_add_u32 m0, s28, 1024
    v_mfma_f32_16x16x32_bf16 v[64:67], v[160:163], v[216:219], v[64:67]
    ds_read_b128 v[132:135], v234 offset:2048
    buffer_load_dwordx4 v225, s[8:11], s25 offen  lds
    v_mfma_f32_16x16x32_bf16 v[68:71], v[164:167], v[216:219], v[68:71]
    s_add_u32 s42, s42, 1
    v_mfma_f32_16x16x32_bf16 v[72:75], v[168:171], v[216:219], v[72:75]
    ds_read_b128 v[136:139], v234 offset:4096
    v_mfma_f32_16x16x32_bf16 v[76:79], v[172:175], v[216:219], v[76:79]
    ds_read_b128 v[140:143], v234 offset:6144
    v_mfma_f32_16x16x32_bf16 v[80:83], v[176:179], v[216:219], v[80:83]
    ds_read_b128 v[144:147], v234 offset:8192
    ds_read_b128 v[148:151], v234 offset:10240
    v_mfma_f32_16x16x32_bf16 v[84:87], v[180:183], v[216:219], v[84:87]
    ds_read_b128 v[152:155], v234 offset:12288
    v_mfma_f32_16x16x32_bf16 v[88:91], v[184:187], v[216:219], v[88:91]
    ds_read_b128 v[156:159], v234 offset:14336
    v_mfma_f32_16x16x32_bf16 v[92:95], v[188:191], v[216:219], v[92:95]
    ds_read_b64_tr_b16 v[196:197], v236 offset:0
    v_mfma_f32_16x16x32_bf16 v[96:99], v[160:163], v[220:223], v[96:99]
    ds_read_b64_tr_b16 v[198:199], v236 offset:2048
    ds_read_b64_tr_b16 v[200:201], v237 offset:0
    v_mfma_f32_16x16x32_bf16 v[100:103], v[164:167], v[220:223], v[100:103]
    ds_read_b64_tr_b16 v[202:203], v237 offset:2048
    v_mfma_f32_16x16x32_bf16 v[104:107], v[168:171], v[220:223], v[104:107]
    ds_read_b64_tr_b16 v[204:205], v238 offset:0
    v_mfma_f32_16x16x32_bf16 v[108:111], v[172:175], v[220:223], v[108:111]
    ds_read_b64_tr_b16 v[206:207], v238 offset:2048
    v_mfma_f32_16x16x32_bf16 v[112:115], v[176:179], v[220:223], v[112:115]
    v_mfma_f32_16x16x32_bf16 v[116:119], v[180:183], v[220:223], v[116:119]
    v_mfma_f32_16x16x32_bf16 v[120:123], v[184:187], v[220:223], v[120:123]
    v_mfma_f32_16x16x32_bf16 v[124:127], v[188:191], v[220:223], v[124:127]
    s_add_u32 s29, s29, 2
    s_cmp_lt_u32 s29, s3
    s_cbranch_scc1 proj_kernel_F1_0
    s_branch proj_kernel_D1_0
proj_kernel_S1_0:
    s_waitcnt lgkmcnt(0)
    s_cmp_lg_u32 s45, 0
    s_cbranch_scc1 proj_kernel_S1_0_rlx
    s_waitcnt vmcnt(8)
    s_barrier
proj_kernel_S1_0_join:
    v_mfma_f32_16x16x32_bf16 v[0:3], v[128:131], v[192:195], v[0:3]
    s_add_u32 s40, s25, s34
    v_add_u32 v234, s27, v233
    v_mfma_f32_16x16x32_bf16 v[4:7], v[132:135], v[192:195], v[4:7]
    s_cmp_eq_u32 s42, s44
    s_cbranch_scc1 proj_kernel_S1_0_wsw
proj_kernel_S1_0_wswr:
    v_mfma_f32_16x16x32_bf16 v[8:11], v[136:139], v[192:195], v[8:11]
    s_and_b32 s94, s98, 15
    v_mfma_f32_16x16x32_bf16 v[12:15], v[140:143], v[192:195], v[12:15]
    s_lshr_b64 s[98:99], s[98:99], 4
    v_mfma_f32_16x16x32_bf16 v[16:19], v[144:147], v[192:195], v[16:19]
    s_mul_i32 s94, s94, s35
    v_mfma_f32_16x16x32_bf16 v[20:23], v[148:151], v[192:195], v[20:23]
    s_lshl_b32 s26, s94, 1
    v_mfma_f32_16x16x32_bf16 v[24:27], v[152:155], v[192:195], v[24:27]
    s_add_u32 m0, s32, 0
    v_mfma_f32_16x16x32_bf16 v[28:31], v[156:159], v[192:195], v[28:31]
    ds_read_b64_tr_b16 v[208:209], v235 offset:16384
    buffer_load_dwordx4 v226, s[12:15], s26 offen  lds
    v_mfma_f32_16x16x32_bf16 v[32:35], v[128:131], v[196:199], v[32:35]
    s_add_u32 m0, s32, 1024
    v_mfma_f32_16x16x32_bf16 v[36:39], v[132:135], v[196:199], v[36:39]
    ds_read_b64_tr_b16 v[210:211], v235 offset:18432
    v_mfma_f32_16x16x32_bf16 v[40:43], v[136:139], v[196:199], v[40:43]
    buffer_load_dwordx4 v227, s[12:15], s26 offen  lds
    v_mfma_f32_16x16x32_bf16 v[44:47], v[140:143], v[196:199], v[44:47]
    s_add_u32 m0, s28, 16384
    v_mfma_f32_16x16x32_bf16 v[48:51], v[144:147], v[196:199], v[48:51]
    ds_read_b128 v[160:163], v234 offset:0
    v_mfma_f32_16x16x32_bf16 v[52:55], v[148:151], v[196:199], v[52:55]
    buffer_load_dwordx4 v224, s[8:11], s40 offen  lds
    v_mfma_f32_16x16x32_bf16 v[56:59], v[152:155], v[196:199], v[56:59]
    s_add_u32 m0, s28, 17408
    ds_read_b128 v[164:167], v234 offset:2048
    v_mfma_f32_16x16x32_bf16 v[60:63], v[156:159], v[196:199], v[60:63]
    buffer_load_dwordx4 v225, s[8:11], s40 offen  lds
    v_mfma_f32_16x16x32_bf16 v[64:67], v[128:131], v[200:203], v[64:67]
    s_add_u32 s42, s42, 1
    v_mfma_f32_16x16x32_bf16 v[68:71], v[132:135], v[200:203], v[68:71]
    ds_read_b128 v[168:171], v234 offset:4096
    v_mfma_f32_16x16x32_bf16 v[72:75], v[136:139], v[200:203], v[72:75]
    ds_read_b128 v[172:175], v234 offset:6144
    v_mfma_f32_16x16x32_bf16 v[76:79], v[140:143], v[200:203], v[76:79]
    ds_read_b128 v[176:179], v234 offset:8192
    v_mfma_f32_16x16x32_bf16 v[80:83], v[144:147], v[200:203], v[80:83]
    ds_read_b128 v[180:183], v234 offset:10240
    v_mfma_f32_16x16x32_bf16 v[84:87], v[148:151], v[200:203], v[84:87]
    ds_read_b128 v[184:187], v234 offset:12288
    ds_read_b128 v[188:191], v234 offset:14336
    v_mfma_f32_16x16x32_bf16 v[88:91], v[152:155], v[200:203], v[88:91]
    ds_read_b64_tr_b16 v[212:213], v236 offset:16384
    v_mfma_f32_16x16x32_bf16 v[92:95], v[156:159], v[200:203], v[92:95]
    ds_read_b64_tr_b16 v[214:215], v236 offset:18432
    v_mfma_f32_16x16x32_bf16 v[96:99], v[128:131], v[204:207], v[96:99]
    ds_read_b64_tr_b16 v[216:217], v237 offset:16384
    v_mfma_f32_16x16x32_bf16 v[100:103], v[132:135], v[204:207], v[100:103]
    ds_read_b64_tr_b16 v[218:219], v237 offset:18432
    v_mfma_f32_16x16x32_bf16 v[104:107], v[136:139], v[204:207], v[104:107]
    ds_read_b64_tr_b16 v[220:221], v238 offset:16384
    v_mfma_f32_16x16x32_bf16 v[108:111], v[140:143], v[204:207], v[108:111]
    ds_read_b64_tr_b16 v[222:223], v238 offset:18432
    v_mfma_f32_16x16x32_bf16 v[112:115], v[144:147], v[204:207], v[112:115]
    v_mfma_f32_16x16x32_bf16 v[116:119], v[148:151], v[204:207], v[116:119]
    v_mfma_f32_16x16x32_bf16 v[120:123], v[152:155], v[204:207], v[120:123]
    v_mfma_f32_16x16x32_bf16 v[124:127], v[156:159], v[204:207], v[124:127]
proj_kernel_S1_1:
    s_waitcnt lgkmcnt(0)
    s_cmp_lg_u32 s45, 0
    s_cbranch_scc1 proj_kernel_S1_1_rlx
    s_waitcnt vmcnt(8)
    s_barrier
proj_kernel_S1_1_join:
    v_mfma_f32_16x16x32_bf16 v[0:3], v[160:163], v[208:211], v[0:3]
    s_sub_u32 s28, s27, 65536
    s_add_u32 s28, s28, s33
    v_mfma_f32_16x16x32_bf16 v[4:7], v[164:167], v[208:211], v[4:7]
    s_add_u32 s27, s27, 32768
    v_mfma_f32_16x16x32_bf16 v[8:11], v[168:171], v[208:211], v[8:11]
    s_cmp_eq_u32 s27, 163840
    s_cselect_b32 s27, 65536, s27
    v_mfma_f32_16x16x32_bf16 v[12:15], v[172:175], v[208:211], v[12:15]
    s_add_u32 s41, s41, 1
    s_cmp_eq_u32 s41, s43
    s_cbranch_scc1 proj_kernel_S1_1_tsw
proj_kernel_S1_1_tswr:
    v_mfma_f32_16x16x32_bf16 v[16:19], v[176:179], v[208:211], v[16:19]
    s_and_b32 s25, s96, 15
    v_mfma_f32_16x16x32_bf16 v[20:23], v[180:183], v[208:211], v[20:23]
    s_lshr_b64 s[96:97], s[96:97], 4
    v_mfma_f32_16x16x32_bf16 v[24:27], v[184:187], v[208:211], v[24:27]
    s_lshl_b32 s25, s25, 7
    v_add_u32 v234, s27, v232
    v_mfma_f32_16x16x32_bf16 v[28:31], v[188:191], v[208:211], v[28:31]
    s_cmp_eq_u32 s42, s44
    s_cbranch_scc1 proj_kernel_S1_1_wsw
proj_kernel_S1_1_wswr:
    v_mfma_f32_16x16x32_bf16 v[32:35], v[160:163], v[212:215], v[32:35]
    s_add_u32 s26, s26, s35
    v_mfma_f32_16x16x32_bf16 v[36:39], v[164:167], v[212:215], v[36:39]
    s_add_u32 m0, s32, 16384
    ds_read_b64_tr_b16 v[192:193], v235 offset:32768
    v_mfma_f32_16x16x32_bf16 v[40:43], v[168:171], v[212:215], v[40:43]
    buffer_load_dwordx4 v226, s[12:15], s26 offen  lds
    v_mfma_f32_16x16x32_bf16 v[44:47], v[172:175], v[212:215], v[44:47]
    s_add_u32 m0, s32, 17408
    v_mfma_f32_16x16x32_bf16 v[48:51], v[176:179], v[212:215], v[48:51]
    ds_read_b64_tr_b16 v[194:195], v235 offset:34816
    buffer_load_dwordx4 v227, s[12:15], s26 offen  lds
    v_mfma_f32_16x16x32_bf16 v[52:55], v[180:183], v[212:215], v[52:55]
    s_add_u32 m0, s28, 0
    v_mfma_f32_16x16x32_bf16 v[56:59], v[184:187], v[212:215], v[56:59]
    ds_read_b128 v[128:131], v234 offset:0
    v_mfma_f32_16x16x32_bf16 v[60:63], v[188:191], v[212:215], v[60:63]
    buffer_load_dwordx4 v224, s[8:11], s25 offen  lds
    s_add_u32 m0, s28, 1024
    v_mfma_f32_16x16x32_bf16 v[64:67], v[160:163], v[216:219], v[64:67]
    ds_read_b128 v[132:135], v234 offset:2048
    v_mfma_f32_16x16x32_bf16 v[68:71], v[164:167], v[216:219], v[68:71]
    buffer_load_dwordx4 v225, s[8:11], s25 offen  lds
    v_mfma_f32_16x16x32_bf16 v[72:75], v[168:171], v[216:219], v[72:75]
    s_add_u32 s42, s42, 1
    ds_read_b128 v[136:139], v234 offset:4096
    v_mfma_f32_16x16x32_bf16 v[76:79], v[172:175], v[216:219], v[76:79]
    ds_read_b128 v[140:143], v234 offset:6144
    v_mfma_f32_16x16x32_bf16 v[80:83], v[176:179], v[216:219], v[80:83]
    ds_read_b128 v[144:147], v234 offset:8192
    v_mfma_f32_16x16x32_bf16 v[84:87], v[180:183], v[216:219], v[84:87]
    ds_read_b128 v[148:151], v234 offset:10240
    ds_read_b128 v[152:155], v234 offset:12288
    v_mfma_f32_16x16x32_bf16 v[88:91], v[184:187], v[216:219], v[88:91]
    ds_read_b128 v[156:159], v234 offset:14336
    v_mfma_f32_16x16x32_bf16 v[92:95], v[188:191], v[216:219], v[92:95]
    ds_read_b64_tr_b16 v[196:197], v236 offset:32768
    v_mfma_f32_16x16x32_bf16 v[96:99], v[160:163], v[220:223], v[96:99]
    ds_read_b64_tr_b16 v[198:199], v236 offset:34816
    ds_read_b64_tr_b16 v[200:201], v237 offset:32768
    v_mfma_f32_16x16x32_bf16 v[100:103], v[164:167], v[220:223], v[100:103]
    ds_read_b64_tr_b16 v[202:203], v237 offset:34816
    v_mfma_f32_16x16x32_bf16 v[104:107], v[168:171], v[220:223], v[104:107]
    ds_read_b64_tr_b16 v[204:205], v238 offset:32768
    v_mfma_f32_16x16x32_bf16 v[108:111], v[172:175], v[220:223], v[108:111]
    ds_read_b64_tr_b16 v[206:207], v238 offset:34816
    v_mfma_f32_16x16x32_bf16 v[112:115], v[176:179], v[220:223], v[112:115]
    v_mfma_f32_16x16x32_bf16 v[116:119], v[180:183], v[220:223], v[116:119]
    v_mfma_f32_16x16x32_bf16 v[120:123], v[184:187], v[220:223], v[120:123]
    v_mfma_f32_16x16x32_bf16 v[124:127], v[188:191], v[220:223], v[124:127]
    s_add_u32 s29, s29, 2
    s_cmp_ge_u32 s29, s21
    s_cbranch_scc1 proj_kernel_epi1_2
    s_branch proj_kernel_D1_2
proj_kernel_S1_2:
    s_waitcnt lgkmcnt(0)
    s_cmp_lg_u32 s45, 0
    s_cbranch_scc1 proj_kernel_S1_2_rlx
    s_waitcnt vmcnt(8)
    s_barrier
proj_kernel_S1_2_join:
    v_mfma_f32_16x16x32_bf16 v[0:3], v[128:131], v[192:195], v[0:3]
    s_add_u32 s40, s25, s34
    v_add_u32 v234, s27, v233
    v_mfma_f32_16x16x32_bf16 v[4:7], v[132:135], v[192:195], v[4:7]
    s_cmp_eq_u32 s42, s44
    s_cbranch_scc1 proj_kernel_S1_2_wsw
proj_kernel_S1_2_wswr:
    v_mfma_f32_16x16x32_bf16 v[8:11], v[136:139], v[192:195], v[8:11]
    s_and_b32 s94, s98, 15
    v_mfma_f32_16x16x32_bf16 v[12:15], v[140:143], v[192:195], v[12:15]
    s_lshr_b64 s[98:99], s[98:99], 4
    v_mfma_f32_16x16x32_bf16 v[16:19], v[144:147], v[192:195], v[16:19]
    s_mul_i32 s94, s94, s35
    v_mfma_f32_16x16x32_bf16 v[20:23], v[148:151], v[192:195], v[20:23]
    s_lshl_b32 s26, s94, 1
    v_mfma_f32_16x16x32_bf16 v[24:27], v[152:155], v[192:195], v[24:27]
    s_add_u32 m0, s32, 32768
    v_mfma_f32_16x16x32_bf16 v[28:31], v[156:159], v[192:195], v[28:31]
    ds_read_b64_tr_b16 v[208:209], v235 offset:49152
    buffer_load_dwordx4 v226, s[12:15], s26 offen  lds
    v_mfma_f32_16x16x32_bf16 v[32:35], v[128:131], v[196:199], v[32:35]
    s_add_u32 m0, s32, 33792
    v_mfma_f32_16x16x32_bf16 v[36:39], v[132:135], v[196:199], v[36:39]
    ds_read_b64_tr_b16 v[210:211], v235 offset:51200
    v_mfma_f32_16x16x32_bf16 v[40:43], v[136:139], v[196:199], v[40:43]
    buffer_load_dwordx4 v227, s[12:15], s26 offen  lds
    v_mfma_f32_16x16x32_bf16 v[44:47], v[140:143], v[196:199], v[44:47]
    s_add_u32 m0, s28, 16384
    v_mfma_f32_16x16x32_bf16 v[48:51], v[144:147], v[196:199], v[48:51]
    ds_read_b128 v[160:163], v234 offset:0
    v_mfma_f32_16x16x32_bf16 v[52:55], v[148:151], v[196:199], v[52:55]
    buffer_load_dwordx4 v224, s[8:11], s40 offen  lds
    v_mfma_f32_16x16x32_bf16 v[56:59], v[152:155], v[196:199], v[56:59]
    s_add_u32 m0, s28, 17408
    ds_read_b128 v[164:167], v234 offset:2048
    v_mfma_f32_16x16x32_bf16 v[60:63], v[156:159], v[196:199], v[60:63]
    buffer_load_dwordx4 v225, s[8:11], s40 offen  lds
    v_mfma_f32_16x16x32_bf16 v[64:67], v[128:131], v[200:203], v[64:67]
    s_add_u32 s42, s42, 1
    v_mfma_f32_16x16x32_bf16 v[68:71], v[132:135], v[200:203], v[68:71]
    ds_read_b128 v[168:171], v234 offset:4096
    v_mfma_f32_16x16x32_bf16 v[72:75], v[136:139], v[200:203], v[72:75]
    ds_read_b128 v[172:175], v234 offset:6144
    v_mfma_f32_16x16x32_bf16 v[76:79], v[140:143], v[200:203], v[76:79]
    ds_read_b128 v[176:179], v234 offset:8192
    v_mfma_f32_16x16x32_bf16 v[80:83], v[144:147], v[200:203], v[80:83]
    ds_read_b128 v[180:183], v234 offset:10240
    v_mfma_f32_16x16x32_bf16 v[84:87], v[148:151], v[200:203], v[84:87]
    ds_read_b128 v[184:187], v234 offset:12288
    ds_read_b128 v[188:191], v234 offset:14336
    v_mfma_f32_16x16x32_bf16 v[88:91], v[152:155], v[200:203], v[88:91]
    ds_read_b64_tr_b16 v[212:213], v236 offset:49152
    v_mfma_f32_16x16x32_bf16 v[92:95], v[156:159], v[200:203], v[92:95]
    ds_read_b64_tr_b16 v[214:215], v236 offset:51200
    v_mfma_f32_16x16x32_bf16 v[96:99], v[128:131], v[204:207], v[96:99]
    ds_read_b64_tr_b16 v[216:217], v237 offset:49152
    v_mfma_f32_16x16x32_bf16 v[100:103], v[132:135], v[204:207], v[100:103]
    ds_read_b64_tr_b16 v[218:219], v237 offset:51200
    v_mfma_f32_16x16x32_bf16 v[104:107], v[136:139], v[204:207], v[104:107]
    ds_read_b64_tr_b16 v[220:221], v238 offset:49152
    v_mfma_f32_16x16x32_bf16 v[108:111], v[140:143], v[204:207], v[108:111]
    ds_read_b64_tr_b16 v[222:223], v238 offset:51200
    v_mfma_f32_16x16x32_bf16 v[112:115], v[144:147], v[204:207], v[112:115]
    v_mfma_f32_16x16x32_bf16 v[116:119], v[148:151], v[204:207], v[116:119]
    v_mfma_f32_16x16x32_bf16 v[120:123], v[152:155], v[204:207], v[120:123]
    v_mfma_f32_16x16x32_bf16 v[124:127], v[156:159], v[204:207], v[124:127]
proj_kernel_S1_3:
    s_waitcnt lgkmcnt(0)
    s_cmp_lg_u32 s45, 0
    s_cbranch_scc1 proj_kernel_S1_3_rlx
    s_waitcnt vmcnt(8)
    s_barrier
proj_kernel_S1_3_join:
    v_mfma_f32_16x16x32_bf16 v[0:3], v[160:163], v[208:211], v[0:3]
    s_sub_u32 s28, s27, 65536
    s_add_u32 s28, s28, s33
    v_mfma_f32_16x16x32_bf16 v[4:7], v[164:167], v[208:211], v[4:7]
    s_add_u32 s27, s27, 32768
    v_mfma_f32_16x16x32_bf16 v[8:11], v[168:171], v[208:211], v[8:11]
    s_cmp_eq_u32 s27, 163840
    s_cselect_b32 s27, 65536, s27
    v_mfma_f32_16x16x32_bf16 v[12:15], v[172:175], v[208:211], v[12:15]
    s_add_u32 s41, s41, 1
    s_cmp_eq_u32 s41, s43
    s_cbranch_scc1 proj_kernel_S1_3_tsw
proj_kernel_S1_3_tswr:
    v_mfma_f32_16x16x32_bf16 v[16:19], v[176:179], v[208:211], v[16:19]
    s_and_b32 s25, s96, 15
    v_mfma_f32_16x16x32_bf16 v[20:23], v[180:183], v[208:211], v[20:23]
    s_lshr_b64 s[96:97], s[96:97], 4
    v_mfma_f32_16x16x32_bf16 v[24:27], v[184:187], v[208:211], v[24:27]
    s_lshl_b32 s25, s25, 7
    v_add_u32 v234, s27, v232
    v_mfma_f32_16x16x32_bf16 v[28:31], v[188:191], v[208:211], v[28:31]
    s_cmp_eq_u32 s42, s44
    s_cbranch_scc1 proj_kernel_S1_3_wsw
proj_kernel_S1_3_wswr:
    v_mfma_f32_16x16x32_bf16 v[32:35], v[160:163], v[212:215], v[32:35]
    s_add_u32 s26, s26, s35
    v_mfma_f32_16x16x32_bf16 v[36:39], v[164:167], v[212:215], v[36:39]
    s_add_u32 m0, s32, 49152
    ds_read_b64_tr_b16 v[192:193], v235 offset:0
    v_mfma_f32_16x16x32_bf16 v[40:43], v[168:171], v[212:215], v[40:43]
    buffer_load_dwordx4 v226, s[12:15], s26 offen  lds
    v_mfma_f32_16x16x32_bf16 v[44:47], v[172:175], v[212:215], v[44:47]
    s_add_u32 m0, s32, 50176
    v_mfma_f32_16x16x32_bf16 v[48:51], v[176:179], v[212:215], v[48:51]
    ds_read_b64_tr_b16 v[194:195], v235 offset:2048
    buffer_load_dwordx4 v227, s[12:15], s26 offen  lds
    v_mfma_f32_16x16x32_bf16 v[52:55], v[180:183], v[212:215], v[52:55]
    s_add_u32 m0, s28, 0
    v_mfma_f32_16x16x32_bf16 v[56:59], v[184:187], v[212:215], v[56:59]
    ds_read_b128 v[128:131], v234 offset:0
    v_mfma_f32_16x16x32_bf16 v[60:63], v[188:191], v[212:215], v[60:63]
    buffer_load_dwordx4 v224, s[8:11], s25 offen  lds
    s_add_u32 m0, s28, 1024
    v_mfma_f32_16x16x32_bf16 v[64:67], v[160:163], v[216:219], v[64:67]
    ds_read_b128 v[132:135], v234 offset:2048
    v_mfma_f32_16x16x32_bf16 v[68:71], v[164:167], v[216:219], v[68:71]
    buffer_load_dwordx4 v225, s[8:11], s25 offen  lds
    v_mfma_f32_16x16x32_bf16 v[72:75], v[168:171], v[216:219], v[72:75]
    s_add_u32 s42, s42, 1
    ds_read_b128 v[136:139], v234 offset:4096
    v_mfma_f32_16x16x32_bf16 v[76:79], v[172:175], v[216:219], v[76:79]
    ds_read_b128 v[140:143], v234 offset:6144
    v_mfma_f32_16x16x32_bf16 v[80:83], v[176:179], v[216:219], v[80:83]
    ds_read_b128 v[144:147], v234 offset:8192
    v_mfma_f32_16x16x32_bf16 v[84:87], v[180:183], v[216:219], v[84:87]
    ds_read_b128 v[148:151], v234 offset:10240
    ds_read_b128 v[152:155], v234 offset:12288
    v_mfma_f32_16x16x32_bf16 v[88:91], v[184:187], v[216:219], v[88:91]
    ds_read_b128 v[156:159], v234 offset:14336
    v_mfma_f32_16x16x32_bf16 v[92:95], v[188:191], v[216:219], v[92:95]
    ds_read_b64_tr_b16 v[196:197], v236 offset:0
    v_mfma_f32_16x16x32_bf16 v[96:99], v[160:163], v[220:223], v[96:99]
    ds_read_b64_tr_b16 v[198:199], v236 offset:2048
    ds_read_b64_tr_b16 v[200:201], v237 offset:0
    v_mfma_f32_16x16x32_bf16 v[100:103], v[164:167], v[220:223], v[100:103]
    ds_read_b64_tr_b16 v[202:203], v237 offset:2048
    v_mfma_f32_16x16x32_bf16 v[104:107], v[168:171], v[220:223], v[104:107]
    ds_read_b64_tr_b16 v[204:205], v238 offset:0
    v_mfma_f32_16x16x32_bf16 v[108:111], v[172:175], v[220:223], v[108:111]
    ds_read_b64_tr_b16 v[206:207], v238 offset:2048
    v_mfma_f32_16x16x32_bf16 v[112:115], v[176:179], v[220:223], v[112:115]
    v_mfma_f32_16x16x32_bf16 v[116:119], v[180:183], v[220:223], v[116:119]
    v_mfma_f32_16x16x32_bf16 v[120:123], v[184:187], v[220:223], v[120:123]
    v_mfma_f32_16x16x32_bf16 v[124:127], v[188:191], v[220:223], v[124:127]
    s_add_u32 s29, s29, 2
    s_cmp_ge_u32 s29, s21
    s_cbranch_scc1 proj_kernel_epi1_0
    s_branch proj_kernel_D1_0
proj_kernel_D1_0:
    s_cmp_eq_u32 s95, 0
    s_cbranch_scc0 proj_kernel_D1_0_n
    s_cmp_ge_u32 s29, 12
    s_cbranch_scc0 proj_kernel_D1_0_n
    s_mov_b32 s95, 1
    s_sub_u32 s3, s21, 6
    s_cmp_eq_u32 s20, 5
    s_cbranch_scc0 proj_kernel_D1_0_n
proj_kernel_D1_0_n:
    s_cmp_lt_u32 s29, s51
    s_cbranch_scc1 proj_kernel_S1_0
    s_cmp_lt_u32 s29, s3
    s_cbranch_scc1 proj_kernel_F1_0
    s_branch proj_kernel_S1_0
proj_kernel_D1_2:
    s_cmp_eq_u32 s95, 0
    s_cbranch_scc0 proj_kernel_D1_2_n
    s_cmp_ge_u32 s29, 12
    s_cbranch_scc0 proj_kernel_D1_2_n
    s_mov_b32 s95, 1
    s_sub_u32 s3, s21, 6
    s_cmp_eq_u32 s20, 5
    s_cbranch_scc0 proj_kernel_D1_2_n
proj_kernel_D1_2_n:
    s_cmp_lt_u32 s29, s51
    s_cbranch_scc1 proj_kernel_S1_2
    s_cmp_lt_u32 s29, s3
    s_cbranch_scc1 proj_kernel_F1_2
    s_branch proj_kernel_S1_2
proj_kernel_epi1_0:
    s_mov_b32 s39, 0
    s_branch proj_kernel_epi1
proj_kernel_epi1_2:
    s_mov_b32 s39, 2
proj_kernel_epi1:
    s_mov_b32 s29, s39
    s_nop 7
    s_nop 7
    s_and_b32 s36, s20, 1
    s_lshr_b32 s37, s20, 1
    s_lshl_b32 s38, s24, 3
    s_lshl_b32 s36, s36, 2
    s_add_u32 s38, s38, s36
    s_lshl_b32 s38, s38, 14
    v_and_b32 v240, 15, v244
    v_lshrrev_b32 v241, 4, v244
    v_lshrrev_b32 v242, 1, v241
    v_and_b32 v241, 1, v241
    v_lshlrev_b32 v242, 13, v242
    v_lshl_add_u32 v242, v241, 9, v242
    v_lshl_add_u32 v239, v240, 4, v242
    s_lshl_b32 s37, s37, 11
    s_add_u32 s38, s38, s37
    s_cmp_eq_u32 s55, 1
    s_cbranch_scc0 proj_kernel_st1_1
    v_cvt_pk_bf16_f32 v160, v0, v1
    v_cvt_pk_bf16_f32 v161, v2, v3
    v_cvt_pk_bf16_f32 v162, v4, v5
    v_cvt_pk_bf16_f32 v163, v6, v7
    buffer_store_dwordx4 v[160:163], v239, s[16:19], s38 offen offset:0 sc1
    v_cvt_pk_bf16_f32 v164, v32, v33
    v_cvt_pk_bf16_f32 v165, v34, v35
    v_cvt_pk_bf16_f32 v166, v36, v37
    v_cvt_pk_bf16_f32 v167, v38, v39
    buffer_store_dwordx4 v[164:167], v239, s[16:19], s38 offen offset:256 sc1
    v_cvt_pk_bf16_f32 v168, v64, v65
    v_cvt_pk_bf16_f32 v169, v66, v67
    v_cvt_pk_bf16_f32 v170, v68, v69
    v_cvt_pk_bf16_f32 v171, v70, v71
    buffer_store_dwordx4 v[168:171], v239, s[16:19], s38 offen offset:1024 sc1
    v_cvt_pk_bf16_f32 v172, v96, v97
    v_cvt_pk_bf16_f32 v173, v98, v99
    v_cvt_pk_bf16_f32 v174, v100, v101
    v_cvt_pk_bf16_f32 v175, v102, v103
    buffer_store_dwordx4 v[172:175], v239, s[16:19], s38 offen offset:1280 sc1
    s_add_u32 s38, s38, 16384
    v_cvt_pk_bf16_f32 v160, v8, v9
    v_cvt_pk_bf16_f32 v161, v10, v11
    v_cvt_pk_bf16_f32 v162, v12, v13
    v_cvt_pk_bf16_f32 v163, v14, v15
    buffer_store_dwordx4 v[160:163], v239, s[16:19], s38 offen offset:0 sc1
    v_cvt_pk_bf16_f32 v164, v40, v41
    v_cvt_pk_bf16_f32 v165, v42, v43
    v_cvt_pk_bf16_f32 v166, v44, v45
    v_cvt_pk_bf16_f32 v167, v46, v47
    buffer_store_dwordx4 v[164:167], v239, s[16:19], s38 offen offset:256 sc1
    v_cvt_pk_bf16_f32 v168, v72, v73
    v_cvt_pk_bf16_f32 v169, v74, v75
    v_cvt_pk_bf16_f32 v170, v76, v77
    v_cvt_pk_bf16_f32 v171, v78, v79
    buffer_store_dwordx4 v[168:171], v239, s[16:19], s38 offen offset:1024 sc1
    v_cvt_pk_bf16_f32 v172, v104, v105
    v_cvt_pk_bf16_f32 v173, v106, v107
    v_cvt_pk_bf16_f32 v174, v108, v109
    v_cvt_pk_bf16_f32 v175, v110, v111
    buffer_store_dwordx4 v[172:175], v239, s[16:19], s38 offen offset:1280 sc1
    s_add_u32 s38, s38, 16384
    v_cvt_pk_bf16_f32 v160, v16, v17
    v_cvt_pk_bf16_f32 v161, v18, v19
    v_cvt_pk_bf16_f32 v162, v20, v21
    v_cvt_pk_bf16_f32 v163, v22, v23
    buffer_store_dwordx4 v[160:163], v239, s[16:19], s38 offen offset:0 sc1
    v_cvt_pk_bf16_f32 v164, v48, v49
    v_cvt_pk_bf16_f32 v165, v50, v51
    v_cvt_pk_bf16_f32 v166, v52, v53
    v_cvt_pk_bf16_f32 v167, v54, v55
    buffer_store_dwordx4 v[164:167], v239, s[16:19], s38 offen offset:256 sc1
    v_cvt_pk_bf16_f32 v168, v80, v81
    v_cvt_pk_bf16_f32 v169, v82, v83
    v_cvt_pk_bf16_f32 v170, v84, v85
    v_cvt_pk_bf16_f32 v171, v86, v87
    buffer_store_dwordx4 v[168:171], v239, s[16:19], s38 offen offset:1024 sc1
    v_cvt_pk_bf16_f32 v172, v112, v113
    v_cvt_pk_bf16_f32 v173, v114, v115
    v_cvt_pk_bf16_f32 v174, v116, v117
    v_cvt_pk_bf16_f32 v175, v118, v119
    buffer_store_dwordx4 v[172:175], v239, s[16:19], s38 offen offset:1280 sc1
    s_add_u32 s38, s38, 16384
    v_cvt_pk_bf16_f32 v160, v24, v25
    v_cvt_pk_bf16_f32 v161, v26, v27
    v_cvt_pk_bf16_f32 v162, v28, v29
    v_cvt_pk_bf16_f32 v163, v30, v31
    buffer_store_dwordx4 v[160:163], v239, s[16:19], s38 offen offset:0 sc1
    v_cvt_pk_bf16_f32 v164, v56, v57
    v_cvt_pk_bf16_f32 v165, v58, v59
    v_cvt_pk_bf16_f32 v166, v60, v61
    v_cvt_pk_bf16_f32 v167, v62, v63
    buffer_store_dwordx4 v[164:167], v239, s[16:19], s38 offen offset:256 sc1
    v_cvt_pk_bf16_f32 v168, v88, v89
    v_cvt_pk_bf16_f32 v169, v90, v91
    v_cvt_pk_bf16_f32 v170, v92, v93
    v_cvt_pk_bf16_f32 v171, v94, v95
    buffer_store_dwordx4 v[168:171], v239, s[16:19], s38 offen offset:1024 sc1
    v_cvt_pk_bf16_f32 v172, v120, v121
    v_cvt_pk_bf16_f32 v173, v122, v123
    v_cvt_pk_bf16_f32 v174, v124, v125
    v_cvt_pk_bf16_f32 v175, v126, v127
    buffer_store_dwordx4 v[172:175], v239, s[16:19], s38 offen offset:1280 sc1
    s_add_u32 s38, s38, 16384
    s_branch proj_kernel_next
proj_kernel_st1_1:
    v_cvt_pk_bf16_f32 v160, v0, v1
    v_cvt_pk_bf16_f32 v161, v2, v3
    v_cvt_pk_bf16_f32 v162, v4, v5
    v_cvt_pk_bf16_f32 v163, v6, v7
    buffer_store_dwordx4 v[160:163], v239, s[16:19], s38 offen offset:0 sc1
    v_cvt_pk_bf16_f32 v164, v32, v33
    v_cvt_pk_bf16_f32 v165, v34, v35
    v_cvt_pk_bf16_f32 v166, v36, v37
    v_cvt_pk_bf16_f32 v167, v38, v39
    buffer_store_dwordx4 v[164:167], v239, s[16:19], s38 offen offset:256 sc1
    v_cvt_pk_bf16_f32 v168, v64, v65
    v_cvt_pk_bf16_f32 v169, v66, v67
    v_cvt_pk_bf16_f32 v170, v68, v69
    v_cvt_pk_bf16_f32 v171, v70, v71
    buffer_store_dwordx4 v[168:171], v239, s[16:19], s38 offen offset:1024 sc1
    v_cvt_pk_bf16_f32 v172, v96, v97
    v_cvt_pk_bf16_f32 v173, v98, v99
    v_cvt_pk_bf16_f32 v174, v100, v101
    v_cvt_pk_bf16_f32 v175, v102, v103
    buffer_store_dwordx4 v[172:175], v239, s[16:19], s38 offen offset:1280 sc1
    s_add_u32 s38, s38, 16384
    v_cvt_pk_bf16_f32 v160, v8, v9
    v_cvt_pk_bf16_f32 v161, v10, v11
    v_cvt_pk_bf16_f32 v162, v12, v13
    v_cvt_pk_bf16_f32 v163, v14, v15
    buffer_store_dwordx4 v[160:163], v239, s[16:19], s38 offen offset:0 sc1
    v_cvt_pk_bf16_f32 v164, v40, v41
    v_cvt_pk_bf16_f32 v165, v42, v43
    v_cvt_pk_bf16_f32 v166, v44, v45
    v_cvt_pk_bf16_f32 v167, v46, v47
    buffer_store_dwordx4 v[164:167], v239, s[16:19], s38 offen offset:256 sc1
    v_cvt_pk_bf16_f32 v168, v72, v73
    v_cvt_pk_bf16_f32 v169, v74, v75
    v_cvt_pk_bf16_f32 v170, v76, v77
    v_cvt_pk_bf16_f32 v171, v78, v79
    buffer_store_dwordx4 v[168:171], v239, s[16:19], s38 offen offset:1024 sc1
    v_cvt_pk_bf16_f32 v172, v104, v105
    v_cvt_pk_bf16_f32 v173, v106, v107
    v_cvt_pk_bf16_f32 v174, v108, v109
    v_cvt_pk_bf16_f32 v175, v110, v111
    buffer_store_dwordx4 v[172:175], v239, s[16:19], s38 offen offset:1280 sc1
    s_add_u32 s38, s38, 16384
    v_cvt_pk_bf16_f32 v160, v16, v17
    v_cvt_pk_bf16_f32 v161, v18, v19
    v_cvt_pk_bf16_f32 v162, v20, v21
    v_cvt_pk_bf16_f32 v163, v22, v23
    buffer_store_dwordx4 v[160:163], v239, s[16:19], s38 offen offset:0 sc1
    v_cvt_pk_bf16_f32 v164, v48, v49
    v_cvt_pk_bf16_f32 v165, v50, v51
    v_cvt_pk_bf16_f32 v166, v52, v53
    v_cvt_pk_bf16_f32 v167, v54, v55
    buffer_store_dwordx4 v[164:167], v239, s[16:19], s38 offen offset:256 sc1
    v_cvt_pk_bf16_f32 v168, v80, v81
    v_cvt_pk_bf16_f32 v169, v82, v83
    v_cvt_pk_bf16_f32 v170, v84, v85
    v_cvt_pk_bf16_f32 v171, v86, v87
    buffer_store_dwordx4 v[168:171], v239, s[16:19], s38 offen offset:1024 sc1
    v_cvt_pk_bf16_f32 v172, v112, v113
    v_cvt_pk_bf16_f32 v173, v114, v115
    v_cvt_pk_bf16_f32 v174, v116, v117
    v_cvt_pk_bf16_f32 v175, v118, v119
    buffer_store_dwordx4 v[172:175], v239, s[16:19], s38 offen offset:1280 sc1
    s_add_u32 s38, s38, 16384
    v_cvt_pk_bf16_f32 v160, v24, v25
    v_cvt_pk_bf16_f32 v161, v26, v27
    v_cvt_pk_bf16_f32 v162, v28, v29
    v_cvt_pk_bf16_f32 v163, v30, v31
    buffer_store_dwordx4 v[160:163], v239, s[16:19], s38 offen offset:0 sc1
    v_cvt_pk_bf16_f32 v164, v56, v57
    v_cvt_pk_bf16_f32 v165, v58, v59
    v_cvt_pk_bf16_f32 v166, v60, v61
    v_cvt_pk_bf16_f32 v167, v62, v63
    buffer_store_dwordx4 v[164:167], v239, s[16:19], s38 offen offset:256 sc1
    v_cvt_pk_bf16_f32 v168, v88, v89
    v_cvt_pk_bf16_f32 v169, v90, v91
    v_cvt_pk_bf16_f32 v170, v92, v93
    v_cvt_pk_bf16_f32 v171, v94, v95
    buffer_store_dwordx4 v[168:171], v239, s[16:19], s38 offen offset:1024 sc1
    v_cvt_pk_bf16_f32 v172, v120, v121
    v_cvt_pk_bf16_f32 v173, v122, v123
    v_cvt_pk_bf16_f32 v174, v124, v125
    v_cvt_pk_bf16_f32 v175, v126, v127
    buffer_store_dwordx4 v[172:175], v239, s[16:19], s38 offen offset:1280 sc1
    s_add_u32 s38, s38, 16384
    s_branch proj_kernel_next
proj_kernel_next:
    s_cmp_eq_u32 s48, 1
    s_cbranch_scc1 proj_kernel_fin
    s_cmp_eq_u32 s75, 0
    s_cbranch_scc1 proj_kernel_battn
    s_mov_b32 s48, 1
    s_mov_b32 s55, 0
    s_mov_b32 s21, s75
    s_mov_b32 s22, s76
    s_mov_b32 s23, s77
    s_mov_b32 s24, s79
    s_lshl_b32 s36, s78, 20
    s_add_u32 s16, s6, s36
    s_addc_u32 s17, s7, 0
    s_mov_b32 s45, 4
    s_mov_b32 s51, 4
    s_sub_u32 s3, s21, 6
    v_mov_b32 v0, 0
    v_mov_b32 v1, 0
    v_mov_b32 v2, 0
    v_mov_b32 v3, 0
    v_mov_b32 v4, 0
    v_mov_b32 v5, 0
    v_mov_b32 v6, 0
    v_mov_b32 v7, 0
    v_mov_b32 v8, 0
    v_mov_b32 v9, 0
    v_mov_b32 v10, 0
    v_mov_b32 v11, 0
    v_mov_b32 v12, 0
    v_mov_b32 v13, 0
    v_mov_b32 v14, 0
    v_mov_b32 v15, 0
    v_mov_b32 v16, 0
    v_mov_b32 v17, 0
    v_mov_b32 v18, 0
    v_mov_b32 v19, 0
    v_mov_b32 v20, 0
    v_mov_b32 v21, 0
    v_mov_b32 v22, 0
    v_mov_b32 v23, 0
    v_mov_b32 v24, 0
    v_mov_b32 v25, 0
    v_mov_b32 v26, 0
    v_mov_b32 v27, 0
    v_mov_b32 v28, 0
    v_mov_b32 v29, 0
    v_mov_b32 v30, 0
    v_mov_b32 v31, 0
    v_mov_b32 v32, 0
    v_mov_b32 v33, 0
    v_mov_b32 v34, 0
    v_mov_b32 v35, 0
    v_mov_b32 v36, 0
    v_mov_b32 v37, 0
    v_mov_b32 v38, 0
    v_mov_b32 v39, 0
    v_mov_b32 v40, 0
    v_mov_b32 v41, 0
    v_mov_b32 v42, 0
    v_mov_b32 v43, 0
    v_mov_b32 v44, 0
    v_mov_b32 v45, 0
    v_mov_b32 v46, 0
    v_mov_b32 v47, 0
    v_mov_b32 v48, 0
    v_mov_b32 v49, 0
    v_mov_b32 v50, 0
    v_mov_b32 v51, 0
    v_mov_b32 v52, 0
    v_mov_b32 v53, 0
    v_mov_b32 v54, 0
    v_mov_b32 v55, 0
    v_mov_b32 v56, 0
    v_mov_b32 v57, 0
    v_mov_b32 v58, 0
    v_mov_b32 v59, 0
    v_mov_b32 v60, 0
    v_mov_b32 v61, 0
    v_mov_b32 v62, 0
    v_mov_b32 v63, 0
    v_mov_b32 v64, 0
    v_mov_b32 v65, 0
    v_mov_b32 v66, 0
    v_mov_b32 v67, 0
    v_mov_b32 v68, 0
    v_mov_b32 v69, 0
    v_mov_b32 v70, 0
    v_mov_b32 v71, 0
    v_mov_b32 v72, 0
    v_mov_b32 v73, 0
    v_mov_b32 v74, 0
    v_mov_b32 v75, 0
    v_mov_b32 v76, 0
    v_mov_b32 v77, 0
    v_mov_b32 v78, 0
    v_mov_b32 v79, 0
    v_mov_b32 v80, 0
    v_mov_b32 v81, 0
    v_mov_b32 v82, 0
    v_mov_b32 v83, 0
    v_mov_b32 v84, 0
    v_mov_b32 v85, 0
    v_mov_b32 v86, 0
    v_mov_b32 v87, 0
    v_mov_b32 v88, 0
    v_mov_b32 v89, 0
    v_mov_b32 v90, 0
    v_mov_b32 v91, 0
    v_mov_b32 v92, 0
    v_mov_b32 v93, 0
    v_mov_b32 v94, 0
    v_mov_b32 v95, 0
    v_mov_b32 v96, 0
    v_mov_b32 v97, 0
    v_mov_b32 v98, 0
    v_mov_b32 v99, 0
    v_mov_b32 v100, 0
    v_mov_b32 v101, 0
    v_mov_b32 v102, 0
    v_mov_b32 v103, 0
    v_mov_b32 v104, 0
    v_mov_b32 v105, 0
    v_mov_b32 v106, 0
    v_mov_b32 v107, 0
    v_mov_b32 v108, 0
    v_mov_b32 v109, 0
    v_mov_b32 v110, 0
    v_mov_b32 v111, 0
    v_mov_b32 v112, 0
    v_mov_b32 v113, 0
    v_mov_b32 v114, 0
    v_mov_b32 v115, 0
    v_mov_b32 v116, 0
    v_mov_b32 v117, 0
    v_mov_b32 v118, 0
    v_mov_b32 v119, 0
    v_mov_b32 v120, 0
    v_mov_b32 v121, 0
    v_mov_b32 v122, 0
    v_mov_b32 v123, 0
    v_mov_b32 v124, 0
    v_mov_b32 v125, 0
    v_mov_b32 v126, 0
    v_mov_b32 v127, 0
    s_mov_b32 s39, s29
    s_mov_b32 s29, 0
    s_lshl_b32 s36, s22, 2
    s_add_u32 s36, s36, s39
    s_cmp_eq_u32 s36, 0
    s_cbranch_scc1 proj_kernel_S0_0
    s_cmp_eq_u32 s36, 2
    s_cbranch_scc1 proj_kernel_S0_2
    s_cmp_eq_u32 s36, 4
    s_cbranch_scc1 proj_kernel_S1_0
    s_cmp_eq_u32 s36, 6
    s_cbranch_scc1 proj_kernel_S1_2
    s_endpgm
proj_kernel_S0_0_rlx:
    s_sub_u32 s45, s45, 1
    s_cmp_eq_u32 s45, 0
    s_cbranch_scc1 proj_kernel_S0_0_rlx0
    s_waitcnt vmcnt(24)
    s_barrier
    s_branch proj_kernel_S0_0_join
proj_kernel_S0_0_rlx0:
    s_waitcnt vmcnt(8)
    s_barrier
    s_cmp_eq_u32 s54, 1
    s_cbranch_scc0 proj_kernel_S0_0_join
    s_cmp_eq_u32 s20, 0
    s_cbranch_scc0 proj_kernel_S0_0_join
    s_mov_b64 exec, 1
    v_mov_b32 v240, 0
    v_mov_b32 v241, 1
    global_atomic_add v240, v241, s[4:5] sc1
    s_mov_b64 exec, -1
    s_branch proj_kernel_S0_0_join
proj_kernel_S0_0_wsw:
    s_cmp_eq_u32 s47, 1
    s_cbranch_scc1 proj_kernel_S0_0_wsw_off
    s_cmp_eq_u32 s75, 0
    s_cbranch_scc1 proj_kernel_S0_0_wsw_off
    s_mov_b32 s47, 1
    s_mov_b32 s12, s70
    s_mov_b32 s13, s71
    s_mov_b32 s14, s72
    s_lshl_b32 s35, s73, 5
    s_mov_b32 s44, s75
    s_mov_b64 s[98:99], s[52:53]
    s_mov_b32 s42, 0
    v_mov_b32 v226, v230
    v_mov_b32 v227, v231
    s_branch proj_kernel_S0_0_wswr
proj_kernel_S0_0_wsw_off:
    s_mov_b32 s14, 0
    s_mov_b32 s44, -1
    s_branch proj_kernel_S0_0_wswr
proj_kernel_S0_1_rlx:
    s_sub_u32 s45, s45, 1
    s_cmp_eq_u32 s45, 0
    s_cbranch_scc1 proj_kernel_S0_1_rlx0
    s_waitcnt vmcnt(24)
    s_barrier
    s_branch proj_kernel_S0_1_join
proj_kernel_S0_1_rlx0:
    s_waitcnt vmcnt(8)
    s_barrier
    s_cmp_eq_u32 s54, 1
    s_cbranch_scc0 proj_kernel_S0_1_join
    s_cmp_eq_u32 s20, 0
    s_cbranch_scc0 proj_kernel_S0_1_join
    s_mov_b64 exec, 1
    v_mov_b32 v240, 0
    v_mov_b32 v241, 1
    global_atomic_add v240, v241, s[4:5] sc1
    s_mov_b64 exec, -1
    s_branch proj_kernel_S0_1_join
proj_kernel_S0_1_tsw:
    s_cmp_eq_u32 s46, 1
    s_cbranch_scc1 proj_kernel_S0_1_tsw_off
    s_cmp_eq_u32 s75, 0
    s_cbranch_scc1 proj_kernel_S0_1_tsw_off
    s_mov_b32 s46, 1
    s_mov_b32 s8, s66
    s_mov_b32 s9, s67
    s_mov_b32 s10, s68
    s_lshl_b32 s34, s69, 7
    s_lshr_b32 s43, s75, 1
    s_mov_b64 s[96:97], s[52:53]
    s_mov_b32 s41, 0
    v_mov_b32 v224, v228
    v_mov_b32 v225, v229
    s_branch proj_kernel_S0_1_tswr
proj_kernel_S0_1_tsw_off:
    s_mov_b32 s10, 0
    s_mov_b32 s43, -1
    s_branch proj_kernel_S0_1_tswr
proj_kernel_S0_1_wsw:
    s_cmp_eq_u32 s47, 1
    s_cbranch_scc1 proj_kernel_S0_1_wsw_off
    s_cmp_eq_u32 s75, 0
    s_cbranch_scc1 proj_kernel_S0_1_wsw_off
    s_mov_b32 s47, 1
    s_mov_b32 s12, s70
    s_mov_b32 s13, s71
    s_mov_b32 s14, s72
    s_lshl_b32 s35, s73, 5
    s_mov_b32 s44, s75
    s_mov_b64 s[98:99], s[52:53]
    s_mov_b32 s42, 0
    v_mov_b32 v226, v230
    v_mov_b32 v227, v231
    s_branch proj_kernel_S0_1_wswr
proj_kernel_S0_1_wsw_off:
    s_mov_b32 s14, 0
    s_mov_b32 s44, -1
    s_branch proj_kernel_S0_1_wswr
proj_kernel_S0_2_rlx:
    s_sub_u32 s45, s45, 1
    s_cmp_eq_u32 s45, 0
    s_cbranch_scc1 proj_kernel_S0_2_rlx0
    s_waitcnt vmcnt(24)
    s_barrier
    s_branch proj_kernel_S0_2_join
proj_kernel_S0_2_rlx0:
    s_waitcnt vmcnt(8)
    s_barrier
    s_cmp_eq_u32 s54, 1
    s_cbranch_scc0 proj_kernel_S0_2_join
    s_cmp_eq_u32 s20, 0
    s_cbranch_scc0 proj_kernel_S0_2_join
    s_mov_b64 exec, 1
    v_mov_b32 v240, 0
    v_mov_b32 v241, 1
    global_atomic_add v240, v241, s[4:5] sc1
    s_mov_b64 exec, -1
    s_branch proj_kernel_S0_2_join
proj_kernel_S0_2_wsw:
    s_cmp_eq_u32 s47, 1
    s_cbranch_scc1 proj_kernel_S0_2_wsw_off
    s_cmp_eq_u32 s75, 0
    s_cbranch_scc1 proj_kernel_S0_2_wsw_off
    s_mov_b32 s47, 1
    s_mov_b32 s12, s70
    s_mov_b32 s13, s71
    s_mov_b32 s14, s72
    s_lshl_b32 s35, s73, 5
    s_mov_b32 s44, s75
    s_mov_b64 s[98:99], s[52:53]
    s_mov_b32 s42, 0
    v_mov_b32 v226, v230
    v_mov_b32 v227, v231
    s_branch proj_kernel_S0_2_wswr
proj_kernel_S0_2_wsw_off:
    s_mov_b32 s14, 0
    s_mov_b32 s44, -1
    s_branch proj_kernel_S0_2_wswr
proj_kernel_S0_3_rlx:
    s_sub_u32 s45, s45, 1
    s_cmp_eq_u32 s45, 0
    s_cbranch_scc1 proj_kernel_S0_3_rlx0
    s_waitcnt vmcnt(24)
    s_barrier
    s_branch proj_kernel_S0_3_join
proj_kernel_S0_3_rlx0:
    s_waitcnt vmcnt(8)
    s_barrier
    s_cmp_eq_u32 s54, 1
    s_cbranch_scc0 proj_kernel_S0_3_join
    s_cmp_eq_u32 s20, 0
    s_cbranch_scc0 proj_kernel_S0_3_join
    s_mov_b64 exec, 1
    v_mov_b32 v240, 0
    v_mov_b32 v241, 1
    global_atomic_add v240, v241, s[4:5] sc1
    s_mov_b64 exec, -1
    s_branch proj_kernel_S0_3_join
proj_kernel_S0_3_tsw:
    s_cmp_eq_u32 s46, 1
    s_cbranch_scc1 proj_kernel_S0_3_tsw_off
    s_cmp_eq_u32 s75, 0
    s_cbranch_scc1 proj_kernel_S0_3_tsw_off
    s_mov_b32 s46, 1
    s_mov_b32 s8, s66
    s_mov_b32 s9, s67
    s_mov_b32 s10, s68
    s_lshl_b32 s34, s69, 7
    s_lshr_b32 s43, s75, 1
    s_mov_b64 s[96:97], s[52:53]
    s_mov_b32 s41, 0
    v_mov_b32 v224, v228
    v_mov_b32 v225, v229
    s_branch proj_kernel_S0_3_tswr
proj_kernel_S0_3_tsw_off:
    s_mov_b32 s10, 0
    s_mov_b32 s43, -1
    s_branch proj_kernel_S0_3_tswr
proj_kernel_S0_3_wsw:
    s_cmp_eq_u32 s47, 1
    s_cbranch_scc1 proj_kernel_S0_3_wsw_off
    s_cmp_eq_u32 s75, 0
    s_cbranch_scc1 proj_kernel_S0_3_wsw_off
    s_mov_b32 s47, 1
    s_mov_b32 s12, s70
    s_mov_b32 s13, s71
    s_mov_b32 s14, s72
    s_lshl_b32 s35, s73, 5
    s_mov_b32 s44, s75
    s_mov_b64 s[98:99], s[52:53]
    s_mov_b32 s42, 0
    v_mov_b32 v226, v230
    v_mov_b32 v227, v231
    s_branch proj_kernel_S0_3_wswr
proj_kernel_S0_3_wsw_off:
    s_mov_b32 s14, 0
    s_mov_b32 s44, -1
    s_branch proj_kernel_S0_3_wswr
proj_kernel_S1_0_rlx:
    s_sub_u32 s45, s45, 1
    s_cmp_eq_u32 s45, 0
    s_cbranch_scc1 proj_kernel_S1_0_rlx0
    s_waitcnt vmcnt(24)
    s_barrier
    s_branch proj_kernel_S1_0_join
proj_kernel_S1_0_rlx0:
    s_waitcnt vmcnt(8)
    s_barrier
    s_cmp_eq_u32 s54, 1
    s_cbranch_scc0 proj_kernel_S1_0_join
    s_cmp_eq_u32 s20, 0
    s_cbranch_scc0 proj_kernel_S1_0_join
    s_mov_b64 exec, 1
    v_mov_b32 v240, 0
    v_mov_b32 v241, 1
    global_atomic_add v240, v241, s[4:5] sc1
    s_mov_b64 exec, -1
    s_branch proj_kernel_S1_0_join
proj_kernel_S1_0_wsw:
    s_cmp_eq_u32 s47, 1
    s_cbranch_scc1 proj_kernel_S1_0_wsw_off
    s_cmp_eq_u32 s75, 0
    s_cbranch_scc1 proj_kernel_S1_0_wsw_off
    s_mov_b32 s47, 1
    s_mov_b32 s12, s70
    s_mov_b32 s13, s71
    s_mov_b32 s14, s72
    s_lshl_b32 s35, s73, 5
    s_mov_b32 s44, s75
    s_mov_b64 s[98:99], s[52:53]
    s_mov_b32 s42, 0
    v_mov_b32 v226, v230
    v_mov_b32 v227, v231
    s_branch proj_kernel_S1_0_wswr
proj_kernel_S1_0_wsw_off:
    s_mov_b32 s14, 0
    s_mov_b32 s44, -1
    s_branch proj_kernel_S1_0_wswr
proj_kernel_S1_1_rlx:
    s_sub_u32 s45, s45, 1
    s_cmp_eq_u32 s45, 0
    s_cbranch_scc1 proj_kernel_S1_1_rlx0
    s_waitcnt vmcnt(24)
    s_barrier
    s_branch proj_kernel_S1_1_join
proj_kernel_S1_1_rlx0:
    s_waitcnt vmcnt(8)
    s_barrier
    s_cmp_eq_u32 s54, 1
    s_cbranch_scc0 proj_kernel_S1_1_join
    s_cmp_eq_u32 s20, 0
    s_cbranch_scc0 proj_kernel_S1_1_join
    s_mov_b64 exec, 1
    v_mov_b32 v240, 0
    v_mov_b32 v241, 1
    global_atomic_add v240, v241, s[4:5] sc1
    s_mov_b64 exec, -1
    s_branch proj_kernel_S1_1_join
proj_kernel_S1_1_tsw:
    s_cmp_eq_u32 s46, 1
    s_cbranch_scc1 proj_kernel_S1_1_tsw_off
    s_cmp_eq_u32 s75, 0
    s_cbranch_scc1 proj_kernel_S1_1_tsw_off
    s_mov_b32 s46, 1
    s_mov_b32 s8, s66
    s_mov_b32 s9, s67
    s_mov_b32 s10, s68
    s_lshl_b32 s34, s69, 7
    s_lshr_b32 s43, s75, 1
    s_mov_b64 s[96:97], s[52:53]
    s_mov_b32 s41, 0
    v_mov_b32 v224, v228
    v_mov_b32 v225, v229
    s_branch proj_kernel_S1_1_tswr
proj_kernel_S1_1_tsw_off:
    s_mov_b32 s10, 0
    s_mov_b32 s43, -1
    s_branch proj_kernel_S1_1_tswr
proj_kernel_S1_1_wsw:
    s_cmp_eq_u32 s47, 1
    s_cbranch_scc1 proj_kernel_S1_1_wsw_off
    s_cmp_eq_u32 s75, 0
    s_cbranch_scc1 proj_kernel_S1_1_wsw_off
    s_mov_b32 s47, 1
    s_mov_b32 s12, s70
    s_mov_b32 s13, s71
    s_mov_b32 s14, s72
    s_lshl_b32 s35, s73, 5
    s_mov_b32 s44, s75
    s_mov_b64 s[98:99], s[52:53]
    s_mov_b32 s42, 0
    v_mov_b32 v226, v230
    v_mov_b32 v227, v231
    s_branch proj_kernel_S1_1_wswr
proj_kernel_S1_1_wsw_off:
    s_mov_b32 s14, 0
    s_mov_b32 s44, -1
    s_branch proj_kernel_S1_1_wswr
proj_kernel_S1_2_rlx:
    s_sub_u32 s45, s45, 1
    s_cmp_eq_u32 s45, 0
    s_cbranch_scc1 proj_kernel_S1_2_rlx0
    s_waitcnt vmcnt(24)
    s_barrier
    s_branch proj_kernel_S1_2_join
proj_kernel_S1_2_rlx0:
    s_waitcnt vmcnt(8)
    s_barrier
    s_cmp_eq_u32 s54, 1
    s_cbranch_scc0 proj_kernel_S1_2_join
    s_cmp_eq_u32 s20, 0
    s_cbranch_scc0 proj_kernel_S1_2_join
    s_mov_b64 exec, 1
    v_mov_b32 v240, 0
    v_mov_b32 v241, 1
    global_atomic_add v240, v241, s[4:5] sc1
    s_mov_b64 exec, -1
    s_branch proj_kernel_S1_2_join
proj_kernel_S1_2_wsw:
    s_cmp_eq_u32 s47, 1
    s_cbranch_scc1 proj_kernel_S1_2_wsw_off
    s_cmp_eq_u32 s75, 0
    s_cbranch_scc1 proj_kernel_S1_2_wsw_off
    s_mov_b32 s47, 1
    s_mov_b32 s12, s70
    s_mov_b32 s13, s71
    s_mov_b32 s14, s72
    s_lshl_b32 s35, s73, 5
    s_mov_b32 s44, s75
    s_mov_b64 s[98:99], s[52:53]
    s_mov_b32 s42, 0
    v_mov_b32 v226, v230
    v_mov_b32 v227, v231
    s_branch proj_kernel_S1_2_wswr
proj_kernel_S1_2_wsw_off:
    s_mov_b32 s14, 0
    s_mov_b32 s44, -1
    s_branch proj_kernel_S1_2_wswr
proj_kernel_S1_3_rlx:
    s_sub_u32 s45, s45, 1
    s_cmp_eq_u32 s45, 0
    s_cbranch_scc1 proj_kernel_S1_3_rlx0
    s_waitcnt vmcnt(24)
    s_barrier
    s_branch proj_kernel_S1_3_join
proj_kernel_S1_3_rlx0:
    s_waitcnt vmcnt(8)
    s_barrier
    s_cmp_eq_u32 s54, 1
    s_cbranch_scc0 proj_kernel_S1_3_join
    s_cmp_eq_u32 s20, 0
    s_cbranch_scc0 proj_kernel_S1_3_join
    s_mov_b64 exec, 1
    v_mov_b32 v240, 0
    v_mov_b32 v241, 1
    global_atomic_add v240, v241, s[4:5] sc1
    s_mov_b64 exec, -1
    s_branch proj_kernel_S1_3_join
proj_kernel_S1_3_tsw:
    s_cmp_eq_u32 s46, 1
    s_cbranch_scc1 proj_kernel_S1_3_tsw_off
    s_cmp_eq_u32 s75, 0
    s_cbranch_scc1 proj_kernel_S1_3_tsw_off
    s_mov_b32 s46, 1
    s_mov_b32 s8, s66
    s_mov_b32 s9, s67
    s_mov_b32 s10, s68
    s_lshl_b32 s34, s69, 7
    s_lshr_b32 s43, s75, 1
    s_mov_b64 s[96:97], s[52:53]
    s_mov_b32 s41, 0
    v_mov_b32 v224, v228
    v_mov_b32 v225, v229
    s_branch proj_kernel_S1_3_tswr
proj_kernel_S1_3_tsw_off:
    s_mov_b32 s10, 0
    s_mov_b32 s43, -1
    s_branch proj_kernel_S1_3_tswr
proj_kernel_S1_3_wsw:
    s_cmp_eq_u32 s47, 1
    s_cbranch_scc1 proj_kernel_S1_3_wsw_off
    s_cmp_eq_u32 s75, 0
    s_cbranch_scc1 proj_kernel_S1_3_wsw_off
    s_mov_b32 s47, 1
    s_mov_b32 s12, s70
    s_mov_b32 s13, s71
    s_mov_b32 s14, s72
    s_lshl_b32 s35, s73, 5
    s_mov_b32 s44, s75
    s_mov_b64 s[98:99], s[52:53]
    s_mov_b32 s42, 0
    v_mov_b32 v226, v230
    v_mov_b32 v227, v231
    s_branch proj_kernel_S1_3_wswr
proj_kernel_S1_3_wsw_off:
    s_mov_b32 s14, 0
    s_mov_b32 s44, -1
    s_branch proj_kernel_S1_3_wswr
proj_kernel_battn:
    s_waitcnt vmcnt(0) lgkmcnt(0)
    v_lshlrev_b32 v200, 4, v244
    v_mov_b32 v202, 0xff800000
    s_sub_u32 s21, s49, 22
    s_lshl_b32 s21, s21, 3
    s_add_u32 s21, s21, s50
    s_cmp_eq_u32 s20, 0
    s_cbranch_scc0 proj_kernel_bw_done
proj_kernel_bw_spin:
    v_mov_b32 v203, 0
    global_load_dword v204, v203, s[4:5] sc1
    s_waitcnt vmcnt(0)
    v_readfirstlane_b32 s36, v204
    s_nop 3
    s_cmp_ge_u32 s36, 48
    s_cbranch_scc0 proj_kernel_bw_spin
proj_kernel_bw_done:
proj_kernel_btask:
    s_barrier
    s_and_b32 s22, s21, 15
    s_lshr_b32 s24, s21, 4
    s_lshl_b32 s23, s24, 3
    s_add_u32 s23, s23, s20
    s_lshr_b32 s36, s22, 3
    s_lshl_b32 s36, s36, 20
    s_add_u32 s37, s36, 50331648
    s_add_u32 s8, s6, s37
    s_addc_u32 s9, s7, 0
    s_mov_b32 s10, 1048576
    s_mov_b32 s11, 0x20000
    s_add_u32 s37, s36, 52428800
    s_add_u32 s12, s6, s37
    s_addc_u32 s13, s7, 0
    s_mov_b32 s14, 1048576
    s_mov_b32 s15, 0x20000
    s_add_u32 s37, s36, 54525952
    s_add_u32 s16, s6, s37
    s_addc_u32 s17, s7, 0
    s_mov_b32 s18, 1048576
    s_mov_b32 s19, 0x20000
    s_add_u32 s52, s6, 75497472
    s_addc_u32 s53, s7, 0
    s_mov_b32 s54, 2097152
    s_mov_b32 s55, 0x20000
    s_and_b32 s38, s22, 7
    s_lshl_b32 s36, s20, 1
    s_add_u32 s36, s36, 0
    s_lshl_b32 s37, s24, 3
    s_add_u32 s37, s37, s36
    s_sub_i32 s37, s37, 8
    s_max_i32 s37, s37, 0
    s_lshl_b32 s37, s37, 14
    s_lshl_b32 s36, s36, 11
    s_mov_b32 m0, s36
    s_lshl_b32 s25, s38, 11
    s_add_u32 s25, s25, s37
    buffer_load_dwordx4 v200, s[12:15], s25 offen sc1 lds
    buffer_load_dwordx4 v200, s[12:15], s25 offen offset:1024 sc1 lds
    s_add_u32 m0, s36, 32768
    s_lshl_b32 s25, s38, 10
    s_add_u32 s25, s25, s37
    buffer_load_dwordx4 v200, s[16:19], s25 offen sc1 lds
    s_add_u32 m0, s36, 33792
    s_add_u32 s25, s25, 8192
    buffer_load_dwordx4 v200, s[16:19], s25 offen sc1 lds
    s_lshl_b32 s36, s20, 1
    s_add_u32 s36, s36, 1
    s_lshl_b32 s37, s24, 3
    s_add_u32 s37, s37, s36
    s_sub_i32 s37, s37, 8
    s_max_i32 s37, s37, 0
    s_lshl_b32 s37, s37, 14
    s_lshl_b32 s36, s36, 11
    s_mov_b32 m0, s36
    s_lshl_b32 s25, s38, 11
    s_add_u32 s25, s25, s37
    buffer_load_dwordx4 v200, s[12:15], s25 offen sc1 lds
    buffer_load_dwordx4 v200, s[12:15], s25 offen offset:1024 sc1 lds
    s_add_u32 m0, s36, 32768
    s_lshl_b32 s25, s38, 10
    s_add_u32 s25, s25, s37
    buffer_load_dwordx4 v200, s[16:19], s25 offen sc1 lds
    s_add_u32 m0, s36, 33792
    s_add_u32 s25, s25, 8192
    buffer_load_dwordx4 v200, s[16:19], s25 offen sc1 lds
    s_lshl_b32 s36, s23, 14
    s_lshl_b32 s37, s38, 11
    s_add_u32 s36, s36, s37
    buffer_load_dwordx4 v[144:147], v200, s[8:11], s36 offen sc1
    buffer_load_dwordx4 v[148:151], v200, s[8:11], s36 offen offset:1024 sc1
    s_lshl_b32 s36, s20, 11
    v_add_u32 v201, s36, v200
    v_and_b32 v203, 31, v244
    v_lshrrev_b32 v204, 5, v244
    v_lshlrev_b32 v205, 2, v204
    v_sub_u32 v203, v203, v205
    s_waitcnt vmcnt(0)
    s_barrier
    v_cmp_eq_u32 vcc, 0, v204
    ds_read_b128 v[152:155], v201 offset:0
    ds_read_b128 v[156:159], v201 offset:1024
    ds_read_b128 v[160:163], v201 offset:2048
    ds_read_b128 v[164:167], v201 offset:3072
    ds_read_b128 v[168:171], v201 offset:4096
    ds_read_b128 v[172:175], v201 offset:5120
    ds_read_b128 v[176:179], v201 offset:6144
    ds_read_b128 v[180:183], v201 offset:7168
    v_cndmask_b32 v150, 0, v150, vcc
    v_cndmask_b32 v151, 0, v151, vcc
    s_waitcnt lgkmcnt(7)
    v_mfma_f32_32x32x16_bf16 v[0:15], v[152:155], v[144:147], 0
    ds_read_b128 v[152:155], v201 offset:8192
    s_waitcnt lgkmcnt(7)
    v_mfma_f32_32x32x16_bf16 v[0:15], v[156:159], v[148:151], v[0:15]
    ds_read_b128 v[156:159], v201 offset:9216
    s_waitcnt lgkmcnt(7)
    v_mfma_f32_32x32x16_bf16 v[16:31], v[160:163], v[144:147], 0
    ds_read_b128 v[160:163], v201 offset:10240
    s_waitcnt lgkmcnt(7)
    v_mfma_f32_32x32x16_bf16 v[16:31], v[164:167], v[148:151], v[16:31]
    ds_read_b128 v[164:167], v201 offset:11264
    s_waitcnt lgkmcnt(7)
    v_mfma_f32_32x32x16_bf16 v[32:47], v[168:171], v[144:147], 0
    ds_read_b128 v[168:171], v201 offset:12288
    s_waitcnt lgkmcnt(7)
    v_mfma_f32_32x32x16_bf16 v[32:47], v[172:175], v[148:151], v[32:47]
    ds_read_b128 v[172:175], v201 offset:13312
    s_waitcnt lgkmcnt(7)
    v_mfma_f32_32x32x16_bf16 v[48:63], v[176:179], v[144:147], 0
    ds_read_b128 v[176:179], v201 offset:14336
    s_waitcnt lgkmcnt(7)
    v_mfma_f32_32x32x16_bf16 v[48:63], v[180:183], v[148:151], v[48:63]
    ds_read_b128 v[180:183], v201 offset:15360
    s_waitcnt lgkmcnt(7)
    v_mfma_f32_32x32x16_bf16 v[64:79], v[152:155], v[144:147], 0
    ds_read_b128 v[152:155], v201 offset:16384
    s_waitcnt lgkmcnt(7)
    v_mfma_f32_32x32x16_bf16 v[64:79], v[156:159], v[148:151], v[64:79]
    ds_read_b128 v[156:159], v201 offset:17408
    s_waitcnt lgkmcnt(7)
    v_mfma_f32_32x32x16_bf16 v[80:95], v[160:163], v[144:147], 0
    s_waitcnt lgkmcnt(6)
    v_mfma_f32_32x32x16_bf16 v[80:95], v[164:167], v[148:151], v[80:95]
    s_waitcnt lgkmcnt(5)
    v_mfma_f32_32x32x16_bf16 v[96:111], v[168:171], v[144:147], 0
    s_waitcnt lgkmcnt(4)
    v_mfma_f32_32x32x16_bf16 v[96:111], v[172:175], v[148:151], v[96:111]
    s_waitcnt lgkmcnt(3)
    v_mfma_f32_32x32x16_bf16 v[112:127], v[176:179], v[144:147], 0
    s_waitcnt lgkmcnt(2)
    v_mfma_f32_32x32x16_bf16 v[112:127], v[180:183], v[148:151], v[112:127]
    s_waitcnt lgkmcnt(1)
    v_mfma_f32_32x32x16_bf16 v[128:143], v[152:155], v[144:147], 0
    s_waitcnt lgkmcnt(0)
    v_mfma_f32_32x32x16_bf16 v[128:143], v[156:159], v[148:151], v[128:143]
    ds_read_b128 v[152:155], v201 offset:32768
    ds_read_b128 v[156:159], v201 offset:33792
    ds_read_b128 v[160:163], v201 offset:34816
    ds_read_b128 v[164:167], v201 offset:35840
    ds_read_b128 v[168:171], v201 offset:36864
    ds_read_b128 v[172:175], v201 offset:37888
    ds_read_b128 v[176:179], v201 offset:38912
    ds_read_b128 v[180:183], v201 offset:39936
    s_nop 7
    s_nop 3
    v_cmp_lt_i32 s[40:41], v203, 0
    v_cmp_lt_i32 s[42:43], v203, 1
    v_cmp_lt_i32 s[44:45], v203, 2
    v_cmp_lt_i32 s[46:47], v203, 3
    v_cndmask_b32 v0, v202, v0, s[40:41]
    v_cmp_lt_i32 s[40:41], v203, 8
    v_cndmask_b32 v1, v202, v1, s[42:43]
    v_cmp_lt_i32 s[42:43], v203, 9
    v_cndmask_b32 v2, v202, v2, s[44:45]
    v_cmp_lt_i32 s[44:45], v203, 10
    v_cndmask_b32 v3, v202, v3, s[46:47]
    v_cmp_lt_i32 s[46:47], v203, 11
    v_cndmask_b32 v4, v202, v4, s[40:41]
    v_cmp_lt_i32 s[40:41], v203, 16
    v_cndmask_b32 v5, v202, v5, s[42:43]
    v_cmp_lt_i32 s[42:43], v203, 17
    v_cndmask_b32 v6, v202, v6, s[44:45]
    v_cmp_lt_i32 s[44:45], v203, 18
    v_cndmask_b32 v7, v202, v7, s[46:47]
    v_cmp_lt_i32 s[46:47], v203, 19
    v_cndmask_b32 v8, v202, v8, s[40:41]
    v_cmp_lt_i32 s[40:41], v203, 24
    v_cndmask_b32 v9, v202, v9, s[42:43]
    v_cmp_lt_i32 s[42:43], v203, 25
    v_cndmask_b32 v10, v202, v10, s[44:45]
    v_cmp_lt_i32 s[44:45], v203, 26
    v_cndmask_b32 v11, v202, v11, s[46:47]
    v_cmp_lt_i32 s[46:47], v203, 27
    v_cndmask_b32 v12, v202, v12, s[40:41]
    s_nop 1
    v_cndmask_b32 v13, v202, v13, s[42:43]
    v_cndmask_b32 v14, v202, v14, s[44:45]
    v_cndmask_b32 v15, v202, v15, s[46:47]
    v_cmp_ge_i32 s[40:41], v203, 0
    v_cmp_ge_i32 s[42:43], v203, 1
    v_cmp_ge_i32 s[44:45], v203, 2
    v_cmp_ge_i32 s[46:47], v203, 3
    v_cndmask_b32 v128, v202, v128, s[40:41]
    v_cmp_ge_i32 s[40:41], v203, 8
    v_cndmask_b32 v129, v202, v129, s[42:43]
    v_cmp_ge_i32 s[42:43], v203, 9
    v_cndmask_b32 v130, v202, v130, s[44:45]
    v_cmp_ge_i32 s[44:45], v203, 10
    v_cndmask_b32 v131, v202, v131, s[46:47]
    v_cmp_ge_i32 s[46:47], v203, 11
    v_cndmask_b32 v132, v202, v132, s[40:41]
    v_cmp_ge_i32 s[40:41], v203, 16
    v_cndmask_b32 v133, v202, v133, s[42:43]
    v_cmp_ge_i32 s[42:43], v203, 17
    v_cndmask_b32 v134, v202, v134, s[44:45]
    v_cmp_ge_i32 s[44:45], v203, 18
    v_cndmask_b32 v135, v202, v135, s[46:47]
    v_cmp_ge_i32 s[46:47], v203, 19
    v_cndmask_b32 v136, v202, v136, s[40:41]
    v_cmp_ge_i32 s[40:41], v203, 24
    v_cndmask_b32 v137, v202, v137, s[42:43]
    v_cmp_ge_i32 s[42:43], v203, 25
    v_cndmask_b32 v138, v202, v138, s[44:45]
    v_cmp_ge_i32 s[44:45], v203, 26
    v_cndmask_b32 v139, v202, v139, s[46:47]
    v_cmp_ge_i32 s[46:47], v203, 27
    v_cndmask_b32 v140, v202, v140, s[40:41]
    s_nop 1
    v_cndmask_b32 v141, v202, v141, s[42:43]
    v_cndmask_b32 v142, v202, v142, s[44:45]
    v_cndmask_b32 v143, v202, v143, s[46:47]
    s_cmp_ge_u32 s23, 8
    s_cbranch_scc1 proj_kernel_bvalid
    s_cmp_ge_u32 s23, 8
    s_cbranch_scc1 proj_kernel_bv_3
    v_mov_b32 v0, v202
    v_mov_b32 v1, v202
    v_mov_b32 v2, v202
    v_mov_b32 v3, v202
    v_mov_b32 v4, v202
    v_mov_b32 v5, v202
    v_mov_b32 v6, v202
    v_mov_b32 v7, v202
    v_mov_b32 v8, v202
    v_mov_b32 v9, v202
    v_mov_b32 v10, v202
    v_mov_b32 v11, v202
    v_mov_b32 v12, v202
    v_mov_b32 v13, v202
    v_mov_b32 v14, v202
    v_mov_b32 v15, v202
proj_kernel_bv_3:
    s_cmp_ge_u32 s23, 7
    s_cbranch_scc1 proj_kernel_bv_4
    v_mov_b32 v16, v202
    v_mov_b32 v17, v202
    v_mov_b32 v18, v202
    v_mov_b32 v19, v202
    v_mov_b32 v20, v202
    v_mov_b32 v21, v202
    v_mov_b32 v22, v202
    v_mov_b32 v23, v202
    v_mov_b32 v24, v202
    v_mov_b32 v25, v202
    v_mov_b32 v26, v202
    v_mov_b32 v27, v202
    v_mov_b32 v28, v202
    v_mov_b32 v29, v202
    v_mov_b32 v30, v202
    v_mov_b32 v31, v202
proj_kernel_bv_4:
    s_cmp_ge_u32 s23, 6
    s_cbranch_scc1 proj_kernel_bv_5
    v_mov_b32 v32, v202
    v_mov_b32 v33, v202
    v_mov_b32 v34, v202
    v_mov_b32 v35, v202
    v_mov_b32 v36, v202
    v_mov_b32 v37, v202
    v_mov_b32 v38, v202
    v_mov_b32 v39, v202
    v_mov_b32 v40, v202
    v_mov_b32 v41, v202
    v_mov_b32 v42, v202
    v_mov_b32 v43, v202
    v_mov_b32 v44, v202
    v_mov_b32 v45, v202
    v_mov_b32 v46, v202
    v_mov_b32 v47, v202
proj_kernel_bv_5:
    s_cmp_ge_u32 s23, 5
    s_cbranch_scc1 proj_kernel_bv_6
    v_mov_b32 v48, v202
    v_mov_b32 v49, v202
    v_mov_b32 v50, v202
    v_mov_b32 v51, v202
    v_mov_b32 v52, v202
    v_mov_b32 v53, v202
    v_mov_b32 v54, v202
    v_mov_b32 v55, v202
    v_mov_b32 v56, v202
    v_mov_b32 v57, v202
    v_mov_b32 v58, v202
    v_mov_b32 v59, v202
    v_mov_b32 v60, v202
    v_mov_b32 v61, v202
    v_mov_b32 v62, v202
    v_mov_b32 v63, v202
proj_kernel_bv_6:
    s_cmp_ge_u32 s23, 4
    s_cbranch_scc1 proj_kernel_bv_7
    v_mov_b32 v64, v202
    v_mov_b32 v65, v202
    v_mov_b32 v66, v202
    v_mov_b32 v67, v202
    v_mov_b32 v68, v202
    v_mov_b32 v69, v202
    v_mov_b32 v70, v202
    v_mov_b32 v71, v202
    v_mov_b32 v72, v202
    v_mov_b32 v73, v202
    v_mov_b32 v74, v202
    v_mov_b32 v75, v202
    v_mov_b32 v76, v202
    v_mov_b32 v77, v202
    v_mov_b32 v78, v202
    v_mov_b32 v79, v202
proj_kernel_bv_7:
    s_cmp_ge_u32 s23, 3
    s_cbranch_scc1 proj_kernel_bv_8
    v_mov_b32 v80, v202
    v_mov_b32 v81, v202
    v_mov_b32 v82, v202
    v_mov_b32 v83, v202
    v_mov_b32 v84, v202
    v_mov_b32 v85, v202
    v_mov_b32 v86, v202
    v_mov_b32 v87, v202
    v_mov_b32 v88, v202
    v_mov_b32 v89, v202
    v_mov_b32 v90, v202
    v_mov_b32 v91, v202
    v_mov_b32 v92, v202
    v_mov_b32 v93, v202
    v_mov_b32 v94, v202
    v_mov_b32 v95, v202
proj_kernel_bv_8:
    s_cmp_ge_u32 s23, 2
    s_cbranch_scc1 proj_kernel_bv_9
    v_mov_b32 v96, v202
    v_mov_b32 v97, v202
    v_mov_b32 v98, v202
    v_mov_b32 v99, v202
    v_mov_b32 v100, v202
    v_mov_b32 v101, v202
    v_mov_b32 v102, v202
    v_mov_b32 v103, v202
    v_mov_b32 v104, v202
    v_mov_b32 v105, v202
    v_mov_b32 v106, v202
    v_mov_b32 v107, v202
    v_mov_b32 v108, v202
    v_mov_b32 v109, v202
    v_mov_b32 v110, v202
    v_mov_b32 v111, v202
proj_kernel_bv_9:
    s_cmp_ge_u32 s23, 1
    s_cbranch_scc1 proj_kernel_bv_10
    v_mov_b32 v112, v202
    v_mov_b32 v113, v202
    v_mov_b32 v114, v202
    v_mov_b32 v115, v202
    v_mov_b32 v116, v202
    v_mov_b32 v117, v202
    v_mov_b32 v118, v202
    v_mov_b32 v119, v202
    v_mov_b32 v120, v202
    v_mov_b32 v121, v202
    v_mov_b32 v122, v202
    v_mov_b32 v123, v202
    v_mov_b32 v124, v202
    v_mov_b32 v125, v202
    v_mov_b32 v126, v202
    v_mov_b32 v127, v202
proj_kernel_bv_10:
proj_kernel_bvalid:
    v_max3_f32 v206, v0, v1, v2
    v_max3_f32 v204, v3, v4, v5
    v_max3_f32 v205, v6, v7, v8
    v_max3_f32 v207, v9, v10, v11
    v_max3_f32 v206, v206, v12, v13
    v_max3_f32 v204, v204, v14, v15
    v_max3_f32 v205, v205, v16, v17
    v_max3_f32 v207, v207, v18, v19
    v_max3_f32 v206, v206, v20, v21
    v_max3_f32 v204, v204, v22, v23
    v_max3_f32 v205, v205, v24, v25
    v_max3_f32 v207, v207, v26, v27
    v_max3_f32 v206, v206, v28, v29
    v_max3_f32 v204, v204, v30, v31
    v_max3_f32 v205, v205, v32, v33
    v_max3_f32 v207, v207, v34, v35
    v_max3_f32 v206, v206, v36, v37
    v_max3_f32 v204, v204, v38, v39
    v_max3_f32 v205, v205, v40, v41
    v_max3_f32 v207, v207, v42, v43
    v_max3_f32 v206, v206, v44, v45
    v_max3_f32 v204, v204, v46, v47
    v_max3_f32 v205, v205, v48, v49
    v_max3_f32 v207, v207, v50, v51
    v_max3_f32 v206, v206, v52, v53
    v_max3_f32 v204, v204, v54, v55
    v_max3_f32 v205, v205, v56, v57
    v_max3_f32 v207, v207, v58, v59
    v_max3_f32 v206, v206, v60, v61
    v_max3_f32 v204, v204, v62, v63
    v_max3_f32 v205, v205, v64, v65
    v_max3_f32 v207, v207, v66, v67
    v_max3_f32 v206, v206, v68, v69
    v_max3_f32 v204, v204, v70, v71
    v_max3_f32 v205, v205, v72, v73
    v_max3_f32 v207, v207, v74, v75
    v_max3_f32 v206, v206, v76, v77
    v_max3_f32 v204, v204, v78, v79
    v_max3_f32 v205, v205, v80, v81
    v_max3_f32 v207, v207, v82, v83
    v_max3_f32 v206, v206, v84, v85
    v_max3_f32 v204, v204, v86, v87
    v_max3_f32 v205, v205, v88, v89
    v_max3_f32 v207, v207, v90, v91
    v_max3_f32 v206, v206, v92, v93
    v_max3_f32 v204, v204, v94, v95
    v_max3_f32 v205, v205, v96, v97
    v_max3_f32 v207, v207, v98, v99
    v_max3_f32 v206, v206, v100, v101
    v_max3_f32 v204, v204, v102, v103
    v_max3_f32 v205, v205, v104, v105
    v_max3_f32 v207, v207, v106, v107
    v_max3_f32 v206, v206, v108, v109
    v_max3_f32 v204, v204, v110, v111
    v_max3_f32 v205, v205, v112, v113
    v_max3_f32 v207, v207, v114, v115
    v_max3_f32 v206, v206, v116, v117
    v_max3_f32 v204, v204, v118, v119
    v_max3_f32 v205, v205, v120, v121
    v_max3_f32 v207, v207, v122, v123
    v_max3_f32 v206, v206, v124, v125
    v_max3_f32 v204, v204, v126, v127
    v_max3_f32 v205, v205, v128, v129
    v_max3_f32 v207, v207, v130, v131
    v_max3_f32 v206, v206, v132, v133
    v_max3_f32 v204, v204, v134, v135
    v_max3_f32 v205, v205, v136, v137
    v_max3_f32 v207, v207, v138, v139
    v_max3_f32 v206, v206, v140, v141
    v_max3_f32 v204, v204, v142, v143
    v_max3_f32 v206, v206, v204, v205
    v_max_f32 v206, v206, v207
    v_mov_b32 v204, v206
    s_nop 1
    v_permlane32_swap_b32 v206, v204
    s_nop 1
    v_max_f32 v206, v206, v204
    v_mov_b32 v207, 0
    v_mov_b32 v204, 0
    v_mov_b32 v205, 0
    v_mov_b32 v203, 0
    v_sub_f32 v0, v0, v206
    v_sub_f32 v1, v1, v206
    v_sub_f32 v2, v2, v206
    v_sub_f32 v3, v3, v206
    v_exp_f32 v0, v0
    v_exp_f32 v1, v1
    v_exp_f32 v2, v2
    v_exp_f32 v3, v3
    v_sub_f32 v4, v4, v206
    v_sub_f32 v5, v5, v206
    v_sub_f32 v6, v6, v206
    v_sub_f32 v7, v7, v206
    v_exp_f32 v4, v4
    v_exp_f32 v5, v5
    v_exp_f32 v6, v6
    v_exp_f32 v7, v7
    v_add_f32 v207, v207, v0
    v_add_f32 v204, v204, v1
    v_add_f32 v205, v205, v2
    v_add_f32 v203, v203, v3
    v_cvt_pk_bf16_f32 v0, v0, v1
    v_cvt_pk_bf16_f32 v1, v2, v3
    v_sub_f32 v8, v8, v206
    v_sub_f32 v9, v9, v206
    v_sub_f32 v10, v10, v206
    v_sub_f32 v11, v11, v206
    v_exp_f32 v8, v8
    v_exp_f32 v9, v9
    v_exp_f32 v10, v10
    v_exp_f32 v11, v11
    v_add_f32 v207, v207, v4
    v_add_f32 v204, v204, v5
    v_add_f32 v205, v205, v6
    v_add_f32 v203, v203, v7
    v_cvt_pk_bf16_f32 v2, v4, v5
    v_cvt_pk_bf16_f32 v3, v6, v7
    v_sub_f32 v12, v12, v206
    v_sub_f32 v13, v13, v206
    v_sub_f32 v14, v14, v206
    v_sub_f32 v15, v15, v206
    v_exp_f32 v12, v12
    v_exp_f32 v13, v13
    v_exp_f32 v14, v14
    v_exp_f32 v15, v15
    v_add_f32 v207, v207, v8
    v_add_f32 v204, v204, v9
    v_add_f32 v205, v205, v10
    v_add_f32 v203, v203, v11
    v_cvt_pk_bf16_f32 v4, v8, v9
    v_cvt_pk_bf16_f32 v5, v10, v11
    v_sub_f32 v16, v16, v206
    v_sub_f32 v17, v17, v206
    v_sub_f32 v18, v18, v206
    v_sub_f32 v19, v19, v206
    v_exp_f32 v16, v16
    v_exp_f32 v17, v17
    v_exp_f32 v18, v18
    v_exp_f32 v19, v19
    v_add_f32 v207, v207, v12
    v_add_f32 v204, v204, v13
    v_add_f32 v205, v205, v14
    v_add_f32 v203, v203, v15
    v_cvt_pk_bf16_f32 v6, v12, v13
    v_cvt_pk_bf16_f32 v7, v14, v15
    v_sub_f32 v20, v20, v206
    v_sub_f32 v21, v21, v206
    v_sub_f32 v22, v22, v206
    v_sub_f32 v23, v23, v206
    v_exp_f32 v20, v20
    v_exp_f32 v21, v21
    v_exp_f32 v22, v22
    v_exp_f32 v23, v23
    v_add_f32 v207, v207, v16
    v_add_f32 v204, v204, v17
    v_add_f32 v205, v205, v18
    v_add_f32 v203, v203, v19
    v_cvt_pk_bf16_f32 v8, v16, v17
    v_cvt_pk_bf16_f32 v9, v18, v19
    v_sub_f32 v24, v24, v206
    v_sub_f32 v25, v25, v206
    v_sub_f32 v26, v26, v206
    v_sub_f32 v27, v27, v206
    v_exp_f32 v24, v24
    v_exp_f32 v25, v25
    v_exp_f32 v26, v26
    v_exp_f32 v27, v27
    v_add_f32 v207, v207, v20
    v_add_f32 v204, v204, v21
    v_add_f32 v205, v205, v22
    v_add_f32 v203, v203, v23
    v_cvt_pk_bf16_f32 v10, v20, v21
    v_cvt_pk_bf16_f32 v11, v22, v23
    v_sub_f32 v28, v28, v206
    v_sub_f32 v29, v29, v206
    v_sub_f32 v30, v30, v206
    v_sub_f32 v31, v31, v206
    v_exp_f32 v28, v28
    v_exp_f32 v29, v29
    v_exp_f32 v30, v30
    v_exp_f32 v31, v31
    v_add_f32 v207, v207, v24
    v_add_f32 v204, v204, v25
    v_add_f32 v205, v205, v26
    v_add_f32 v203, v203, v27
    v_cvt_pk_bf16_f32 v12, v24, v25
    v_cvt_pk_bf16_f32 v13, v26, v27
    v_sub_f32 v32, v32, v206
    v_sub_f32 v33, v33, v206
    v_sub_f32 v34, v34, v206
    v_sub_f32 v35, v35, v206
    v_exp_f32 v32, v32
    v_exp_f32 v33, v33
    v_exp_f32 v34, v34
    v_exp_f32 v35, v35
    v_add_f32 v207, v207, v28
    v_add_f32 v204, v204, v29
    v_add_f32 v205, v205, v30
    v_add_f32 v203, v203, v31
    v_cvt_pk_bf16_f32 v14, v28, v29
    v_cvt_pk_bf16_f32 v15, v30, v31
    v_sub_f32 v36, v36, v206
    v_sub_f32 v37, v37, v206
    v_sub_f32 v38, v38, v206
    v_sub_f32 v39, v39, v206
    v_exp_f32 v36, v36
    v_exp_f32 v37, v37
    v_exp_f32 v38, v38
    v_exp_f32 v39, v39
    v_add_f32 v207, v207, v32
    v_add_f32 v204, v204, v33
    v_add_f32 v205, v205, v34
    v_add_f32 v203, v203, v35
    v_cvt_pk_bf16_f32 v16, v32, v33
    v_cvt_pk_bf16_f32 v17, v34, v35
    v_sub_f32 v40, v40, v206
    v_sub_f32 v41, v41, v206
    v_sub_f32 v42, v42, v206
    v_sub_f32 v43, v43, v206
    v_exp_f32 v40, v40
    v_exp_f32 v41, v41
    v_exp_f32 v42, v42
    v_exp_f32 v43, v43
    v_add_f32 v207, v207, v36
    v_add_f32 v204, v204, v37
    v_add_f32 v205, v205, v38
    v_add_f32 v203, v203, v39
    v_cvt_pk_bf16_f32 v18, v36, v37
    v_cvt_pk_bf16_f32 v19, v38, v39
    v_sub_f32 v44, v44, v206
    v_sub_f32 v45, v45, v206
    v_sub_f32 v46, v46, v206
    v_sub_f32 v47, v47, v206
    v_exp_f32 v44, v44
    v_exp_f32 v45, v45
    v_exp_f32 v46, v46
    v_exp_f32 v47, v47
    v_add_f32 v207, v207, v40
    v_add_f32 v204, v204, v41
    v_add_f32 v205, v205, v42
    v_add_f32 v203, v203, v43
    v_cvt_pk_bf16_f32 v20, v40, v41
    v_cvt_pk_bf16_f32 v21, v42, v43
    v_sub_f32 v48, v48, v206
    v_sub_f32 v49, v49, v206
    v_sub_f32 v50, v50, v206
    v_sub_f32 v51, v51, v206
    v_exp_f32 v48, v48
    v_exp_f32 v49, v49
    v_exp_f32 v50, v50
    v_exp_f32 v51, v51
    v_add_f32 v207, v207, v44
    v_add_f32 v204, v204, v45
    v_add_f32 v205, v205, v46
    v_add_f32 v203, v203, v47
    v_cvt_pk_bf16_f32 v22, v44, v45
    v_cvt_pk_bf16_f32 v23, v46, v47
    v_sub_f32 v52, v52, v206
    v_sub_f32 v53, v53, v206
    v_sub_f32 v54, v54, v206
    v_sub_f32 v55, v55, v206
    v_exp_f32 v52, v52
    v_exp_f32 v53, v53
    v_exp_f32 v54, v54
    v_exp_f32 v55, v55
    v_add_f32 v207, v207, v48
    v_add_f32 v204, v204, v49
    v_add_f32 v205, v205, v50
    v_add_f32 v203, v203, v51
    v_cvt_pk_bf16_f32 v24, v48, v49
    v_cvt_pk_bf16_f32 v25, v50, v51
    v_sub_f32 v56, v56, v206
    v_sub_f32 v57, v57, v206
    v_sub_f32 v58, v58, v206
    v_sub_f32 v59, v59, v206
    v_exp_f32 v56, v56
    v_exp_f32 v57, v57
    v_exp_f32 v58, v58
    v_exp_f32 v59, v59
    v_add_f32 v207, v207, v52
    v_add_f32 v204, v204, v53
    v_add_f32 v205, v205, v54
    v_add_f32 v203, v203, v55
    v_cvt_pk_bf16_f32 v26, v52, v53
    v_cvt_pk_bf16_f32 v27, v54, v55
    v_sub_f32 v60, v60, v206
    v_sub_f32 v61, v61, v206
    v_sub_f32 v62, v62, v206
    v_sub_f32 v63, v63, v206
    v_exp_f32 v60, v60
    v_exp_f32 v61, v61
    v_exp_f32 v62, v62
    v_exp_f32 v63, v63
    v_add_f32 v207, v207, v56
    v_add_f32 v204, v204, v57
    v_add_f32 v205, v205, v58
    v_add_f32 v203, v203, v59
    v_cvt_pk_bf16_f32 v28, v56, v57
    v_cvt_pk_bf16_f32 v29, v58, v59
    v_sub_f32 v64, v64, v206
    v_sub_f32 v65, v65, v206
    v_sub_f32 v66, v66, v206
    v_sub_f32 v67, v67, v206
    v_exp_f32 v64, v64
    v_exp_f32 v65, v65
    v_exp_f32 v66, v66
    v_exp_f32 v67, v67
    v_add_f32 v207, v207, v60
    v_add_f32 v204, v204, v61
    v_add_f32 v205, v205, v62
    v_add_f32 v203, v203, v63
    v_cvt_pk_bf16_f32 v30, v60, v61
    v_cvt_pk_bf16_f32 v31, v62, v63
    v_sub_f32 v68, v68, v206
    v_sub_f32 v69, v69, v206
    v_sub_f32 v70, v70, v206
    v_sub_f32 v71, v71, v206
    v_exp_f32 v68, v68
    v_exp_f32 v69, v69
    v_exp_f32 v70, v70
    v_exp_f32 v71, v71
    v_add_f32 v207, v207, v64
    v_add_f32 v204, v204, v65
    v_add_f32 v205, v205, v66
    v_add_f32 v203, v203, v67
    v_cvt_pk_bf16_f32 v32, v64, v65
    v_cvt_pk_bf16_f32 v33, v66, v67
    v_sub_f32 v72, v72, v206
    v_sub_f32 v73, v73, v206
    v_sub_f32 v74, v74, v206
    v_sub_f32 v75, v75, v206
    v_exp_f32 v72, v72
    v_exp_f32 v73, v73
    v_exp_f32 v74, v74
    v_exp_f32 v75, v75
    v_add_f32 v207, v207, v68
    v_add_f32 v204, v204, v69
    v_add_f32 v205, v205, v70
    v_add_f32 v203, v203, v71
    v_cvt_pk_bf16_f32 v34, v68, v69
    v_cvt_pk_bf16_f32 v35, v70, v71
    v_sub_f32 v76, v76, v206
    v_sub_f32 v77, v77, v206
    v_sub_f32 v78, v78, v206
    v_sub_f32 v79, v79, v206
    v_exp_f32 v76, v76
    v_exp_f32 v77, v77
    v_exp_f32 v78, v78
    v_exp_f32 v79, v79
    v_add_f32 v207, v207, v72
    v_add_f32 v204, v204, v73
    v_add_f32 v205, v205, v74
    v_add_f32 v203, v203, v75
    v_cvt_pk_bf16_f32 v36, v72, v73
    v_cvt_pk_bf16_f32 v37, v74, v75
    v_sub_f32 v80, v80, v206
    v_sub_f32 v81, v81, v206
    v_sub_f32 v82, v82, v206
    v_sub_f32 v83, v83, v206
    v_exp_f32 v80, v80
    v_exp_f32 v81, v81
    v_exp_f32 v82, v82
    v_exp_f32 v83, v83
    v_add_f32 v207, v207, v76
    v_add_f32 v204, v204, v77
    v_add_f32 v205, v205, v78
    v_add_f32 v203, v203, v79
    v_cvt_pk_bf16_f32 v38, v76, v77
    v_cvt_pk_bf16_f32 v39, v78, v79
    v_sub_f32 v84, v84, v206
    v_sub_f32 v85, v85, v206
    v_sub_f32 v86, v86, v206
    v_sub_f32 v87, v87, v206
    v_exp_f32 v84, v84
    v_exp_f32 v85, v85
    v_exp_f32 v86, v86
    v_exp_f32 v87, v87
    v_add_f32 v207, v207, v80
    v_add_f32 v204, v204, v81
    v_add_f32 v205, v205, v82
    v_add_f32 v203, v203, v83
    v_cvt_pk_bf16_f32 v40, v80, v81
    v_cvt_pk_bf16_f32 v41, v82, v83
    v_sub_f32 v88, v88, v206
    v_sub_f32 v89, v89, v206
    v_sub_f32 v90, v90, v206
    v_sub_f32 v91, v91, v206
    v_exp_f32 v88, v88
    v_exp_f32 v89, v89
    v_exp_f32 v90, v90
    v_exp_f32 v91, v91
    v_add_f32 v207, v207, v84
    v_add_f32 v204, v204, v85
    v_add_f32 v205, v205, v86
    v_add_f32 v203, v203, v87
    v_cvt_pk_bf16_f32 v42, v84, v85
    v_cvt_pk_bf16_f32 v43, v86, v87
    v_sub_f32 v92, v92, v206
    v_sub_f32 v93, v93, v206
    v_sub_f32 v94, v94, v206
    v_sub_f32 v95, v95, v206
    v_exp_f32 v92, v92
    v_exp_f32 v93, v93
    v_exp_f32 v94, v94
    v_exp_f32 v95, v95
    v_add_f32 v207, v207, v88
    v_add_f32 v204, v204, v89
    v_add_f32 v205, v205, v90
    v_add_f32 v203, v203, v91
    v_cvt_pk_bf16_f32 v44, v88, v89
    v_cvt_pk_bf16_f32 v45, v90, v91
    v_sub_f32 v96, v96, v206
    v_sub_f32 v97, v97, v206
    v_sub_f32 v98, v98, v206
    v_sub_f32 v99, v99, v206
    v_exp_f32 v96, v96
    v_exp_f32 v97, v97
    v_exp_f32 v98, v98
    v_exp_f32 v99, v99
    v_add_f32 v207, v207, v92
    v_add_f32 v204, v204, v93
    v_add_f32 v205, v205, v94
    v_add_f32 v203, v203, v95
    v_cvt_pk_bf16_f32 v46, v92, v93
    v_cvt_pk_bf16_f32 v47, v94, v95
    v_sub_f32 v100, v100, v206
    v_sub_f32 v101, v101, v206
    v_sub_f32 v102, v102, v206
    v_sub_f32 v103, v103, v206
    v_exp_f32 v100, v100
    v_exp_f32 v101, v101
    v_exp_f32 v102, v102
    v_exp_f32 v103, v103
    v_add_f32 v207, v207, v96
    v_add_f32 v204, v204, v97
    v_add_f32 v205, v205, v98
    v_add_f32 v203, v203, v99
    v_cvt_pk_bf16_f32 v48, v96, v97
    v_cvt_pk_bf16_f32 v49, v98, v99
    v_sub_f32 v104, v104, v206
    v_sub_f32 v105, v105, v206
    v_sub_f32 v106, v106, v206
    v_sub_f32 v107, v107, v206
    v_exp_f32 v104, v104
    v_exp_f32 v105, v105
    v_exp_f32 v106, v106
    v_exp_f32 v107, v107
    v_add_f32 v207, v207, v100
    v_add_f32 v204, v204, v101
    v_add_f32 v205, v205, v102
    v_add_f32 v203, v203, v103
    v_cvt_pk_bf16_f32 v50, v100, v101
    v_cvt_pk_bf16_f32 v51, v102, v103
    v_sub_f32 v108, v108, v206
    v_sub_f32 v109, v109, v206
    v_sub_f32 v110, v110, v206
    v_sub_f32 v111, v111, v206
    v_exp_f32 v108, v108
    v_exp_f32 v109, v109
    v_exp_f32 v110, v110
    v_exp_f32 v111, v111
    v_add_f32 v207, v207, v104
    v_add_f32 v204, v204, v105
    v_add_f32 v205, v205, v106
    v_add_f32 v203, v203, v107
    v_cvt_pk_bf16_f32 v52, v104, v105
    v_cvt_pk_bf16_f32 v53, v106, v107
    v_sub_f32 v112, v112, v206
    v_sub_f32 v113, v113, v206
    v_sub_f32 v114, v114, v206
    v_sub_f32 v115, v115, v206
    v_exp_f32 v112, v112
    v_exp_f32 v113, v113
    v_exp_f32 v114, v114
    v_exp_f32 v115, v115
    v_add_f32 v207, v207, v108
    v_add_f32 v204, v204, v109
    v_add_f32 v205, v205, v110
    v_add_f32 v203, v203, v111
    v_cvt_pk_bf16_f32 v54, v108, v109
    v_cvt_pk_bf16_f32 v55, v110, v111
    v_sub_f32 v116, v116, v206
    v_sub_f32 v117, v117, v206
    v_sub_f32 v118, v118, v206
    v_sub_f32 v119, v119, v206
    v_exp_f32 v116, v116
    v_exp_f32 v117, v117
    v_exp_f32 v118, v118
    v_exp_f32 v119, v119
    v_add_f32 v207, v207, v112
    v_add_f32 v204, v204, v113
    v_add_f32 v205, v205, v114
    v_add_f32 v203, v203, v115
    v_cvt_pk_bf16_f32 v56, v112, v113
    v_cvt_pk_bf16_f32 v57, v114, v115
    v_sub_f32 v120, v120, v206
    v_sub_f32 v121, v121, v206
    v_sub_f32 v122, v122, v206
    v_sub_f32 v123, v123, v206
    v_exp_f32 v120, v120
    v_exp_f32 v121, v121
    v_exp_f32 v122, v122
    v_exp_f32 v123, v123
    v_add_f32 v207, v207, v116
    v_add_f32 v204, v204, v117
    v_add_f32 v205, v205, v118
    v_add_f32 v203, v203, v119
    v_cvt_pk_bf16_f32 v58, v116, v117
    v_cvt_pk_bf16_f32 v59, v118, v119
    v_sub_f32 v124, v124, v206
    v_sub_f32 v125, v125, v206
    v_sub_f32 v126, v126, v206
    v_sub_f32 v127, v127, v206
    v_exp_f32 v124, v124
    v_exp_f32 v125, v125
    v_exp_f32 v126, v126
    v_exp_f32 v127, v127
    v_add_f32 v207, v207, v120
    v_add_f32 v204, v204, v121
    v_add_f32 v205, v205, v122
    v_add_f32 v203, v203, v123
    v_cvt_pk_bf16_f32 v60, v120, v121
    v_cvt_pk_bf16_f32 v61, v122, v123
    v_sub_f32 v128, v128, v206
    v_sub_f32 v129, v129, v206
    v_sub_f32 v130, v130, v206
    v_sub_f32 v131, v131, v206
    v_exp_f32 v128, v128
    v_exp_f32 v129, v129
    v_exp_f32 v130, v130
    v_exp_f32 v131, v131
    v_add_f32 v207, v207, v124
    v_add_f32 v204, v204, v125
    v_add_f32 v205, v205, v126
    v_add_f32 v203, v203, v127
    v_cvt_pk_bf16_f32 v62, v124, v125
    v_cvt_pk_bf16_f32 v63, v126, v127
    v_sub_f32 v132, v132, v206
    v_sub_f32 v133, v133, v206
    v_sub_f32 v134, v134, v206
    v_sub_f32 v135, v135, v206
    v_exp_f32 v132, v132
    v_exp_f32 v133, v133
    v_exp_f32 v134, v134
    v_exp_f32 v135, v135
    v_add_f32 v207, v207, v128
    v_add_f32 v204, v204, v129
    v_add_f32 v205, v205, v130
    v_add_f32 v203, v203, v131
    v_cvt_pk_bf16_f32 v64, v128, v129
    v_cvt_pk_bf16_f32 v65, v130, v131
    v_sub_f32 v136, v136, v206
    v_sub_f32 v137, v137, v206
    v_sub_f32 v138, v138, v206
    v_sub_f32 v139, v139, v206
    v_exp_f32 v136, v136
    v_exp_f32 v137, v137
    v_exp_f32 v138, v138
    v_exp_f32 v139, v139
    v_add_f32 v207, v207, v132
    v_add_f32 v204, v204, v133
    v_add_f32 v205, v205, v134
    v_add_f32 v203, v203, v135
    v_cvt_pk_bf16_f32 v66, v132, v133
    v_cvt_pk_bf16_f32 v67, v134, v135
    v_sub_f32 v140, v140, v206
    v_sub_f32 v141, v141, v206
    v_sub_f32 v142, v142, v206
    v_sub_f32 v143, v143, v206
    v_exp_f32 v140, v140
    v_exp_f32 v141, v141
    v_exp_f32 v142, v142
    v_exp_f32 v143, v143
    v_add_f32 v207, v207, v136
    v_add_f32 v204, v204, v137
    v_add_f32 v205, v205, v138
    v_add_f32 v203, v203, v139
    v_cvt_pk_bf16_f32 v68, v136, v137
    v_cvt_pk_bf16_f32 v69, v138, v139
    s_nop 0
    v_add_f32 v207, v207, v140
    v_add_f32 v204, v204, v141
    v_add_f32 v205, v205, v142
    v_add_f32 v203, v203, v143
    v_cvt_pk_bf16_f32 v70, v140, v141
    v_cvt_pk_bf16_f32 v71, v142, v143
    v_add_f32 v207, v207, v204
    v_add_f32 v205, v205, v203
    v_add_f32 v207, v207, v205
    v_mov_b32 v204, v207
    s_nop 1
    v_permlane32_swap_b32 v207, v204
    s_nop 1
    v_add_f32 v207, v207, v204
    s_waitcnt lgkmcnt(7)
    v_mfma_f32_32x32x16_bf16 v[184:199], v[152:155], v[0:3], 0
    ds_read_b128 v[152:155], v201 offset:40960
    s_waitcnt lgkmcnt(7)
    v_mfma_f32_32x32x16_bf16 v[184:199], v[156:159], v[4:7], v[184:199]
    ds_read_b128 v[156:159], v201 offset:41984
    s_waitcnt lgkmcnt(7)
    v_mfma_f32_32x32x16_bf16 v[184:199], v[160:163], v[8:11], v[184:199]
    ds_read_b128 v[160:163], v201 offset:43008
    s_waitcnt lgkmcnt(7)
    v_mfma_f32_32x32x16_bf16 v[184:199], v[164:167], v[12:15], v[184:199]
    ds_read_b128 v[164:167], v201 offset:44032
    s_waitcnt lgkmcnt(7)
    v_mfma_f32_32x32x16_bf16 v[184:199], v[168:171], v[16:19], v[184:199]
    ds_read_b128 v[168:171], v201 offset:45056
    s_waitcnt lgkmcnt(7)
    v_mfma_f32_32x32x16_bf16 v[184:199], v[172:175], v[20:23], v[184:199]
    ds_read_b128 v[172:175], v201 offset:46080
    s_waitcnt lgkmcnt(7)
    v_mfma_f32_32x32x16_bf16 v[184:199], v[176:179], v[24:27], v[184:199]
    ds_read_b128 v[176:179], v201 offset:47104
    s_waitcnt lgkmcnt(7)
    v_mfma_f32_32x32x16_bf16 v[184:199], v[180:183], v[28:31], v[184:199]
    ds_read_b128 v[180:183], v201 offset:48128
    s_waitcnt lgkmcnt(7)
    v_mfma_f32_32x32x16_bf16 v[184:199], v[152:155], v[32:35], v[184:199]
    ds_read_b128 v[152:155], v201 offset:49152
    s_waitcnt lgkmcnt(7)
    v_mfma_f32_32x32x16_bf16 v[184:199], v[156:159], v[36:39], v[184:199]
    ds_read_b128 v[156:159], v201 offset:50176
    s_waitcnt lgkmcnt(7)
    v_mfma_f32_32x32x16_bf16 v[184:199], v[160:163], v[40:43], v[184:199]
    s_waitcnt lgkmcnt(6)
    v_mfma_f32_32x32x16_bf16 v[184:199], v[164:167], v[44:47], v[184:199]
    s_waitcnt lgkmcnt(5)
    v_mfma_f32_32x32x16_bf16 v[184:199], v[168:171], v[48:51], v[184:199]
    s_waitcnt lgkmcnt(4)
    v_mfma_f32_32x32x16_bf16 v[184:199], v[172:175], v[52:55], v[184:199]
    s_waitcnt lgkmcnt(3)
    v_mfma_f32_32x32x16_bf16 v[184:199], v[176:179], v[56:59], v[184:199]
    s_waitcnt lgkmcnt(2)
    v_mfma_f32_32x32x16_bf16 v[184:199], v[180:183], v[60:63], v[184:199]
    s_waitcnt lgkmcnt(1)
    v_mfma_f32_32x32x16_bf16 v[184:199], v[152:155], v[64:67], v[184:199]
    s_waitcnt lgkmcnt(0)
    v_mfma_f32_32x32x16_bf16 v[184:199], v[156:159], v[68:71], v[184:199]
    v_rcp_f32 v207, v207
    s_nop 7
    s_nop 7
    v_mul_f32 v184, v184, v207
    v_mul_f32 v185, v185, v207
    v_mul_f32 v186, v186, v207
    v_mul_f32 v187, v187, v207
    v_mul_f32 v188, v188, v207
    v_mul_f32 v189, v189, v207
    v_mul_f32 v190, v190, v207
    v_mul_f32 v191, v191, v207
    v_mul_f32 v192, v192, v207
    v_mul_f32 v193, v193, v207
    v_mul_f32 v194, v194, v207
    v_mul_f32 v195, v195, v207
    v_mul_f32 v196, v196, v207
    v_mul_f32 v197, v197, v207
    v_mul_f32 v198, v198, v207
    v_mul_f32 v199, v199, v207
    v_lshrrev_b32 v204, 5, v244
    v_cmp_eq_u32 vcc, 0, v204
    s_nop 1
    v_cndmask_b32 v196, 0, v196, vcc
    v_cndmask_b32 v197, 0, v197, vcc
    v_cndmask_b32 v198, 0, v198, vcc
    v_cndmask_b32 v199, 0, v199, vcc
    v_cvt_pk_bf16_f32 v152, v184, v185
    v_cvt_pk_bf16_f32 v153, v186, v187
    v_cvt_pk_bf16_f32 v154, v188, v189
    v_cvt_pk_bf16_f32 v155, v190, v191
    v_cvt_pk_bf16_f32 v156, v192, v193
    v_cvt_pk_bf16_f32 v157, v194, v195
    v_cvt_pk_bf16_f32 v158, v196, v197
    v_cvt_pk_bf16_f32 v159, v198, v199
    s_lshl_b32 s36, s23, 15
    s_lshl_b32 s37, s22, 11
    s_add_u32 s36, s36, s37
    buffer_store_dwordx4 v[152:155], v200, s[52:55], s36 offen sc1
    buffer_store_dwordx4 v[156:159], v200, s[52:55], s36 offen offset:1024 sc1
    s_add_u32 s21, s21, 80
    s_cmp_lt_u32 s21, 128
    s_cbranch_scc1 proj_kernel_btask
proj_kernel_fin:
    s_cmp_lt_u32 s49, 28
    s_cbranch_scc1 proj_kernel_nowarm
    s_sub_u32 s51, s49, 28
    s_lshl_b32 s51, s51, 3
    s_add_u32 s51, s51, s20
    s_getpc_b64 s[36:37]
proj_kernel_c2_pc:
    s_add_u32 s36, s36, attn_kernel-proj_kernel_c2_pc
    s_addc_u32 s37, s37, (attn_kernel-proj_kernel_c2_pc)>>32
    s_lshl_b32 s38, s51, 12
    s_cmp_ge_u32 s38, attn_kernel_end-attn_kernel
    s_cbranch_scc1 proj_kernel_c2_skip
    v_lshl_add_u32 v250, v244, 6, s38
    v_min_u32 v250, attn_kernel_end-attn_kernel-4, v250
    v_mov_b32 v249, s37
    v_add_co_u32 v248, vcc, s36, v250
    s_nop 1
    v_addc_co_u32 v249, vcc, 0, v249, vcc
    global_load_dword v251, v[248:249], off
proj_kernel_c2_skip:
    s_load_dwordx2 s[8:9], s[0:1], 40
    s_load_dwordx2 s[12:13], s[0:1], 64
    s_lshl_b32 s36, s51, 3
    s_add_u32 s36, s36, s50
    v_lshlrev_b32 v240, 6, v244
    s_waitcnt lgkmcnt(0)
    s_mov_b32 s10, 3670016
    s_mov_b32 s11, 0x20000
    s_mov_b32 s14, 401408
    s_mov_b32 s15, 0x20000
    s_lshl_b32 s37, s36, 14
    buffer_load_dword v241, v240, s[8:11], s37 offen
    s_add_u32 s37, s37, 4096
    buffer_load_dword v241, v240, s[8:11], s37 offen
    s_add_u32 s37, s37, 4096
    buffer_load_dword v241, v240, s[8:11], s37 offen
    s_add_u32 s37, s37, 4096
    buffer_load_dword v241, v240, s[8:11], s37 offen
    s_add_u32 s37, s37, 4096
    s_lshl_b32 s37, s36, 12
    buffer_load_dword v241, v240, s[12:15], s37 offen
proj_kernel_nowarm:
    s_cmp_lt_u32 s49, 28
    s_cbranch_scc0 proj_kernel_no2nd
    s_cmp_eq_u32 s20, 6
    s_cbranch_scc0 proj_kernel_no2nd
    s_getpc_b64 s[36:37]
proj_kernel_c3_pc:
    s_add_u32 s36, s36, attn_kernel-proj_kernel_c3_pc
    s_addc_u32 s37, s37, (attn_kernel-proj_kernel_c3_pc)>>32
    s_lshl_b32 s38, s49, 12
    s_cmp_ge_u32 s38, attn_kernel_end-attn_kernel
    s_cbranch_scc1 proj_kernel_c3_skip
    v_lshl_add_u32 v250, v244, 6, s38
    v_min_u32 v250, attn_kernel_end-attn_kernel-4, v250
    v_mov_b32 v249, s37
    v_add_co_u32 v248, vcc, s36, v250
    s_nop 1
    v_addc_co_u32 v249, vcc, 0, v249, vcc
    global_load_dword v251, v[248:249], off
proj_kernel_c3_skip:
proj_kernel_no2nd:
proj_kernel_end:
    s_endpgm
.text
.globl attn_kernel
.p2align 8
.type attn_kernel,@function
attn_kernel:
    s_cmp_ge_u32 s2, 256
    s_cbranch_scc1 attn_kernel_end
    s_load_dwordx4 s[60:63], s[0:1], 80
    v_and_b32 v251, 63, v0
    v_lshrrev_b32 v246, 6, v0
    v_lshlrev_b32 v224, 4, v251
    v_readfirstlane_b32 s28, v246
    v_mov_b32 v245, 0xff800000
    s_mov_b32 s51, 1199570944
    s_and_b32 s41, s2, 7
    s_lshr_b32 s42, s2, 3
    s_and_b32 s43, s42, 1
    s_lshl_b32 s29, s41, 1
    s_add_u32 s29, s29, s43
    s_lshr_b32 s42, s42, 1
    s_lshr_b32 s50, s42, 1
    s_and_b32 s47, s42, 1
    s_lshl_b32 s48, s29, 3
    s_add_u32 s48, s48, s50
    s_lshl_b32 s40, s28, 13
    s_add_u32 s7, s40, 65536
    s_lshl_b32 s41, s48, 2
    s_add_u32 s41, s41, s28
    s_lshr_b32 s78, s41, 5
    s_lshl_b32 s78, s78, 2
    s_and_b32 s41, s41, 31
    s_lshl_b32 s79, 1, s41
    s_sub_u32 s30, 15, s50
    s_lshl_b32 s33, s30, 1
    s_add_u32 s41, s33, 2
    s_cmp_lt_u32 s50, 8
    s_cselect_b32 s42, 18, 17
    s_cmp_eq_u32 s47, 0
    s_cselect_b32 s31, 0, s42
    s_cselect_b32 s32, s42, s41
    s_mov_b32 s75, s31
    s_sub_u32 s74, s32, s31
    s_lshl_b32 s42, s50, 1
    s_add_u32 s42, s42, 2
    s_cmp_eq_u32 s47, 0
    s_cselect_b32 s42, 0, s42
    s_add_u32 s73, s74, s42
    s_cmp_eq_u32 s50, 7
    s_cbranch_scc0 attn_kernel_s18d
    s_cmp_eq_u32 s47, 0
    s_mov_b32 s47, 2
    s_cbranch_scc1 attn_kernel_s18d
    s_mov_b32 s30, 7
    s_mov_b32 s33, 14
    s_mov_b32 s31, 0
    s_mov_b32 s32, 16
    s_mov_b32 s75, 0
    s_mov_b32 s74, 16
    s_mov_b32 s73, 16
attn_kernel_s18d:
    s_mul_i32 s72, s50, 0
    s_cmp_eq_u32 s47, 0
    s_cselect_b32 s5, 16, 0
    s_mov_b32 s76, 0
    s_mov_b32 s77, 0
    s_waitcnt lgkmcnt(0)
    s_lshl_b32 s41, s29, 20
    s_add_u32 s42, s41, 16777216
    s_add_u32 s8, s62, s42
    s_addc_u32 s9, s63, 0
    s_mov_b32 s10, 1048576
    s_mov_b32 s11, 0x20000
    s_add_u32 s42, s42, 16777216
    s_add_u32 s12, s62, s42
    s_addc_u32 s13, s63, 0
    s_mov_b32 s14, 1048576
    s_mov_b32 s15, 0x20000
    s_add_u32 s16, s62, s41
    s_addc_u32 s17, s63, 0
    s_mov_b32 s18, 1048576
    s_mov_b32 s19, 0x20000
    s_mov_b32 s38, 0
    s_mov_b32 s39, 0
    s_mov_b32 s34, 0
    s_mov_b32 s35, 0
    s_cmp_lt_u32 s38, s73
    s_cselect_b32 s10, 1048576, 0
    s_sub_u32 s45, s38, s74
    s_add_u32 s44, s38, s75
    s_cmp_lt_u32 s38, s74
    s_cselect_b32 s45, s44, s45
    s_lshl_b32 s45, s45, 15
    s_add_u32 m0, s34, s40
    s_add_u32 s45, s45, s40
    buffer_load_dwordx4 v224, s[8:11], s45 offen offset:0  lds
    buffer_load_dwordx4 v224, s[8:11], s45 offen offset:1024  lds
    buffer_load_dwordx4 v224, s[8:11], s45 offen offset:2048  lds
    buffer_load_dwordx4 v224, s[8:11], s45 offen offset:3072  lds
    s_add_u32 m0, s34, s40
    s_add_u32 s45, s45, 4096
    s_add_u32 m0, m0, 4096
    s_nop 0
    buffer_load_dwordx4 v224, s[8:11], s45 offen offset:0  lds
    buffer_load_dwordx4 v224, s[8:11], s45 offen offset:1024  lds
    buffer_load_dwordx4 v224, s[8:11], s45 offen offset:2048  lds
    buffer_load_dwordx4 v224, s[8:11], s45 offen offset:3072  lds
    s_add_u32 s38, s38, 1
    s_xor_b32 s34, s34, 32768
    s_lshl_b32 s41, s30, 2
    s_add_u32 s41, s41, s28
    s_lshl_b32 s42, s41, 14
    buffer_load_dwordx4 a[0:3], v224, s[16:19], s42 offen offset:0
    buffer_load_dwordx4 a[4:7], v224, s[16:19], s42 offen offset:1024
    buffer_load_dwordx4 a[8:11], v224, s[16:19], s42 offen offset:2048
    buffer_load_dwordx4 a[12:15], v224, s[16:19], s42 offen offset:3072
    s_add_u32 s42, s42, 4096
    buffer_load_dwordx4 a[16:19], v224, s[16:19], s42 offen offset:0
    buffer_load_dwordx4 a[20:23], v224, s[16:19], s42 offen offset:1024
    buffer_load_dwordx4 a[24:27], v224, s[16:19], s42 offen offset:2048
    buffer_load_dwordx4 a[28:31], v224, s[16:19], s42 offen offset:3072
    s_add_u32 s42, s42, 4096
    buffer_load_dwordx4 a[32:35], v224, s[16:19], s42 offen offset:0
    buffer_load_dwordx4 a[36:39], v224, s[16:19], s42 offen offset:1024
    buffer_load_dwordx4 a[40:43], v224, s[16:19], s42 offen offset:2048
    buffer_load_dwordx4 a[44:47], v224, s[16:19], s42 offen offset:3072
    s_add_u32 s42, s42, 4096
    buffer_load_dwordx4 a[48:51], v224, s[16:19], s42 offen offset:0
    buffer_load_dwordx4 a[52:55], v224, s[16:19], s42 offen offset:1024
    buffer_load_dwordx4 a[56:59], v224, s[16:19], s42 offen offset:2048
    buffer_load_dwordx4 a[60:63], v224, s[16:19], s42 offen offset:3072
    s_add_u32 s20, s62, 58720256
    s_addc_u32 s21, s63, 0
    s_mov_b32 s22, 16777216
    s_mov_b32 s23, 0x20000
    s_mul_i32 s41, s48, 69632
    s_mul_i32 s42, s28, 17408
    s_add_u32 s41, s41, s42
    s_add_u32 s41, s41, 83886080
    s_add_u32 s24, s62, s41
    s_addc_u32 s25, s63, 0
    s_mov_b32 s26, 17408
    s_mov_b32 s27, 0x20000
    v_and_b32 v246, 31, v251
    v_lshrrev_b32 v247, 5, v251
    v_lshlrev_b32 v247, 2, v247
    v_sub_u32 v252, v246, v247
    s_lshl_b32 s41, s30, 2
    s_add_u32 s41, s41, s28
    s_lshl_b32 s41, s41, 5
    v_add_u32 v242, s41, v252
    s_sub_u32 s6, s32, 2
    s_max_i32 s6, s6, 0
    s_min_u32 s6, s6, s33
    v_mov_b32 v0, 0
    v_mov_b32 v1, 0
    v_mov_b32 v2, 0
    v_mov_b32 v3, 0
    v_mov_b32 v4, 0
    v_mov_b32 v5, 0
    v_mov_b32 v6, 0
    v_mov_b32 v7, 0
    v_mov_b32 v8, 0
    v_mov_b32 v9, 0
    v_mov_b32 v10, 0
    v_mov_b32 v11, 0
    v_mov_b32 v12, 0
    v_mov_b32 v13, 0
    v_mov_b32 v14, 0
    v_mov_b32 v15, 0
    v_mov_b32 v16, 0
    v_mov_b32 v17, 0
    v_mov_b32 v18, 0
    v_mov_b32 v19, 0
    v_mov_b32 v20, 0
    v_mov_b32 v21, 0
    v_mov_b32 v22, 0
    v_mov_b32 v23, 0
    v_mov_b32 v24, 0
    v_mov_b32 v25, 0
    v_mov_b32 v26, 0
    v_mov_b32 v27, 0
    v_mov_b32 v28, 0
    v_mov_b32 v29, 0
    v_mov_b32 v30, 0
    v_mov_b32 v31, 0
    v_mov_b32 v32, 0
    v_mov_b32 v33, 0
    v_mov_b32 v34, 0
    v_mov_b32 v35, 0
    v_mov_b32 v36, 0
    v_mov_b32 v37, 0
    v_mov_b32 v38, 0
    v_mov_b32 v39, 0
    v_mov_b32 v40, 0
    v_mov_b32 v41, 0
    v_mov_b32 v42, 0
    v_mov_b32 v43, 0
    v_mov_b32 v44, 0
    v_mov_b32 v45, 0
    v_mov_b32 v46, 0
    v_mov_b32 v47, 0
    v_mov_b32 v48, 0
    v_mov_b32 v49, 0
    v_mov_b32 v50, 0
    v_mov_b32 v51, 0
    v_mov_b32 v52, 0
    v_mov_b32 v53, 0
    v_mov_b32 v54, 0
    v_mov_b32 v55, 0
    v_mov_b32 v56, 0
    v_mov_b32 v57, 0
    v_mov_b32 v58, 0
    v_mov_b32 v59, 0
    v_mov_b32 v60, 0
    v_mov_b32 v61, 0
    v_mov_b32 v62, 0
    v_mov_b32 v63, 0
    v_mov_b32 v64, 0
    v_mov_b32 v65, 0
    v_mov_b32 v66, 0
    v_mov_b32 v67, 0
    v_mov_b32 v68, 0
    v_mov_b32 v69, 0
    v_mov_b32 v70, 0
    v_mov_b32 v71, 0
    v_mov_b32 v72, 0
    v_mov_b32 v73, 0
    v_mov_b32 v74, 0
    v_mov_b32 v75, 0
    v_mov_b32 v76, 0
    v_mov_b32 v77, 0
    v_mov_b32 v78, 0
    v_mov_b32 v79, 0
    v_mov_b32 v80, 0
    v_mov_b32 v81, 0
    v_mov_b32 v82, 0
    v_mov_b32 v83, 0
    v_mov_b32 v84, 0
    v_mov_b32 v85, 0
    v_mov_b32 v86, 0
    v_mov_b32 v87, 0
    v_mov_b32 v88, 0
    v_mov_b32 v89, 0
    v_mov_b32 v90, 0
    v_mov_b32 v91, 0
    v_mov_b32 v92, 0
    v_mov_b32 v93, 0
    v_mov_b32 v94, 0
    v_mov_b32 v95, 0
    v_mov_b32 v96, 0
    v_mov_b32 v97, 0
    v_mov_b32 v98, 0
    v_mov_b32 v99, 0
    v_mov_b32 v100, 0
    v_mov_b32 v101, 0
    v_mov_b32 v102, 0
    v_mov_b32 v103, 0
    v_mov_b32 v104, 0
    v_mov_b32 v105, 0
    v_mov_b32 v106, 0
    v_mov_b32 v107, 0
    v_mov_b32 v108, 0
    v_mov_b32 v109, 0
    v_mov_b32 v110, 0
    v_mov_b32 v111, 0
    v_mov_b32 v112, 0
    v_mov_b32 v113, 0
    v_mov_b32 v114, 0
    v_mov_b32 v115, 0
    v_mov_b32 v116, 0
    v_mov_b32 v117, 0
    v_mov_b32 v118, 0
    v_mov_b32 v119, 0
    v_mov_b32 v120, 0
    v_mov_b32 v121, 0
    v_mov_b32 v122, 0
    v_mov_b32 v123, 0
    v_mov_b32 v124, 0
    v_mov_b32 v125, 0
    v_mov_b32 v126, 0
    v_mov_b32 v127, 0
    v_mov_b32 v228, 0
    s_waitcnt vmcnt(16)
    s_barrier
    v_mov_b32 v225, v224
    ds_read_b128 a[64:67], v225 offset:0
    ds_read_b128 a[68:71], v225 offset:1024
    ds_read_b128 a[72:75], v225 offset:2048
    ds_read_b128 a[76:79], v225 offset:3072
    ds_read_b128 a[80:83], v225 offset:4096
    ds_read_b128 a[84:87], v225 offset:5120
    ds_read_b128 a[88:91], v225 offset:6144
    ds_read_b128 a[92:95], v225 offset:7168
    ds_read_b128 a[96:99], v225 offset:8192
    s_waitcnt lgkmcnt(8)
    s_waitcnt vmcnt(14)
    v_mfma_f32_32x32x16_bf16 v[128:143], a[64:67], a[0:3], 0
    s_cmp_lt_u32 s38, s73
    s_cselect_b32 s10, 1048576, 0
    s_sub_u32 s45, s38, s74
    s_add_u32 s44, s38, s75
    ds_read_b128 a[100:103], v225 offset:9216
    s_waitcnt lgkmcnt(8)
    v_mfma_f32_32x32x16_bf16 v[128:143], a[68:71], a[4:7], v[128:143]
    s_cmp_lt_u32 s38, s74
    s_cselect_b32 s45, s44, s45
    s_lshl_b32 s45, s45, 15
    ds_read_b128 a[104:107], v225 offset:10240
    s_waitcnt lgkmcnt(8)
    s_waitcnt vmcnt(12)
    v_mfma_f32_32x32x16_bf16 v[128:143], a[72:75], a[8:11], v[128:143]
    s_add_u32 m0, s34, s40
    s_add_u32 s45, s45, s40
    ds_read_b128 a[108:111], v225 offset:11264
    s_waitcnt lgkmcnt(8)
    v_mfma_f32_32x32x16_bf16 v[128:143], a[76:79], a[12:15], v[128:143]
    buffer_load_dwordx4 v224, s[8:11], s45 offen offset:0  lds
    buffer_load_dwordx4 v224, s[8:11], s45 offen offset:1024  lds
    ds_read_b128 a[112:115], v225 offset:12288
    s_waitcnt lgkmcnt(8)
    s_waitcnt vmcnt(12)
    v_mfma_f32_32x32x16_bf16 v[128:143], a[80:83], a[16:19], v[128:143]
    buffer_load_dwordx4 v224, s[8:11], s45 offen offset:2048  lds
    buffer_load_dwordx4 v224, s[8:11], s45 offen offset:3072  lds
    ds_read_b128 a[116:119], v225 offset:13312
    s_waitcnt lgkmcnt(8)
    v_mfma_f32_32x32x16_bf16 v[128:143], a[84:87], a[20:23], v[128:143]
    s_add_u32 m0, s34, s40
    s_add_u32 s45, s45, 4096
    ds_read_b128 a[120:123], v225 offset:14336
    s_waitcnt lgkmcnt(8)
    s_waitcnt vmcnt(12)
    v_mfma_f32_32x32x16_bf16 v[128:143], a[88:91], a[24:27], v[128:143]
    s_add_u32 m0, m0, 4096
    s_nop 0
    ds_read_b128 a[124:127], v225 offset:15360
    s_waitcnt lgkmcnt(8)
    v_mfma_f32_32x32x16_bf16 v[128:143], a[92:95], a[28:31], v[128:143]
    buffer_load_dwordx4 v224, s[8:11], s45 offen offset:0  lds
    buffer_load_dwordx4 v224, s[8:11], s45 offen offset:1024  lds
    ds_read_b128 a[64:67], v225 offset:16384
    s_waitcnt lgkmcnt(8)
    s_waitcnt vmcnt(12)
    v_mfma_f32_32x32x16_bf16 v[128:143], a[96:99], a[32:35], v[128:143]
    buffer_load_dwordx4 v224, s[8:11], s45 offen offset:2048  lds
    buffer_load_dwordx4 v224, s[8:11], s45 offen offset:3072  lds
    ds_read_b128 a[68:71], v225 offset:17408
    s_waitcnt lgkmcnt(8)
    v_mfma_f32_32x32x16_bf16 v[128:143], a[100:103], a[36:39], v[128:143]
    s_add_u32 s38, s38, 1
    s_xor_b32 s34, s34, 32768
    ds_read_b128 a[72:75], v225 offset:18432
    s_waitcnt lgkmcnt(8)
    s_waitcnt vmcnt(12)
    v_mfma_f32_32x32x16_bf16 v[128:143], a[104:107], a[40:43], v[128:143]
    s_cmp_lt_u32 s39, s73
    s_cselect_b32 s14, 1048576, 0
    s_sub_u32 s46, s39, s74
    s_add_u32 s44, s39, s75
    ds_read_b128 a[76:79], v225 offset:19456
    s_waitcnt lgkmcnt(8)
    v_mfma_f32_32x32x16_bf16 v[128:143], a[108:111], a[44:47], v[128:143]
    s_cmp_lt_u32 s39, s74
    s_cselect_b32 s46, s44, s46
    s_lshl_b32 s46, s46, 15
    ds_read_b128 a[80:83], v225 offset:20480
    s_waitcnt lgkmcnt(8)
    s_waitcnt vmcnt(10)
    v_mfma_f32_32x32x16_bf16 v[128:143], a[112:115], a[48:51], v[128:143]
    s_add_u32 m0, s35, s7
    s_add_u32 s46, s46, s40
    ds_read_b128 a[84:87], v225 offset:21504
    s_waitcnt lgkmcnt(8)
    v_mfma_f32_32x32x16_bf16 v[128:143], a[116:119], a[52:55], v[128:143]
    buffer_load_dwordx4 v224, s[12:15], s46 offen offset:0  lds
    buffer_load_dwordx4 v224, s[12:15], s46 offen offset:1024  lds
    ds_read_b128 a[88:91], v225 offset:22528
    s_waitcnt lgkmcnt(8)
    s_waitcnt vmcnt(10)
    v_mfma_f32_32x32x16_bf16 v[128:143], a[120:123], a[56:59], v[128:143]
    buffer_load_dwordx4 v224, s[12:15], s46 offen offset:2048  lds
    buffer_load_dwordx4 v224, s[12:15], s46 offen offset:3072  lds
    ds_read_b128 a[92:95], v225 offset:23552
    s_waitcnt lgkmcnt(8)
    v_mfma_f32_32x32x16_bf16 v[128:143], a[124:127], a[60:63], v[128:143]
    s_add_u32 m0, s35, s7
    s_add_u32 s46, s46, 4096
    ds_read_b128 a[96:99], v225 offset:24576
    s_waitcnt lgkmcnt(8)
    v_mfma_f32_32x32x16_bf16 v[144:159], a[64:67], a[0:3], 0
    s_add_u32 m0, m0, 4096
    s_nop 0
    ds_read_b128 a[100:103], v225 offset:25600
    s_waitcnt lgkmcnt(8)
    v_mfma_f32_32x32x16_bf16 v[144:159], a[68:71], a[4:7], v[144:159]
    buffer_load_dwordx4 v224, s[12:15], s46 offen offset:0  lds
    buffer_load_dwordx4 v224, s[12:15], s46 offen offset:1024  lds
    ds_read_b128 a[104:107], v225 offset:26624
    s_waitcnt lgkmcnt(8)
    v_mfma_f32_32x32x16_bf16 v[144:159], a[72:75], a[8:11], v[144:159]
    buffer_load_dwordx4 v224, s[12:15], s46 offen offset:2048  lds
    buffer_load_dwordx4 v224, s[12:15], s46 offen offset:3072  lds
    ds_read_b128 a[108:111], v225 offset:27648
    s_waitcnt lgkmcnt(8)
    v_mfma_f32_32x32x16_bf16 v[144:159], a[76:79], a[12:15], v[144:159]
    s_add_u32 s39, s39, 1
    s_add_u32 s35, s35, 32768
    ds_read_b128 a[112:115], v225 offset:28672
    s_waitcnt lgkmcnt(8)
    v_mfma_f32_32x32x16_bf16 v[144:159], a[80:83], a[16:19], v[144:159]
    s_cmp_eq_u32 s35, 98304
    s_cselect_b32 s35, 0, s35
    s_cmp_lt_u32 s39, s73
    s_cselect_b32 s14, 1048576, 0
    s_sub_u32 s46, s39, s74
    ds_read_b128 a[116:119], v225 offset:29696
    s_waitcnt lgkmcnt(8)
    v_mfma_f32_32x32x16_bf16 v[144:159], a[84:87], a[20:23], v[144:159]
    s_add_u32 s44, s39, s75
    s_cmp_lt_u32 s39, s74
    s_cselect_b32 s46, s44, s46
    ds_read_b128 a[120:123], v225 offset:30720
    s_waitcnt lgkmcnt(8)
    v_mfma_f32_32x32x16_bf16 v[144:159], a[88:91], a[24:27], v[144:159]
    s_lshl_b32 s46, s46, 15
    s_add_u32 m0, s35, s7
    ds_read_b128 a[124:127], v225 offset:31744
    s_waitcnt lgkmcnt(8)
    v_mfma_f32_32x32x16_bf16 v[144:159], a[92:95], a[28:31], v[144:159]
    s_add_u32 s46, s46, s40
    buffer_load_dwordx4 v224, s[12:15], s46 offen offset:0  lds
    s_waitcnt lgkmcnt(7)
    v_mfma_f32_32x32x16_bf16 v[144:159], a[96:99], a[32:35], v[144:159]
    buffer_load_dwordx4 v224, s[12:15], s46 offen offset:1024  lds
    buffer_load_dwordx4 v224, s[12:15], s46 offen offset:2048  lds
    s_waitcnt lgkmcnt(6)
    v_mfma_f32_32x32x16_bf16 v[144:159], a[100:103], a[36:39], v[144:159]
    buffer_load_dwordx4 v224, s[12:15], s46 offen offset:3072  lds
    s_add_u32 m0, s35, s7
    s_waitcnt lgkmcnt(5)
    v_mfma_f32_32x32x16_bf16 v[144:159], a[104:107], a[40:43], v[144:159]
    s_add_u32 s46, s46, 4096
    s_add_u32 m0, m0, 4096
    s_waitcnt lgkmcnt(4)
    v_mfma_f32_32x32x16_bf16 v[144:159], a[108:111], a[44:47], v[144:159]
    s_nop 0
    buffer_load_dwordx4 v224, s[12:15], s46 offen offset:0  lds
    s_waitcnt lgkmcnt(3)
    v_mfma_f32_32x32x16_bf16 v[144:159], a[112:115], a[48:51], v[144:159]
    buffer_load_dwordx4 v224, s[12:15], s46 offen offset:1024  lds
    buffer_load_dwordx4 v224, s[12:15], s46 offen offset:2048  lds
    s_waitcnt lgkmcnt(2)
    v_mfma_f32_32x32x16_bf16 v[144:159], a[116:119], a[52:55], v[144:159]
    buffer_load_dwordx4 v224, s[12:15], s46 offen offset:3072  lds
    s_add_u32 s39, s39, 1
    s_waitcnt lgkmcnt(1)
    v_mfma_f32_32x32x16_bf16 v[144:159], a[120:123], a[56:59], v[144:159]
    s_add_u32 s35, s35, 32768
    s_cmp_eq_u32 s35, 98304
    s_cselect_b32 s35, 0, s35
    s_waitcnt lgkmcnt(0)
    v_mfma_f32_32x32x16_bf16 v[144:159], a[124:127], a[60:63], v[144:159]
    s_nop 7
    s_nop 3
    s_lshl_b32 s41, s31, 6
    v_subrev_u32 v243, s41, v242
    v_subrev_u32 v244, 32, v243
    v_cmp_ge_i32 s[52:53], v243, 0
    v_cmp_ge_i32 s[54:55], v243, 1
    v_cmp_ge_i32 s[56:57], v243, 2
    v_cmp_ge_i32 s[58:59], v243, 3
    v_cndmask_b32 v128, v245, v128, s[52:53]
    v_cmp_ge_i32 s[52:53], v243, 8
    v_cndmask_b32 v129, v245, v129, s[54:55]
    v_cmp_ge_i32 s[54:55], v243, 9
    v_cndmask_b32 v130, v245, v130, s[56:57]
    v_cmp_ge_i32 s[56:57], v243, 10
    v_cndmask_b32 v131, v245, v131, s[58:59]
    v_cmp_ge_i32 s[58:59], v243, 11
    v_cndmask_b32 v132, v245, v132, s[52:53]
    v_cmp_ge_i32 s[52:53], v243, 16
    v_cndmask_b32 v133, v245, v133, s[54:55]
    v_cmp_ge_i32 s[54:55], v243, 17
    v_cndmask_b32 v134, v245, v134, s[56:57]
    v_cmp_ge_i32 s[56:57], v243, 18
    v_cndmask_b32 v135, v245, v135, s[58:59]
    v_cmp_ge_i32 s[58:59], v243, 19
    v_cndmask_b32 v136, v245, v136, s[52:53]
    v_cmp_ge_i32 s[52:53], v243, 24
    v_cndmask_b32 v137, v245, v137, s[54:55]
    v_cmp_ge_i32 s[54:55], v243, 25
    v_cndmask_b32 v138, v245, v138, s[56:57]
    v_cmp_ge_i32 s[56:57], v243, 26
    v_cndmask_b32 v139, v245, v139, s[58:59]
    v_cmp_ge_i32 s[58:59], v243, 27
    v_cndmask_b32 v140, v245, v140, s[52:53]
    v_cmp_ge_i32 s[52:53], v244, 0
    v_cndmask_b32 v141, v245, v141, s[54:55]
    v_cmp_ge_i32 s[54:55], v244, 1
    v_cndmask_b32 v142, v245, v142, s[56:57]
    v_cmp_ge_i32 s[56:57], v244, 2
    v_cndmask_b32 v143, v245, v143, s[58:59]
    v_cmp_ge_i32 s[58:59], v244, 3
    v_cndmask_b32 v144, v245, v144, s[52:53]
    v_cmp_ge_i32 s[52:53], v244, 8
    v_cndmask_b32 v145, v245, v145, s[54:55]
    v_cmp_ge_i32 s[54:55], v244, 9
    v_cndmask_b32 v146, v245, v146, s[56:57]
    v_cmp_ge_i32 s[56:57], v244, 10
    v_cndmask_b32 v147, v245, v147, s[58:59]
    v_cmp_ge_i32 s[58:59], v244, 11
    v_cndmask_b32 v148, v245, v148, s[52:53]
    v_cmp_ge_i32 s[52:53], v244, 16
    v_cndmask_b32 v149, v245, v149, s[54:55]
    v_cmp_ge_i32 s[54:55], v244, 17
    v_cndmask_b32 v150, v245, v150, s[56:57]
    v_cmp_ge_i32 s[56:57], v244, 18
    v_cndmask_b32 v151, v245, v151, s[58:59]
    v_cmp_ge_i32 s[58:59], v244, 19
    v_cndmask_b32 v152, v245, v152, s[52:53]
    v_cmp_ge_i32 s[52:53], v244, 24
    v_cndmask_b32 v153, v245, v153, s[54:55]
    v_cmp_ge_i32 s[54:55], v244, 25
    v_cndmask_b32 v154, v245, v154, s[56:57]
    v_cmp_ge_i32 s[56:57], v244, 26
    v_cndmask_b32 v155, v245, v155, s[58:59]
    v_cmp_ge_i32 s[58:59], v244, 27
    v_cndmask_b32 v156, v245, v156, s[52:53]
    s_nop 1
    v_cndmask_b32 v157, v245, v157, s[54:55]
    v_cndmask_b32 v158, v245, v158, s[56:57]
    v_cndmask_b32 v159, v245, v159, s[58:59]
    v_max3_f32 v246, v128, v129, v130
    v_max3_f32 v247, v131, v132, v133
    v_max3_f32 v246, v246, v134, v135
    v_max3_f32 v247, v247, v136, v137
    v_max3_f32 v246, v246, v138, v139
    v_max3_f32 v247, v247, v140, v141
    v_max3_f32 v246, v246, v142, v143
    v_max3_f32 v247, v247, v144, v145
    v_max3_f32 v246, v246, v146, v147
    v_max3_f32 v247, v247, v148, v149
    v_max3_f32 v246, v246, v150, v151
    v_max3_f32 v247, v247, v152, v153
    v_max3_f32 v246, v246, v154, v155
    v_max3_f32 v247, v247, v156, v157
    v_max3_f32 v246, v246, v158, v159
    v_max_f32 v246, v246, v247
    v_mov_b32 v247, v246
    s_nop 1
    v_permlane32_swap_b32 v246, v247
    s_nop 1
    v_max_f32 v246, v246, v247
    v_mov_b32 v247, 0xf149f2ca
    v_cmp_gt_f32 vcc, v246, v247
    s_nop 1
    v_cndmask_b32 v250, 0, v246, vcc
    v_sub_f32 v128, v128, v250
    v_sub_f32 v129, v129, v250
    v_sub_f32 v130, v130, v250
    v_sub_f32 v131, v131, v250
    v_sub_f32 v132, v132, v250
    v_sub_f32 v133, v133, v250
    v_sub_f32 v134, v134, v250
    v_sub_f32 v135, v135, v250
    v_sub_f32 v136, v136, v250
    v_sub_f32 v137, v137, v250
    v_sub_f32 v138, v138, v250
    v_sub_f32 v139, v139, v250
    v_sub_f32 v140, v140, v250
    v_sub_f32 v141, v141, v250
    v_sub_f32 v142, v142, v250
    v_sub_f32 v143, v143, v250
    v_sub_f32 v144, v144, v250
    v_sub_f32 v145, v145, v250
    v_sub_f32 v146, v146, v250
    v_sub_f32 v147, v147, v250
    v_sub_f32 v148, v148, v250
    v_sub_f32 v149, v149, v250
    v_sub_f32 v150, v150, v250
    v_sub_f32 v151, v151, v250
    v_sub_f32 v152, v152, v250
    v_sub_f32 v153, v153, v250
    v_sub_f32 v154, v154, v250
    v_sub_f32 v155, v155, v250
    v_sub_f32 v156, v156, v250
    v_sub_f32 v157, v157, v250
    v_sub_f32 v158, v158, v250
    v_sub_f32 v159, v159, v250
    v_sub_f32 v192, 0, v250
    v_sub_f32 v193, 0, v250
    v_sub_f32 v194, 0, v250
    v_sub_f32 v195, 0, v250
    v_sub_f32 v196, 0, v250
    v_sub_f32 v197, 0, v250
    v_sub_f32 v198, 0, v250
    v_sub_f32 v199, 0, v250
    v_sub_f32 v200, 0, v250
    v_sub_f32 v201, 0, v250
    v_sub_f32 v202, 0, v250
    v_sub_f32 v203, 0, v250
    v_sub_f32 v204, 0, v250
    v_sub_f32 v205, 0, v250
    v_sub_f32 v206, 0, v250
    v_sub_f32 v207, 0, v250
    s_waitcnt vmcnt(8)
attn_kernel_w8b:
    s_barrier
    s_cmp_lt_u32 s38, s73
    s_cselect_b32 s10, 1048576, 0
    s_sub_u32 s45, s38, s74
    s_add_u32 s44, s38, s75
    s_cmp_lt_u32 s38, s74
    s_cselect_b32 s45, s44, s45
    s_lshl_b32 s45, s45, 15
    s_add_u32 m0, s34, s40
    s_add_u32 s45, s45, s40
    buffer_load_dwordx4 v224, s[8:11], s45 offen offset:0  lds
    buffer_load_dwordx4 v224, s[8:11], s45 offen offset:1024  lds
    buffer_load_dwordx4 v224, s[8:11], s45 offen offset:2048  lds
    buffer_load_dwordx4 v224, s[8:11], s45 offen offset:3072  lds
    s_mov_b32 s36, 32768
    s_mov_b32 s37, 0
    v_add_u32 v225, s36, v224
    v_add_u32 v226, 65536, v224
    ds_read_b128 a[64:67], v225 offset:0
    ds_read_b128 a[68:71], v225 offset:1024
    ds_read_b128 a[72:75], v225 offset:2048
    ds_read_b128 a[76:79], v225 offset:3072
    ds_read_b128 a[80:83], v225 offset:4096
    ds_read_b128 a[84:87], v225 offset:5120
    ds_read_b128 a[88:91], v225 offset:6144
    ds_read_b128 a[92:95], v225 offset:7168
    ds_read_b128 a[96:99], v225 offset:8192
    ds_read_b128 a[100:103], v225 offset:9216
    ds_read_b128 a[104:107], v225 offset:10240
    ds_read_b128 a[108:111], v225 offset:11264
    s_cmp_eq_u32 s74, 1
    s_cbranch_scc0 attn_kernel_q2ok
    s_waitcnt vmcnt(4)
attn_kernel_q2ok:
    s_branch attn_kernel_dispatch0
attn_kernel_dispatch0:
    s_cmp_lt_u32 s31, s6
    s_cbranch_scc1 attn_kernel_body_0_0_1
    s_add_u32 s41, s31, 1
    s_cmp_lt_u32 s41, s32
    s_cbranch_scc0 attn_kernel_d0_last
    s_add_u32 s41, s31, 2
    s_cmp_eq_u32 s41, s32
    s_cbranch_scc0 attn_kernel_d0_nl
    s_cmp_eq_u32 s47, 1
    s_cbranch_scc0 attn_kernel_d0_nq
    s_lshl_b32 s41, s50, 2
    s_add_u32 s41, s41, s28
    s_lshl_b32 s42, s41, 14
    buffer_load_dwordx4 a[128:131], v224, s[16:19], s42 offen offset:0
    buffer_load_dwordx4 a[132:135], v224, s[16:19], s42 offen offset:1024
    buffer_load_dwordx4 a[136:139], v224, s[16:19], s42 offen offset:2048
    buffer_load_dwordx4 a[140:143], v224, s[16:19], s42 offen offset:3072
    s_add_u32 s42, s42, 4096
    buffer_load_dwordx4 a[144:147], v224, s[16:19], s42 offen offset:0
    buffer_load_dwordx4 a[148:151], v224, s[16:19], s42 offen offset:1024
    buffer_load_dwordx4 a[152:155], v224, s[16:19], s42 offen offset:2048
    buffer_load_dwordx4 a[156:159], v224, s[16:19], s42 offen offset:3072
    s_add_u32 s42, s42, 4096
    buffer_load_dwordx4 a[160:163], v224, s[16:19], s42 offen offset:0
    buffer_load_dwordx4 a[164:167], v224, s[16:19], s42 offen offset:1024
    buffer_load_dwordx4 a[168:171], v224, s[16:19], s42 offen offset:2048
    buffer_load_dwordx4 a[172:175], v224, s[16:19], s42 offen offset:3072
    s_add_u32 s42, s42, 4096
    buffer_load_dwordx4 a[176:179], v224, s[16:19], s42 offen offset:0
    buffer_load_dwordx4 a[180:183], v224, s[16:19], s42 offen offset:1024
    buffer_load_dwordx4 a[184:187], v224, s[16:19], s42 offen offset:2048
    buffer_load_dwordx4 a[188:191], v224, s[16:19], s42 offen offset:3072
    s_branch attn_kernel_d0_nl
attn_kernel_d0_nq:
    s_cmp_eq_u32 s47, 0
    s_cbranch_scc0 attn_kernel_d0_nl
    v_mov_b32 v246, s78
    global_load_dword v227, v246, s[60:61] sc1
    s_mov_b32 s77, 1
attn_kernel_d0_nl:
    s_cmp_ge_u32 s31, s33
    s_cbranch_scc1 attn_kernel_body_0_1_1
    s_branch attn_kernel_body_0_0_1
attn_kernel_d0_last:
    s_cmp_eq_u32 s47, 1
    s_cbranch_scc1 attn_kernel_body_0_1_2
    s_cmp_eq_u32 s77, 1
    s_cbranch_scc0 attn_kernel_d0_l2
    v_readfirstlane_b32 s41, v227
    s_nop 3
    s_and_b32 s41, s41, s79
    s_cmp_lg_u32 s41, 0
    s_cselect_b32 s77, 2, 3
    s_cbranch_scc0 attn_kernel_d0_rp
    s_mov_b32 s42, 0
    buffer_load_dwordx4 a[128:131], v224, s[24:27], s42 offen offset:0 sc1
    buffer_load_dwordx4 a[132:135], v224, s[24:27], s42 offen offset:1024 sc1
    buffer_load_dwordx4 a[136:139], v224, s[24:27], s42 offen offset:2048 sc1
    buffer_load_dwordx4 a[140:143], v224, s[24:27], s42 offen offset:3072 sc1
    s_add_u32 s42, s42, 4096
    buffer_load_dwordx4 a[144:147], v224, s[24:27], s42 offen offset:0 sc1
    buffer_load_dwordx4 a[148:151], v224, s[24:27], s42 offen offset:1024 sc1
    buffer_load_dwordx4 a[152:155], v224, s[24:27], s42 offen offset:2048 sc1
    buffer_load_dwordx4 a[156:159], v224, s[24:27], s42 offen offset:3072 sc1
    s_add_u32 s42, s42, 4096
    buffer_load_dwordx4 a[160:163], v224, s[24:27], s42 offen offset:0 sc1
    buffer_load_dwordx4 a[164:167], v224, s[24:27], s42 offen offset:1024 sc1
    buffer_load_dwordx4 a[168:171], v224, s[24:27], s42 offen offset:2048 sc1
    buffer_load_dwordx4 a[172:175], v224, s[24:27], s42 offen offset:3072 sc1
    s_add_u32 s42, s42, 4096
    buffer_load_dwordx4 a[176:179], v224, s[24:27], s42 offen offset:0 sc1
    buffer_load_dwordx4 a[180:183], v224, s[24:27], s42 offen offset:1024 sc1
    buffer_load_dwordx4 a[184:187], v224, s[24:27], s42 offen offset:2048 sc1
    buffer_load_dwordx4 a[188:191], v224, s[24:27], s42 offen offset:3072 sc1
    s_add_u32 s42, s42, 4096
    v_lshrrev_b32 v248, 1, v224
    buffer_load_dwordx2 v[254:255], v248, s[24:27], s42 offen sc1
    s_branch attn_kernel_d0_l2
attn_kernel_d0_rp:
    v_mov_b32 v246, s78
    global_load_dword v227, v246, s[60:61] sc1
attn_kernel_d0_l2:
    s_cmp_ge_u32 s31, s33
    s_cbranch_scc1 attn_kernel_body_0_1_0
    s_branch attn_kernel_body_0_0_0
attn_kernel_dispatch1:
    s_cmp_lt_u32 s31, s6
    s_cbranch_scc1 attn_kernel_body_1_0_1
    s_add_u32 s41, s31, 1
    s_cmp_lt_u32 s41, s32
    s_cbranch_scc0 attn_kernel_d1_last
    s_add_u32 s41, s31, 2
    s_cmp_eq_u32 s41, s32
    s_cbranch_scc0 attn_kernel_d1_nl
    s_cmp_eq_u32 s47, 1
    s_cbranch_scc0 attn_kernel_d1_nq
    s_lshl_b32 s41, s50, 2
    s_add_u32 s41, s41, s28
    s_lshl_b32 s42, s41, 14
    buffer_load_dwordx4 a[128:131], v224, s[16:19], s42 offen offset:0
    buffer_load_dwordx4 a[132:135], v224, s[16:19], s42 offen offset:1024
    buffer_load_dwordx4 a[136:139], v224, s[16:19], s42 offen offset:2048
    buffer_load_dwordx4 a[140:143], v224, s[16:19], s42 offen offset:3072
    s_add_u32 s42, s42, 4096
    buffer_load_dwordx4 a[144:147], v224, s[16:19], s42 offen offset:0
    buffer_load_dwordx4 a[148:151], v224, s[16:19], s42 offen offset:1024
    buffer_load_dwordx4 a[152:155], v224, s[16:19], s42 offen offset:2048
    buffer_load_dwordx4 a[156:159], v224, s[16:19], s42 offen offset:3072
    s_add_u32 s42, s42, 4096
    buffer_load_dwordx4 a[160:163], v224, s[16:19], s42 offen offset:0
    buffer_load_dwordx4 a[164:167], v224, s[16:19], s42 offen offset:1024
    buffer_load_dwordx4 a[168:171], v224, s[16:19], s42 offen offset:2048
    buffer_load_dwordx4 a[172:175], v224, s[16:19], s42 offen offset:3072
    s_add_u32 s42, s42, 4096
    buffer_load_dwordx4 a[176:179], v224, s[16:19], s42 offen offset:0
    buffer_load_dwordx4 a[180:183], v224, s[16:19], s42 offen offset:1024
    buffer_load_dwordx4 a[184:187], v224, s[16:19], s42 offen offset:2048
    buffer_load_dwordx4 a[188:191], v224, s[16:19], s42 offen offset:3072
    s_branch attn_kernel_d1_nl
attn_kernel_d1_nq:
    s_cmp_eq_u32 s47, 0
    s_cbranch_scc0 attn_kernel_d1_nl
    v_mov_b32 v246, s78
    global_load_dword v227, v246, s[60:61] sc1
    s_mov_b32 s77, 1
attn_kernel_d1_nl:
    s_cmp_ge_u32 s31, s33
    s_cbranch_scc1 attn_kernel_body_1_1_1
    s_branch attn_kernel_body_1_0_1
attn_kernel_d1_last:
    s_cmp_eq_u32 s47, 1
    s_cbranch_scc1 attn_kernel_body_1_1_2
    s_cmp_eq_u32 s77, 1
    s_cbranch_scc0 attn_kernel_d1_l2
    v_readfirstlane_b32 s41, v227
    s_nop 3
    s_and_b32 s41, s41, s79
    s_cmp_lg_u32 s41, 0
    s_cselect_b32 s77, 2, 3
    s_cbranch_scc0 attn_kernel_d1_rp
    s_mov_b32 s42, 0
    buffer_load_dwordx4 a[128:131], v224, s[24:27], s42 offen offset:0 sc1
    buffer_load_dwordx4 a[132:135], v224, s[24:27], s42 offen offset:1024 sc1
    buffer_load_dwordx4 a[136:139], v224, s[24:27], s42 offen offset:2048 sc1
    buffer_load_dwordx4 a[140:143], v224, s[24:27], s42 offen offset:3072 sc1
    s_add_u32 s42, s42, 4096
    buffer_load_dwordx4 a[144:147], v224, s[24:27], s42 offen offset:0 sc1
    buffer_load_dwordx4 a[148:151], v224, s[24:27], s42 offen offset:1024 sc1
    buffer_load_dwordx4 a[152:155], v224, s[24:27], s42 offen offset:2048 sc1
    buffer_load_dwordx4 a[156:159], v224, s[24:27], s42 offen offset:3072 sc1
    s_add_u32 s42, s42, 4096
    buffer_load_dwordx4 a[160:163], v224, s[24:27], s42 offen offset:0 sc1
    buffer_load_dwordx4 a[164:167], v224, s[24:27], s42 offen offset:1024 sc1
    buffer_load_dwordx4 a[168:171], v224, s[24:27], s42 offen offset:2048 sc1
    buffer_load_dwordx4 a[172:175], v224, s[24:27], s42 offen offset:3072 sc1
    s_add_u32 s42, s42, 4096
    buffer_load_dwordx4 a[176:179], v224, s[24:27], s42 offen offset:0 sc1
    buffer_load_dwordx4 a[180:183], v224, s[24:27], s42 offen offset:1024 sc1
    buffer_load_dwordx4 a[184:187], v224, s[24:27], s42 offen offset:2048 sc1
    buffer_load_dwordx4 a[188:191], v224, s[24:27], s42 offen offset:3072 sc1
    s_add_u32 s42, s42, 4096
    v_lshrrev_b32 v248, 1, v224
    buffer_load_dwordx2 v[254:255], v248, s[24:27], s42 offen sc1
    s_branch attn_kernel_d1_l2
attn_kernel_d1_rp:
    v_mov_b32 v246, s78
    global_load_dword v227, v246, s[60:61] sc1
attn_kernel_d1_l2:
    s_cmp_ge_u32 s31, s33
    s_cbranch_scc1 attn_kernel_body_1_1_0
    s_branch attn_kernel_body_1_0_0
attn_kernel_body_0_0_1:
    s_waitcnt lgkmcnt(8)
    v_mfma_f32_32x32x16_bf16 v[160:175], a[64:67], a[0:3], v[192:207]
    ds_read_b128 a[112:115], v225 offset:12288
    v_exp_f32 v234, v128
    v_exp_f32 v235, v129
    v_mfma_f32_32x32x16_bf16 v[160:175], a[68:71], a[4:7], v[160:175]
    ds_read_b128 a[116:119], v225 offset:13312
    s_add_u32 m0, s34, s40
    v_exp_f32 v236, v130
    v_mfma_f32_32x32x16_bf16 v[160:175], a[72:75], a[8:11], v[160:175]
    ds_read_b128 a[120:123], v225 offset:14336
    s_add_u32 s45, s45, 4096
    v_exp_f32 v237, v131
    v_mov_b32 v229, v234
    v_mov_b32 v230, v235
    v_mfma_f32_32x32x16_bf16 v[160:175], a[76:79], a[12:15], v[160:175]
    ds_read_b128 a[124:127], v225 offset:15360
    s_add_u32 m0, m0, 4096
    v_cvt_pk_bf16_f32 v208, v234, v235
    v_exp_f32 v238, v132
    s_waitcnt lgkmcnt(8)
    v_mfma_f32_32x32x16_bf16 v[160:175], a[80:83], a[16:19], v[160:175]
    ds_read_b128 a[64:67], v225 offset:16384
    v_exp_f32 v239, v133
    v_mov_b32 v231, v236
    v_mov_b32 v232, v237
    v_mfma_f32_32x32x16_bf16 v[160:175], a[84:87], a[20:23], v[160:175]
    ds_read_b128 a[68:71], v225 offset:17408
    s_nop 0
    v_cvt_pk_bf16_f32 v209, v236, v237
    v_exp_f32 v240, v134
    v_mfma_f32_32x32x16_bf16 v[160:175], a[88:91], a[24:27], v[160:175]
    ds_read_b128 a[72:75], v225 offset:18432
    buffer_load_dwordx4 v224, s[8:11], s45 offen offset:0  lds
    v_exp_f32 v241, v135
    v_add_f32 v229, v229, v238
    v_mfma_f32_32x32x16_bf16 v[160:175], a[92:95], a[28:31], v[160:175]
    ds_read_b128 a[76:79], v225 offset:19456
    v_add_f32 v230, v230, v239
    v_cvt_pk_bf16_f32 v210, v238, v239
    v_exp_f32 v234, v136
    s_waitcnt lgkmcnt(8)
    v_mfma_f32_32x32x16_bf16 v[160:175], a[96:99], a[32:35], v[160:175]
    ds_read_b128 a[80:83], v225 offset:20480
    buffer_load_dwordx4 v224, s[8:11], s45 offen offset:1024  lds
    v_exp_f32 v235, v137
    v_add_f32 v231, v231, v240
    v_mfma_f32_32x32x16_bf16 v[160:175], a[100:103], a[36:39], v[160:175]
    ds_read_b128 a[84:87], v225 offset:21504
    buffer_load_dwordx4 v224, s[8:11], s45 offen offset:2048  lds
    v_add_f32 v232, v232, v241
    v_cvt_pk_bf16_f32 v211, v240, v241
    v_exp_f32 v236, v138
    v_mfma_f32_32x32x16_bf16 v[160:175], a[104:107], a[40:43], v[160:175]
    ds_read_b128 a[88:91], v225 offset:22528
    buffer_load_dwordx4 v224, s[8:11], s45 offen offset:3072  lds
    v_exp_f32 v237, v139
    v_add_f32 v229, v229, v234
    v_mfma_f32_32x32x16_bf16 v[160:175], a[108:111], a[44:47], v[160:175]
    ds_read_b128 a[92:95], v225 offset:23552
    v_add_f32 v230, v230, v235
    v_cvt_pk_bf16_f32 v212, v234, v235
    v_exp_f32 v238, v140
    s_waitcnt lgkmcnt(8)
    v_mfma_f32_32x32x16_bf16 v[160:175], a[112:115], a[48:51], v[160:175]
    ds_read_b128 a[96:99], v225 offset:24576
    s_add_u32 s38, s38, 1
    v_exp_f32 v239, v141
    v_mfma_f32_32x32x16_bf16 v[160:175], a[116:119], a[52:55], v[160:175]
    ds_read_b128 a[100:103], v225 offset:25600
    s_xor_b32 s34, s34, 32768
    v_add_f32 v231, v231, v236
    v_add_f32 v232, v232, v237
    v_cvt_pk_bf16_f32 v213, v236, v237
    v_mfma_f32_32x32x16_bf16 v[160:175], a[120:123], a[56:59], v[160:175]
    ds_read_b128 a[104:107], v225 offset:26624
    v_exp_f32 v240, v142
    v_exp_f32 v241, v143
    v_add_f32 v229, v229, v238
    v_mfma_f32_32x32x16_bf16 v[160:175], a[124:127], a[60:63], v[160:175]
    ds_read_b128 a[108:111], v225 offset:27648
    v_add_f32 v230, v230, v239
    v_cvt_pk_bf16_f32 v214, v238, v239
    v_exp_f32 v234, v144
    s_waitcnt lgkmcnt(8)
    v_mfma_f32_32x32x16_bf16 v[176:191], a[64:67], a[0:3], v[192:207]
    ds_read_b128 a[112:115], v225 offset:28672
    v_exp_f32 v235, v145
    v_add_f32 v231, v231, v240
    v_mfma_f32_32x32x16_bf16 v[176:191], a[68:71], a[4:7], v[176:191]
    ds_read_b128 a[116:119], v225 offset:29696
    v_add_f32 v232, v232, v241
    v_cvt_pk_bf16_f32 v215, v240, v241
    v_exp_f32 v236, v146
    v_mfma_f32_32x32x16_bf16 v[176:191], a[72:75], a[8:11], v[176:191]
    ds_read_b128 a[120:123], v225 offset:30720
    v_exp_f32 v237, v147
    v_add_f32 v229, v229, v234
    v_add_f32 v230, v230, v235
    v_cvt_pk_bf16_f32 v216, v234, v235
    v_mfma_f32_32x32x16_bf16 v[176:191], a[76:79], a[12:15], v[176:191]
    ds_read_b128 a[124:127], v225 offset:31744
    v_exp_f32 v238, v148
    v_exp_f32 v239, v149
    s_waitcnt lgkmcnt(8)
    v_mfma_f32_32x32x16_bf16 v[176:191], a[80:83], a[16:19], v[176:191]
    ds_read_b128 a[64:67], v226 offset:0
    v_add_f32 v231, v231, v236
    v_add_f32 v232, v232, v237
    v_cvt_pk_bf16_f32 v217, v236, v237
    v_mfma_f32_32x32x16_bf16 v[176:191], a[84:87], a[20:23], v[176:191]
    ds_read_b128 a[68:71], v226 offset:1024
    v_exp_f32 v240, v150
    v_exp_f32 v241, v151
    v_add_f32 v229, v229, v238
    v_mfma_f32_32x32x16_bf16 v[176:191], a[88:91], a[24:27], v[176:191]
    ds_read_b128 a[72:75], v226 offset:2048
    v_add_f32 v230, v230, v239
    v_cvt_pk_bf16_f32 v218, v238, v239
    v_exp_f32 v234, v152
    v_mfma_f32_32x32x16_bf16 v[176:191], a[92:95], a[28:31], v[176:191]
    ds_read_b128 a[76:79], v226 offset:3072
    v_exp_f32 v235, v153
    v_add_f32 v231, v231, v240
    v_add_f32 v232, v232, v241
    v_cvt_pk_bf16_f32 v219, v240, v241
    s_waitcnt lgkmcnt(8)
    v_mfma_f32_32x32x16_bf16 v[176:191], a[96:99], a[32:35], v[176:191]
    ds_read_b128 a[80:83], v226 offset:4096
    v_exp_f32 v236, v154
    v_exp_f32 v237, v155
    v_mfma_f32_32x32x16_bf16 v[176:191], a[100:103], a[36:39], v[176:191]
    ds_read_b128 a[84:87], v226 offset:5120
    v_add_f32 v229, v229, v234
    v_add_f32 v230, v230, v235
    v_cvt_pk_bf16_f32 v220, v234, v235
    v_mfma_f32_32x32x16_bf16 v[176:191], a[104:107], a[40:43], v[176:191]
    ds_read_b128 a[88:91], v226 offset:6144
    v_exp_f32 v238, v156
    v_exp_f32 v239, v157
    v_add_f32 v231, v231, v236
    v_mfma_f32_32x32x16_bf16 v[176:191], a[108:111], a[44:47], v[176:191]
    ds_read_b128 a[92:95], v226 offset:7168
    v_add_f32 v232, v232, v237
    v_cvt_pk_bf16_f32 v221, v236, v237
    v_exp_f32 v240, v158
    s_waitcnt lgkmcnt(8)
    v_mfma_f32_32x32x16_bf16 v[176:191], a[112:115], a[48:51], v[176:191]
    ds_read_b128 a[96:99], v226 offset:8192
    v_exp_f32 v241, v159
    v_add_f32 v229, v229, v238
    v_mfma_f32_32x32x16_bf16 v[176:191], a[116:119], a[52:55], v[176:191]
    ds_read_b128 a[100:103], v226 offset:9216
    v_add_f32 v230, v230, v239
    v_cvt_pk_bf16_f32 v222, v238, v239
    s_nop 0
    v_add_f32 v231, v231, v240
    v_add_f32 v232, v232, v241
    v_mfma_f32_32x32x16_bf16 v[176:191], a[120:123], a[56:59], v[176:191]
    ds_read_b128 a[104:107], v226 offset:10240
    v_cvt_pk_bf16_f32 v223, v240, v241
    v_add_f32 v229, v229, v230
    v_add_f32 v231, v231, v232
    v_add_f32 v229, v229, v231
    v_mfma_f32_32x32x16_bf16 v[176:191], a[124:127], a[60:63], v[176:191]
    ds_read_b128 a[108:111], v226 offset:11264
    s_waitcnt lgkmcnt(8)
    v_cmp_lt_f32 vcc, s51, v229
    s_mov_b32 s49, 1
    s_cbranch_vccnz attn_kernel_slow0
attn_kernel_ret1:
    v_add_f32 v228, v228, v229
    v_mfma_f32_32x32x16_bf16 v[0:15], a[64:67], v[208:211], v[0:15]
    ds_read_b128 a[112:115], v226 offset:12288
    s_cmp_lt_u32 s39, s73
    s_cselect_b32 s14, 1048576, 0
    v_mfma_f32_32x32x16_bf16 v[16:31], a[68:71], v[208:211], v[16:31]
    ds_read_b128 a[116:119], v226 offset:13312
    s_sub_u32 s46, s39, s74
    s_xor_b32 s36, s36, 32768
    v_mfma_f32_32x32x16_bf16 v[32:47], a[72:75], v[208:211], v[32:47]
    ds_read_b128 a[120:123], v226 offset:14336
    s_add_u32 s44, s39, s75
    v_add_u32 v225, s36, v224
    v_mfma_f32_32x32x16_bf16 v[48:63], a[76:79], v[208:211], v[48:63]
    ds_read_b128 a[124:127], v226 offset:15360
    s_cmp_lt_u32 s39, s74
    s_cselect_b32 s46, s44, s46
    s_waitcnt lgkmcnt(8)
    v_mfma_f32_32x32x16_bf16 v[64:79], a[80:83], v[208:211], v[64:79]
    ds_read_b128 a[64:67], v226 offset:16384
    s_lshl_b32 s46, s46, 15
    v_mfma_f32_32x32x16_bf16 v[80:95], a[84:87], v[208:211], v[80:95]
    ds_read_b128 a[68:71], v226 offset:17408
    s_add_u32 m0, s35, s7
    v_mfma_f32_32x32x16_bf16 v[96:111], a[88:91], v[208:211], v[96:111]
    ds_read_b128 a[72:75], v226 offset:18432
    s_add_u32 s46, s46, s40
    v_mfma_f32_32x32x16_bf16 v[112:127], a[92:95], v[208:211], v[112:127]
    ds_read_b128 a[76:79], v226 offset:19456
    buffer_load_dwordx4 v224, s[12:15], s46 offen offset:0  lds
    s_waitcnt lgkmcnt(8)
    v_mfma_f32_32x32x16_bf16 v[0:15], a[96:99], v[212:215], v[0:15]
    ds_read_b128 a[80:83], v226 offset:20480
    buffer_load_dwordx4 v224, s[12:15], s46 offen offset:1024  lds
    v_mfma_f32_32x32x16_bf16 v[16:31], a[100:103], v[212:215], v[16:31]
    ds_read_b128 a[84:87], v226 offset:21504
    buffer_load_dwordx4 v224, s[12:15], s46 offen offset:2048  lds
    v_mfma_f32_32x32x16_bf16 v[32:47], a[104:107], v[212:215], v[32:47]
    ds_read_b128 a[88:91], v226 offset:22528
    buffer_load_dwordx4 v224, s[12:15], s46 offen offset:3072  lds
    v_mfma_f32_32x32x16_bf16 v[48:63], a[108:111], v[212:215], v[48:63]
    ds_read_b128 a[92:95], v226 offset:23552
    s_add_u32 m0, s35, s7
    s_waitcnt lgkmcnt(8)
    v_mfma_f32_32x32x16_bf16 v[64:79], a[112:115], v[212:215], v[64:79]
    ds_read_b128 a[96:99], v226 offset:24576
    s_add_u32 s46, s46, 4096
    v_mfma_f32_32x32x16_bf16 v[80:95], a[116:119], v[212:215], v[80:95]
    ds_read_b128 a[100:103], v226 offset:25600
    s_add_u32 m0, m0, 4096
    v_mfma_f32_32x32x16_bf16 v[96:111], a[120:123], v[212:215], v[96:111]
    ds_read_b128 a[104:107], v226 offset:26624
    s_nop 0
    v_mfma_f32_32x32x16_bf16 v[112:127], a[124:127], v[212:215], v[112:127]
    ds_read_b128 a[108:111], v226 offset:27648
    buffer_load_dwordx4 v224, s[12:15], s46 offen offset:0  lds
    s_waitcnt lgkmcnt(8)
    v_mfma_f32_32x32x16_bf16 v[0:15], a[64:67], v[216:219], v[0:15]
    ds_read_b128 a[112:115], v226 offset:28672
    buffer_load_dwordx4 v224, s[12:15], s46 offen offset:1024  lds
    v_mfma_f32_32x32x16_bf16 v[16:31], a[68:71], v[216:219], v[16:31]
    ds_read_b128 a[116:119], v226 offset:29696
    buffer_load_dwordx4 v224, s[12:15], s46 offen offset:2048  lds
    v_mfma_f32_32x32x16_bf16 v[32:47], a[72:75], v[216:219], v[32:47]
    ds_read_b128 a[120:123], v226 offset:30720
    buffer_load_dwordx4 v224, s[12:15], s46 offen offset:3072  lds
    v_mfma_f32_32x32x16_bf16 v[48:63], a[76:79], v[216:219], v[48:63]
    ds_read_b128 a[124:127], v226 offset:31744
    s_add_u32 s39, s39, 1
    s_waitcnt lgkmcnt(8)
    v_mfma_f32_32x32x16_bf16 v[64:79], a[80:83], v[216:219], v[64:79]
    s_add_u32 s35, s35, 32768
    s_add_u32 s37, s37, 32768
    s_cmp_eq_u32 s37, 98304
    s_cselect_b32 s37, 0, s37
    v_mfma_f32_32x32x16_bf16 v[80:95], a[84:87], v[216:219], v[80:95]
    s_cmp_eq_u32 s35, 98304
    s_cselect_b32 s35, 0, s35
    s_add_u32 s42, s37, 65536
    v_add_u32 v226, s42, v224
    v_mfma_f32_32x32x16_bf16 v[96:111], a[88:91], v[216:219], v[96:111]
    s_add_u32 s31, s31, 1
    v_mfma_f32_32x32x16_bf16 v[112:127], a[92:95], v[216:219], v[112:127]
    s_waitcnt vmcnt(8) lgkmcnt(0)
    s_barrier
    v_mfma_f32_32x32x16_bf16 v[0:15], a[96:99], v[220:223], v[0:15]
    ds_read_b128 a[64:67], v225 offset:0
    ds_read_b128 a[68:71], v225 offset:1024
    s_cmp_lt_u32 s38, s73
    s_cselect_b32 s10, 1048576, 0
    s_sub_u32 s45, s38, s74
    v_mfma_f32_32x32x16_bf16 v[16:31], a[100:103], v[220:223], v[16:31]
    ds_read_b128 a[72:75], v225 offset:2048
    ds_read_b128 a[76:79], v225 offset:3072
    s_add_u32 s44, s38, s75
    s_cmp_lt_u32 s38, s74
    s_cselect_b32 s45, s44, s45
    v_mfma_f32_32x32x16_bf16 v[32:47], a[104:107], v[220:223], v[32:47]
    ds_read_b128 a[80:83], v225 offset:4096
    ds_read_b128 a[84:87], v225 offset:5120
    s_lshl_b32 s45, s45, 15
    v_mfma_f32_32x32x16_bf16 v[48:63], a[108:111], v[220:223], v[48:63]
    ds_read_b128 a[88:91], v225 offset:6144
    ds_read_b128 a[92:95], v225 offset:7168
    s_add_u32 m0, s34, s40
    s_add_u32 s45, s45, s40
    v_mfma_f32_32x32x16_bf16 v[64:79], a[112:115], v[220:223], v[64:79]
    ds_read_b128 a[96:99], v225 offset:8192
    buffer_load_dwordx4 v224, s[8:11], s45 offen offset:0  lds
    v_mfma_f32_32x32x16_bf16 v[80:95], a[116:119], v[220:223], v[80:95]
    ds_read_b128 a[100:103], v225 offset:9216
    buffer_load_dwordx4 v224, s[8:11], s45 offen offset:1024  lds
    buffer_load_dwordx4 v224, s[8:11], s45 offen offset:2048  lds
    v_mfma_f32_32x32x16_bf16 v[96:111], a[120:123], v[220:223], v[96:111]
    ds_read_b128 a[104:107], v225 offset:10240
    buffer_load_dwordx4 v224, s[8:11], s45 offen offset:3072  lds
    v_mfma_f32_32x32x16_bf16 v[112:127], a[124:127], v[220:223], v[112:127]
    ds_read_b128 a[108:111], v225 offset:11264
    s_cmp_lt_u32 s31, s6
    s_cbranch_scc1 attn_kernel_body_1_0_1
    s_branch attn_kernel_dispatch1
attn_kernel_body_0_1_1:
    s_waitcnt lgkmcnt(8)
    v_mfma_f32_32x32x16_bf16 v[160:175], a[64:67], a[0:3], v[192:207]
    ds_read_b128 a[112:115], v225 offset:12288
    s_lshl_b32 s41, s31, 6
    v_subrev_u32 v243, s41, v242
    v_subrev_u32 v244, 32, v243
    v_cmp_ge_i32 s[52:53], v243, 0
    v_cmp_ge_i32 s[54:55], v243, 1
    v_cmp_ge_i32 s[56:57], v243, 2
    v_mfma_f32_32x32x16_bf16 v[160:175], a[68:71], a[4:7], v[160:175]
    ds_read_b128 a[116:119], v225 offset:13312
    s_add_u32 m0, s34, s40
    v_cmp_ge_i32 s[58:59], v243, 3
    v_cndmask_b32 v128, v245, v128, s[52:53]
    v_cmp_ge_i32 s[52:53], v243, 8
    v_cndmask_b32 v129, v245, v129, s[54:55]
    v_cmp_ge_i32 s[54:55], v243, 9
    v_mfma_f32_32x32x16_bf16 v[160:175], a[72:75], a[8:11], v[160:175]
    ds_read_b128 a[120:123], v225 offset:14336
    s_add_u32 s45, s45, 4096
    v_cndmask_b32 v130, v245, v130, s[56:57]
    v_cmp_ge_i32 s[56:57], v243, 10
    v_cndmask_b32 v131, v245, v131, s[58:59]
    v_cmp_ge_i32 s[58:59], v243, 11
    v_cndmask_b32 v132, v245, v132, s[52:53]
    v_cmp_ge_i32 s[52:53], v243, 16
    v_mfma_f32_32x32x16_bf16 v[160:175], a[76:79], a[12:15], v[160:175]
    ds_read_b128 a[124:127], v225 offset:15360
    s_add_u32 m0, m0, 4096
    v_cndmask_b32 v133, v245, v133, s[54:55]
    v_cmp_ge_i32 s[54:55], v243, 17
    v_cndmask_b32 v134, v245, v134, s[56:57]
    v_cmp_ge_i32 s[56:57], v243, 18
    v_cndmask_b32 v135, v245, v135, s[58:59]
    s_waitcnt lgkmcnt(8)
    v_mfma_f32_32x32x16_bf16 v[160:175], a[80:83], a[16:19], v[160:175]
    ds_read_b128 a[64:67], v225 offset:16384
    v_cmp_ge_i32 s[58:59], v243, 19
    v_cndmask_b32 v136, v245, v136, s[52:53]
    v_cmp_ge_i32 s[52:53], v243, 24
    v_cndmask_b32 v137, v245, v137, s[54:55]
    v_cmp_ge_i32 s[54:55], v243, 25
    v_cndmask_b32 v138, v245, v138, s[56:57]
    v_mfma_f32_32x32x16_bf16 v[160:175], a[84:87], a[20:23], v[160:175]
    ds_read_b128 a[68:71], v225 offset:17408
    s_nop 0
    v_cmp_ge_i32 s[56:57], v243, 26
    v_cndmask_b32 v139, v245, v139, s[58:59]
    v_cmp_ge_i32 s[58:59], v243, 27
    v_cndmask_b32 v140, v245, v140, s[52:53]
    v_cmp_ge_i32 s[52:53], v244, 0
    v_mfma_f32_32x32x16_bf16 v[160:175], a[88:91], a[24:27], v[160:175]
    ds_read_b128 a[72:75], v225 offset:18432
    buffer_load_dwordx4 v224, s[8:11], s45 offen offset:0  lds
    v_cndmask_b32 v141, v245, v141, s[54:55]
    v_cmp_ge_i32 s[54:55], v244, 1
    v_cndmask_b32 v142, v245, v142, s[56:57]
    v_cmp_ge_i32 s[56:57], v244, 2
    v_cndmask_b32 v143, v245, v143, s[58:59]
    v_cmp_ge_i32 s[58:59], v244, 3
    v_mfma_f32_32x32x16_bf16 v[160:175], a[92:95], a[28:31], v[160:175]
    ds_read_b128 a[76:79], v225 offset:19456
    v_cndmask_b32 v144, v245, v144, s[52:53]
    v_cmp_ge_i32 s[52:53], v244, 8
    v_cndmask_b32 v145, v245, v145, s[54:55]
    v_cmp_ge_i32 s[54:55], v244, 9
    v_cndmask_b32 v146, v245, v146, s[56:57]
    v_cmp_ge_i32 s[56:57], v244, 10
    s_waitcnt lgkmcnt(8)
    v_mfma_f32_32x32x16_bf16 v[160:175], a[96:99], a[32:35], v[160:175]
    ds_read_b128 a[80:83], v225 offset:20480
    buffer_load_dwordx4 v224, s[8:11], s45 offen offset:1024  lds
    v_cndmask_b32 v147, v245, v147, s[58:59]
    v_cmp_ge_i32 s[58:59], v244, 11
    v_cndmask_b32 v148, v245, v148, s[52:53]
    v_cmp_ge_i32 s[52:53], v244, 16
    v_cndmask_b32 v149, v245, v149, s[54:55]
    v_mfma_f32_32x32x16_bf16 v[160:175], a[100:103], a[36:39], v[160:175]
    ds_read_b128 a[84:87], v225 offset:21504
    buffer_load_dwordx4 v224, s[8:11], s45 offen offset:2048  lds
    v_cmp_ge_i32 s[54:55], v244, 17
    v_cndmask_b32 v150, v245, v150, s[56:57]
    v_cmp_ge_i32 s[56:57], v244, 18
    v_cndmask_b32 v151, v245, v151, s[58:59]
    v_cmp_ge_i32 s[58:59], v244, 19
    v_mfma_f32_32x32x16_bf16 v[160:175], a[104:107], a[40:43], v[160:175]
    ds_read_b128 a[88:91], v225 offset:22528
    buffer_load_dwordx4 v224, s[8:11], s45 offen offset:3072  lds
    v_cndmask_b32 v152, v245, v152, s[52:53]
    v_cmp_ge_i32 s[52:53], v244, 24
    v_cndmask_b32 v153, v245, v153, s[54:55]
    v_cmp_ge_i32 s[54:55], v244, 25
    v_cndmask_b32 v154, v245, v154, s[56:57]
    v_cmp_ge_i32 s[56:57], v244, 26
    v_mfma_f32_32x32x16_bf16 v[160:175], a[108:111], a[44:47], v[160:175]
    ds_read_b128 a[92:95], v225 offset:23552
    v_cndmask_b32 v155, v245, v155, s[58:59]
    v_cmp_ge_i32 s[58:59], v244, 27
    v_cndmask_b32 v156, v245, v156, s[52:53]
    s_nop 1
    v_cndmask_b32 v157, v245, v157, s[54:55]
    v_cndmask_b32 v158, v245, v158, s[56:57]
    s_waitcnt lgkmcnt(8)
    v_mfma_f32_32x32x16_bf16 v[160:175], a[112:115], a[48:51], v[160:175]
    ds_read_b128 a[96:99], v225 offset:24576
    s_add_u32 s38, s38, 1
    v_cndmask_b32 v159, v245, v159, s[58:59]
    v_exp_f32 v234, v128
    v_exp_f32 v235, v129
    v_mfma_f32_32x32x16_bf16 v[160:175], a[116:119], a[52:55], v[160:175]
    ds_read_b128 a[100:103], v225 offset:25600
    s_xor_b32 s34, s34, 32768
    v_exp_f32 v236, v130
    v_exp_f32 v237, v131
    v_mov_b32 v229, v234
    v_mfma_f32_32x32x16_bf16 v[160:175], a[120:123], a[56:59], v[160:175]
    ds_read_b128 a[104:107], v225 offset:26624
    v_mov_b32 v230, v235
    v_cvt_pk_bf16_f32 v208, v234, v235
    v_exp_f32 v238, v132
    v_exp_f32 v239, v133
    v_mov_b32 v231, v236
    v_mfma_f32_32x32x16_bf16 v[160:175], a[124:127], a[60:63], v[160:175]
    ds_read_b128 a[108:111], v225 offset:27648
    v_mov_b32 v232, v237
    v_cvt_pk_bf16_f32 v209, v236, v237
    v_exp_f32 v240, v134
    v_exp_f32 v241, v135
    s_waitcnt lgkmcnt(8)
    v_mfma_f32_32x32x16_bf16 v[176:191], a[64:67], a[0:3], v[192:207]
    ds_read_b128 a[112:115], v225 offset:28672
    v_add_f32 v229, v229, v238
    v_add_f32 v230, v230, v239
    v_cvt_pk_bf16_f32 v210, v238, v239
    v_exp_f32 v234, v136
    v_mfma_f32_32x32x16_bf16 v[176:191], a[68:71], a[4:7], v[176:191]
    ds_read_b128 a[116:119], v225 offset:29696
    v_exp_f32 v235, v137
    v_add_f32 v231, v231, v240
    v_add_f32 v232, v232, v241
    v_cvt_pk_bf16_f32 v211, v240, v241
    v_exp_f32 v236, v138
    v_mfma_f32_32x32x16_bf16 v[176:191], a[72:75], a[8:11], v[176:191]
    ds_read_b128 a[120:123], v225 offset:30720
    v_exp_f32 v237, v139
    v_add_f32 v229, v229, v234
    v_add_f32 v230, v230, v235
    v_cvt_pk_bf16_f32 v212, v234, v235
    v_exp_f32 v238, v140
    v_mfma_f32_32x32x16_bf16 v[176:191], a[76:79], a[12:15], v[176:191]
    ds_read_b128 a[124:127], v225 offset:31744
    v_exp_f32 v239, v141
    v_add_f32 v231, v231, v236
    v_add_f32 v232, v232, v237
    v_cvt_pk_bf16_f32 v213, v236, v237
    v_exp_f32 v240, v142
    s_waitcnt lgkmcnt(8)
    v_mfma_f32_32x32x16_bf16 v[176:191], a[80:83], a[16:19], v[176:191]
    ds_read_b128 a[64:67], v226 offset:0
    v_exp_f32 v241, v143
    v_add_f32 v229, v229, v238
    v_add_f32 v230, v230, v239
    v_cvt_pk_bf16_f32 v214, v238, v239
    v_mfma_f32_32x32x16_bf16 v[176:191], a[84:87], a[20:23], v[176:191]
    ds_read_b128 a[68:71], v226 offset:1024
    v_exp_f32 v234, v144
    v_exp_f32 v235, v145
    v_add_f32 v231, v231, v240
    v_add_f32 v232, v232, v241
    v_mfma_f32_32x32x16_bf16 v[176:191], a[88:91], a[24:27], v[176:191]
    ds_read_b128 a[72:75], v226 offset:2048
    v_cvt_pk_bf16_f32 v215, v240, v241
    v_exp_f32 v236, v146
    v_exp_f32 v237, v147
    v_add_f32 v229, v229, v234
    v_add_f32 v230, v230, v235
    v_mfma_f32_32x32x16_bf16 v[176:191], a[92:95], a[28:31], v[176:191]
    ds_read_b128 a[76:79], v226 offset:3072
    v_cvt_pk_bf16_f32 v216, v234, v235
    v_exp_f32 v238, v148
    v_exp_f32 v239, v149
    v_add_f32 v231, v231, v236
    s_waitcnt lgkmcnt(8)
    v_mfma_f32_32x32x16_bf16 v[176:191], a[96:99], a[32:35], v[176:191]
    ds_read_b128 a[80:83], v226 offset:4096
    v_add_f32 v232, v232, v237
    v_cvt_pk_bf16_f32 v217, v236, v237
    v_exp_f32 v240, v150
    v_exp_f32 v241, v151
    v_mfma_f32_32x32x16_bf16 v[176:191], a[100:103], a[36:39], v[176:191]
    ds_read_b128 a[84:87], v226 offset:5120
    v_add_f32 v229, v229, v238
    v_add_f32 v230, v230, v239
    v_cvt_pk_bf16_f32 v218, v238, v239
    v_exp_f32 v234, v152
    v_exp_f32 v235, v153
    v_mfma_f32_32x32x16_bf16 v[176:191], a[104:107], a[40:43], v[176:191]
    ds_read_b128 a[88:91], v226 offset:6144
    v_add_f32 v231, v231, v240
    v_add_f32 v232, v232, v241
    v_cvt_pk_bf16_f32 v219, v240, v241
    v_exp_f32 v236, v154
    v_mfma_f32_32x32x16_bf16 v[176:191], a[108:111], a[44:47], v[176:191]
    ds_read_b128 a[92:95], v226 offset:7168
    v_exp_f32 v237, v155
    v_add_f32 v229, v229, v234
    v_add_f32 v230, v230, v235
    v_cvt_pk_bf16_f32 v220, v234, v235
    v_exp_f32 v238, v156
    s_waitcnt lgkmcnt(8)
    v_mfma_f32_32x32x16_bf16 v[176:191], a[112:115], a[48:51], v[176:191]
    ds_read_b128 a[96:99], v226 offset:8192
    v_exp_f32 v239, v157
    v_add_f32 v231, v231, v236
    v_add_f32 v232, v232, v237
    v_cvt_pk_bf16_f32 v221, v236, v237
    v_mfma_f32_32x32x16_bf16 v[176:191], a[116:119], a[52:55], v[176:191]
    ds_read_b128 a[100:103], v226 offset:9216
    v_exp_f32 v240, v158
    v_exp_f32 v241, v159
    v_add_f32 v229, v229, v238
    v_add_f32 v230, v230, v239
    v_cvt_pk_bf16_f32 v222, v238, v239
    v_mfma_f32_32x32x16_bf16 v[176:191], a[120:123], a[56:59], v[176:191]
    ds_read_b128 a[104:107], v226 offset:10240
    s_nop 0
    v_add_f32 v231, v231, v240
    v_add_f32 v232, v232, v241
    v_cvt_pk_bf16_f32 v223, v240, v241
    v_add_f32 v229, v229, v230
    v_add_f32 v231, v231, v232
    v_add_f32 v229, v229, v231
    v_mfma_f32_32x32x16_bf16 v[176:191], a[124:127], a[60:63], v[176:191]
    ds_read_b128 a[108:111], v226 offset:11264
    s_waitcnt lgkmcnt(8)
    v_cmp_lt_f32 vcc, s51, v229
    s_mov_b32 s49, 5
    s_cbranch_vccnz attn_kernel_slow0
attn_kernel_ret5:
    v_add_f32 v228, v228, v229
    v_mfma_f32_32x32x16_bf16 v[0:15], a[64:67], v[208:211], v[0:15]
    ds_read_b128 a[112:115], v226 offset:12288
    s_cmp_lt_u32 s39, s73
    s_cselect_b32 s14, 1048576, 0
    v_mfma_f32_32x32x16_bf16 v[16:31], a[68:71], v[208:211], v[16:31]
    ds_read_b128 a[116:119], v226 offset:13312
    s_sub_u32 s46, s39, s74
    s_xor_b32 s36, s36, 32768
    v_mfma_f32_32x32x16_bf16 v[32:47], a[72:75], v[208:211], v[32:47]
    ds_read_b128 a[120:123], v226 offset:14336
    s_add_u32 s44, s39, s75
    v_add_u32 v225, s36, v224
    v_mfma_f32_32x32x16_bf16 v[48:63], a[76:79], v[208:211], v[48:63]
    ds_read_b128 a[124:127], v226 offset:15360
    s_cmp_lt_u32 s39, s74
    s_cselect_b32 s46, s44, s46
    s_waitcnt lgkmcnt(8)
    v_mfma_f32_32x32x16_bf16 v[64:79], a[80:83], v[208:211], v[64:79]
    ds_read_b128 a[64:67], v226 offset:16384
    s_lshl_b32 s46, s46, 15
    v_mfma_f32_32x32x16_bf16 v[80:95], a[84:87], v[208:211], v[80:95]
    ds_read_b128 a[68:71], v226 offset:17408
    s_add_u32 m0, s35, s7
    v_mfma_f32_32x32x16_bf16 v[96:111], a[88:91], v[208:211], v[96:111]
    ds_read_b128 a[72:75], v226 offset:18432
    s_add_u32 s46, s46, s40
    v_mfma_f32_32x32x16_bf16 v[112:127], a[92:95], v[208:211], v[112:127]
    ds_read_b128 a[76:79], v226 offset:19456
    buffer_load_dwordx4 v224, s[12:15], s46 offen offset:0  lds
    s_waitcnt lgkmcnt(8)
    v_mfma_f32_32x32x16_bf16 v[0:15], a[96:99], v[212:215], v[0:15]
    ds_read_b128 a[80:83], v226 offset:20480
    buffer_load_dwordx4 v224, s[12:15], s46 offen offset:1024  lds
    v_mfma_f32_32x32x16_bf16 v[16:31], a[100:103], v[212:215], v[16:31]
    ds_read_b128 a[84:87], v226 offset:21504
    buffer_load_dwordx4 v224, s[12:15], s46 offen offset:2048  lds
    v_mfma_f32_32x32x16_bf16 v[32:47], a[104:107], v[212:215], v[32:47]
    ds_read_b128 a[88:91], v226 offset:22528
    buffer_load_dwordx4 v224, s[12:15], s46 offen offset:3072  lds
    v_mfma_f32_32x32x16_bf16 v[48:63], a[108:111], v[212:215], v[48:63]
    ds_read_b128 a[92:95], v226 offset:23552
    s_add_u32 m0, s35, s7
    s_waitcnt lgkmcnt(8)
    v_mfma_f32_32x32x16_bf16 v[64:79], a[112:115], v[212:215], v[64:79]
    ds_read_b128 a[96:99], v226 offset:24576
    s_add_u32 s46, s46, 4096
    v_mfma_f32_32x32x16_bf16 v[80:95], a[116:119], v[212:215], v[80:95]
    ds_read_b128 a[100:103], v226 offset:25600
    s_add_u32 m0, m0, 4096
    v_mfma_f32_32x32x16_bf16 v[96:111], a[120:123], v[212:215], v[96:111]
    ds_read_b128 a[104:107], v226 offset:26624
    s_nop 0
    v_mfma_f32_32x32x16_bf16 v[112:127], a[124:127], v[212:215], v[112:127]
    ds_read_b128 a[108:111], v226 offset:27648
    buffer_load_dwordx4 v224, s[12:15], s46 offen offset:0  lds
    s_waitcnt lgkmcnt(8)
    v_mfma_f32_32x32x16_bf16 v[0:15], a[64:67], v[216:219], v[0:15]
    ds_read_b128 a[112:115], v226 offset:28672
    buffer_load_dwordx4 v224, s[12:15], s46 offen offset:1024  lds
    v_mfma_f32_32x32x16_bf16 v[16:31], a[68:71], v[216:219], v[16:31]
    ds_read_b128 a[116:119], v226 offset:29696
    buffer_load_dwordx4 v224, s[12:15], s46 offen offset:2048  lds
    v_mfma_f32_32x32x16_bf16 v[32:47], a[72:75], v[216:219], v[32:47]
    ds_read_b128 a[120:123], v226 offset:30720
    buffer_load_dwordx4 v224, s[12:15], s46 offen offset:3072  lds
    v_mfma_f32_32x32x16_bf16 v[48:63], a[76:79], v[216:219], v[48:63]
    ds_read_b128 a[124:127], v226 offset:31744
    s_add_u32 s39, s39, 1
    s_waitcnt lgkmcnt(8)
    v_mfma_f32_32x32x16_bf16 v[64:79], a[80:83], v[216:219], v[64:79]
    s_add_u32 s35, s35, 32768
    s_add_u32 s37, s37, 32768
    s_cmp_eq_u32 s37, 98304
    s_cselect_b32 s37, 0, s37
    v_mfma_f32_32x32x16_bf16 v[80:95], a[84:87], v[216:219], v[80:95]
    s_cmp_eq_u32 s35, 98304
    s_cselect_b32 s35, 0, s35
    s_add_u32 s42, s37, 65536
    v_add_u32 v226, s42, v224
    v_mfma_f32_32x32x16_bf16 v[96:111], a[88:91], v[216:219], v[96:111]
    s_add_u32 s31, s31, 1
    v_mfma_f32_32x32x16_bf16 v[112:127], a[92:95], v[216:219], v[112:127]
    s_waitcnt vmcnt(8) lgkmcnt(0)
    s_barrier
    v_mfma_f32_32x32x16_bf16 v[0:15], a[96:99], v[220:223], v[0:15]
    ds_read_b128 a[64:67], v225 offset:0
    ds_read_b128 a[68:71], v225 offset:1024
    s_cmp_lt_u32 s38, s73
    s_cselect_b32 s10, 1048576, 0
    s_sub_u32 s45, s38, s74
    v_mfma_f32_32x32x16_bf16 v[16:31], a[100:103], v[220:223], v[16:31]
    ds_read_b128 a[72:75], v225 offset:2048
    ds_read_b128 a[76:79], v225 offset:3072
    s_add_u32 s44, s38, s75
    s_cmp_lt_u32 s38, s74
    s_cselect_b32 s45, s44, s45
    v_mfma_f32_32x32x16_bf16 v[32:47], a[104:107], v[220:223], v[32:47]
    ds_read_b128 a[80:83], v225 offset:4096
    ds_read_b128 a[84:87], v225 offset:5120
    s_lshl_b32 s45, s45, 15
    v_mfma_f32_32x32x16_bf16 v[48:63], a[108:111], v[220:223], v[48:63]
    ds_read_b128 a[88:91], v225 offset:6144
    ds_read_b128 a[92:95], v225 offset:7168
    s_add_u32 m0, s34, s40
    s_add_u32 s45, s45, s40
    v_mfma_f32_32x32x16_bf16 v[64:79], a[112:115], v[220:223], v[64:79]
    ds_read_b128 a[96:99], v225 offset:8192
    buffer_load_dwordx4 v224, s[8:11], s45 offen offset:0  lds
    v_mfma_f32_32x32x16_bf16 v[80:95], a[116:119], v[220:223], v[80:95]
    ds_read_b128 a[100:103], v225 offset:9216
    buffer_load_dwordx4 v224, s[8:11], s45 offen offset:1024  lds
    buffer_load_dwordx4 v224, s[8:11], s45 offen offset:2048  lds
    v_mfma_f32_32x32x16_bf16 v[96:111], a[120:123], v[220:223], v[96:111]
    ds_read_b128 a[104:107], v225 offset:10240
    buffer_load_dwordx4 v224, s[8:11], s45 offen offset:3072  lds
    v_mfma_f32_32x32x16_bf16 v[112:127], a[124:127], v[220:223], v[112:127]
    ds_read_b128 a[108:111], v225 offset:11264
    s_branch attn_kernel_dispatch1
attn_kernel_body_0_1_2:
    s_waitcnt lgkmcnt(8)
    v_mfma_f32_32x32x16_bf16 v[160:175], a[64:67], a[128:131], 0
    ds_read_b128 a[112:115], v225 offset:12288
    s_lshl_b32 s41, s31, 6
    v_subrev_u32 v243, s41, v242
    v_subrev_u32 v244, 32, v243
    v_cmp_ge_i32 s[52:53], v243, 0
    v_cmp_ge_i32 s[54:55], v243, 1
    v_cmp_ge_i32 s[56:57], v243, 2
    v_mfma_f32_32x32x16_bf16 v[160:175], a[68:71], a[132:135], v[160:175]
    ds_read_b128 a[116:119], v225 offset:13312
    s_add_u32 m0, s34, s40
    v_cmp_ge_i32 s[58:59], v243, 3
    v_cndmask_b32 v128, v245, v128, s[52:53]
    v_cmp_ge_i32 s[52:53], v243, 8
    v_cndmask_b32 v129, v245, v129, s[54:55]
    v_cmp_ge_i32 s[54:55], v243, 9
    v_mfma_f32_32x32x16_bf16 v[160:175], a[72:75], a[136:139], v[160:175]
    ds_read_b128 a[120:123], v225 offset:14336
    s_add_u32 s45, s45, 4096
    v_cndmask_b32 v130, v245, v130, s[56:57]
    v_cmp_ge_i32 s[56:57], v243, 10
    v_cndmask_b32 v131, v245, v131, s[58:59]
    v_cmp_ge_i32 s[58:59], v243, 11
    v_cndmask_b32 v132, v245, v132, s[52:53]
    v_cmp_ge_i32 s[52:53], v243, 16
    v_mfma_f32_32x32x16_bf16 v[160:175], a[76:79], a[140:143], v[160:175]
    ds_read_b128 a[124:127], v225 offset:15360
    s_add_u32 m0, m0, 4096
    v_cndmask_b32 v133, v245, v133, s[54:55]
    v_cmp_ge_i32 s[54:55], v243, 17
    v_cndmask_b32 v134, v245, v134, s[56:57]
    v_cmp_ge_i32 s[56:57], v243, 18
    v_cndmask_b32 v135, v245, v135, s[58:59]
    s_waitcnt lgkmcnt(8)
    v_mfma_f32_32x32x16_bf16 v[160:175], a[80:83], a[144:147], v[160:175]
    ds_read_b128 a[64:67], v225 offset:16384
    v_cmp_ge_i32 s[58:59], v243, 19
    v_cndmask_b32 v136, v245, v136, s[52:53]
    v_cmp_ge_i32 s[52:53], v243, 24
    v_cndmask_b32 v137, v245, v137, s[54:55]
    v_cmp_ge_i32 s[54:55], v243, 25
    v_cndmask_b32 v138, v245, v138, s[56:57]
    v_mfma_f32_32x32x16_bf16 v[160:175], a[84:87], a[148:151], v[160:175]
    ds_read_b128 a[68:71], v225 offset:17408
    s_nop 0
    v_cmp_ge_i32 s[56:57], v243, 26
    v_cndmask_b32 v139, v245, v139, s[58:59]
    v_cmp_ge_i32 s[58:59], v243, 27
    v_cndmask_b32 v140, v245, v140, s[52:53]
    v_cmp_ge_i32 s[52:53], v244, 0
    v_mfma_f32_32x32x16_bf16 v[160:175], a[88:91], a[152:155], v[160:175]
    ds_read_b128 a[72:75], v225 offset:18432
    buffer_load_dwordx4 v224, s[8:11], s45 offen offset:0  lds
    v_cndmask_b32 v141, v245, v141, s[54:55]
    v_cmp_ge_i32 s[54:55], v244, 1
    v_cndmask_b32 v142, v245, v142, s[56:57]
    v_cmp_ge_i32 s[56:57], v244, 2
    v_cndmask_b32 v143, v245, v143, s[58:59]
    v_cmp_ge_i32 s[58:59], v244, 3
    v_mfma_f32_32x32x16_bf16 v[160:175], a[92:95], a[156:159], v[160:175]
    ds_read_b128 a[76:79], v225 offset:19456
    v_cndmask_b32 v144, v245, v144, s[52:53]
    v_cmp_ge_i32 s[52:53], v244, 8
    v_cndmask_b32 v145, v245, v145, s[54:55]
    v_cmp_ge_i32 s[54:55], v244, 9
    v_cndmask_b32 v146, v245, v146, s[56:57]
    v_cmp_ge_i32 s[56:57], v244, 10
    s_waitcnt lgkmcnt(8)
    v_mfma_f32_32x32x16_bf16 v[160:175], a[96:99], a[160:163], v[160:175]
    ds_read_b128 a[80:83], v225 offset:20480
    buffer_load_dwordx4 v224, s[8:11], s45 offen offset:1024  lds
    v_cndmask_b32 v147, v245, v147, s[58:59]
    v_cmp_ge_i32 s[58:59], v244, 11
    v_cndmask_b32 v148, v245, v148, s[52:53]
    v_cmp_ge_i32 s[52:53], v244, 16
    v_cndmask_b32 v149, v245, v149, s[54:55]
    v_mfma_f32_32x32x16_bf16 v[160:175], a[100:103], a[164:167], v[160:175]
    ds_read_b128 a[84:87], v225 offset:21504
    buffer_load_dwordx4 v224, s[8:11], s45 offen offset:2048  lds
    v_cmp_ge_i32 s[54:55], v244, 17
    v_cndmask_b32 v150, v245, v150, s[56:57]
    v_cmp_ge_i32 s[56:57], v244, 18
    v_cndmask_b32 v151, v245, v151, s[58:59]
    v_cmp_ge_i32 s[58:59], v244, 19
    v_mfma_f32_32x32x16_bf16 v[160:175], a[104:107], a[168:171], v[160:175]
    ds_read_b128 a[88:91], v225 offset:22528
    buffer_load_dwordx4 v224, s[8:11], s45 offen offset:3072  lds
    v_cndmask_b32 v152, v245, v152, s[52:53]
    v_cmp_ge_i32 s[52:53], v244, 24
    v_cndmask_b32 v153, v245, v153, s[54:55]
    v_cmp_ge_i32 s[54:55], v244, 25
    v_cndmask_b32 v154, v245, v154, s[56:57]
    v_cmp_ge_i32 s[56:57], v244, 26
    v_mfma_f32_32x32x16_bf16 v[160:175], a[108:111], a[172:175], v[160:175]
    ds_read_b128 a[92:95], v225 offset:23552
    v_cndmask_b32 v155, v245, v155, s[58:59]
    v_cmp_ge_i32 s[58:59], v244, 27
    v_cndmask_b32 v156, v245, v156, s[52:53]
    s_nop 1
    v_cndmask_b32 v157, v245, v157, s[54:55]
    v_cndmask_b32 v158, v245, v158, s[56:57]
    s_waitcnt lgkmcnt(8)
    v_mfma_f32_32x32x16_bf16 v[160:175], a[112:115], a[176:179], v[160:175]
    ds_read_b128 a[96:99], v225 offset:24576
    s_add_u32 s38, s38, 1
    v_cndmask_b32 v159, v245, v159, s[58:59]
    v_exp_f32 v234, v128
    v_exp_f32 v235, v129
    v_mfma_f32_32x32x16_bf16 v[160:175], a[116:119], a[180:183], v[160:175]
    ds_read_b128 a[100:103], v225 offset:25600
    s_xor_b32 s34, s34, 32768
    v_exp_f32 v236, v130
    v_exp_f32 v237, v131
    v_mov_b32 v229, v234
    v_mfma_f32_32x32x16_bf16 v[160:175], a[120:123], a[184:187], v[160:175]
    ds_read_b128 a[104:107], v225 offset:26624
    v_mov_b32 v230, v235
    v_cvt_pk_bf16_f32 v208, v234, v235
    v_exp_f32 v238, v132
    v_exp_f32 v239, v133
    v_mov_b32 v231, v236
    v_mfma_f32_32x32x16_bf16 v[160:175], a[124:127], a[188:191], v[160:175]
    ds_read_b128 a[108:111], v225 offset:27648
    v_mov_b32 v232, v237
    v_cvt_pk_bf16_f32 v209, v236, v237
    v_exp_f32 v240, v134
    v_exp_f32 v241, v135
    s_waitcnt lgkmcnt(8)
    v_mfma_f32_32x32x16_bf16 v[176:191], a[64:67], a[128:131], 0
    ds_read_b128 a[112:115], v225 offset:28672
    v_add_f32 v229, v229, v238
    v_add_f32 v230, v230, v239
    v_cvt_pk_bf16_f32 v210, v238, v239
    v_exp_f32 v234, v136
    v_mfma_f32_32x32x16_bf16 v[176:191], a[68:71], a[132:135], v[176:191]
    ds_read_b128 a[116:119], v225 offset:29696
    v_exp_f32 v235, v137
    v_add_f32 v231, v231, v240
    v_add_f32 v232, v232, v241
    v_cvt_pk_bf16_f32 v211, v240, v241
    v_exp_f32 v236, v138
    v_mfma_f32_32x32x16_bf16 v[176:191], a[72:75], a[136:139], v[176:191]
    ds_read_b128 a[120:123], v225 offset:30720
    v_exp_f32 v237, v139
    v_add_f32 v229, v229, v234
    v_add_f32 v230, v230, v235
    v_cvt_pk_bf16_f32 v212, v234, v235
    v_exp_f32 v238, v140
    v_mfma_f32_32x32x16_bf16 v[176:191], a[76:79], a[140:143], v[176:191]
    ds_read_b128 a[124:127], v225 offset:31744
    v_exp_f32 v239, v141
    v_add_f32 v231, v231, v236
    v_add_f32 v232, v232, v237
    v_cvt_pk_bf16_f32 v213, v236, v237
    v_exp_f32 v240, v142
    s_waitcnt lgkmcnt(8)
    v_mfma_f32_32x32x16_bf16 v[176:191], a[80:83], a[144:147], v[176:191]
    ds_read_b128 a[64:67], v226 offset:0
    v_exp_f32 v241, v143
    v_add_f32 v229, v229, v238
    v_add_f32 v230, v230, v239
    v_cvt_pk_bf16_f32 v214, v238, v239
    v_mfma_f32_32x32x16_bf16 v[176:191], a[84:87], a[148:151], v[176:191]
    ds_read_b128 a[68:71], v226 offset:1024
    v_exp_f32 v234, v144
    v_exp_f32 v235, v145
    v_add_f32 v231, v231, v240
    v_add_f32 v232, v232, v241
    v_mfma_f32_32x32x16_bf16 v[176:191], a[88:91], a[152:155], v[176:191]
    ds_read_b128 a[72:75], v226 offset:2048
    v_cvt_pk_bf16_f32 v215, v240, v241
    v_exp_f32 v236, v146
    v_exp_f32 v237, v147
    v_add_f32 v229, v229, v234
    v_add_f32 v230, v230, v235
    v_mfma_f32_32x32x16_bf16 v[176:191], a[92:95], a[156:159], v[176:191]
    ds_read_b128 a[76:79], v226 offset:3072
    v_cvt_pk_bf16_f32 v216, v234, v235
    v_exp_f32 v238, v148
    v_exp_f32 v239, v149
    v_add_f32 v231, v231, v236
    s_waitcnt lgkmcnt(8)
    v_mfma_f32_32x32x16_bf16 v[176:191], a[96:99], a[160:163], v[176:191]
    ds_read_b128 a[80:83], v226 offset:4096
    v_add_f32 v232, v232, v237
    v_cvt_pk_bf16_f32 v217, v236, v237
    v_exp_f32 v240, v150
    v_exp_f32 v241, v151
    v_mfma_f32_32x32x16_bf16 v[176:191], a[100:103], a[164:167], v[176:191]
    ds_read_b128 a[84:87], v226 offset:5120
    v_add_f32 v229, v229, v238
    v_add_f32 v230, v230, v239
    v_cvt_pk_bf16_f32 v218, v238, v239
    v_exp_f32 v234, v152
    v_exp_f32 v235, v153
    v_mfma_f32_32x32x16_bf16 v[176:191], a[104:107], a[168:171], v[176:191]
    ds_read_b128 a[88:91], v226 offset:6144
    v_add_f32 v231, v231, v240
    v_add_f32 v232, v232, v241
    v_cvt_pk_bf16_f32 v219, v240, v241
    v_exp_f32 v236, v154
    v_mfma_f32_32x32x16_bf16 v[176:191], a[108:111], a[172:175], v[176:191]
    ds_read_b128 a[92:95], v226 offset:7168
    v_exp_f32 v237, v155
    v_add_f32 v229, v229, v234
    v_add_f32 v230, v230, v235
    v_cvt_pk_bf16_f32 v220, v234, v235
    v_exp_f32 v238, v156
    s_waitcnt lgkmcnt(8)
    v_mfma_f32_32x32x16_bf16 v[176:191], a[112:115], a[176:179], v[176:191]
    ds_read_b128 a[96:99], v226 offset:8192
    v_exp_f32 v239, v157
    v_add_f32 v231, v231, v236
    v_add_f32 v232, v232, v237
    v_cvt_pk_bf16_f32 v221, v236, v237
    v_mfma_f32_32x32x16_bf16 v[176:191], a[116:119], a[180:183], v[176:191]
    ds_read_b128 a[100:103], v226 offset:9216
    v_exp_f32 v240, v158
    v_exp_f32 v241, v159
    v_add_f32 v229, v229, v238
    v_add_f32 v230, v230, v239
    v_cvt_pk_bf16_f32 v222, v238, v239
    v_mfma_f32_32x32x16_bf16 v[176:191], a[120:123], a[184:187], v[176:191]
    ds_read_b128 a[104:107], v226 offset:10240
    s_nop 0
    v_add_f32 v231, v231, v240
    v_add_f32 v232, v232, v241
    v_cvt_pk_bf16_f32 v223, v240, v241
    v_add_f32 v229, v229, v230
    v_add_f32 v231, v231, v232
    v_add_f32 v229, v229, v231
    v_mfma_f32_32x32x16_bf16 v[176:191], a[124:127], a[188:191], v[176:191]
    ds_read_b128 a[108:111], v226 offset:11264
    s_waitcnt lgkmcnt(8)
    v_cmp_lt_f32 vcc, s51, v229
    s_mov_b32 s49, 6
    s_cbranch_vccnz attn_kernel_slow0
attn_kernel_ret6:
    v_add_f32 v228, v228, v229
    v_mfma_f32_32x32x16_bf16 v[0:15], a[64:67], v[208:211], v[0:15]
    ds_read_b128 a[112:115], v226 offset:12288
    s_cmp_lt_u32 s39, s73
    s_cselect_b32 s14, 1048576, 0
    v_mfma_f32_32x32x16_bf16 v[16:31], a[68:71], v[208:211], v[16:31]
    ds_read_b128 a[116:119], v226 offset:13312
    s_sub_u32 s46, s39, s74
    s_xor_b32 s36, s36, 32768
    v_mfma_f32_32x32x16_bf16 v[32:47], a[72:75], v[208:211], v[32:47]
    ds_read_b128 a[120:123], v226 offset:14336
    s_add_u32 s44, s39, s75
    v_add_u32 v225, s36, v224
    v_mfma_f32_32x32x16_bf16 v[48:63], a[76:79], v[208:211], v[48:63]
    ds_read_b128 a[124:127], v226 offset:15360
    s_cmp_lt_u32 s39, s74
    s_cselect_b32 s46, s44, s46
    s_waitcnt lgkmcnt(8)
    v_mfma_f32_32x32x16_bf16 v[64:79], a[80:83], v[208:211], v[64:79]
    ds_read_b128 a[64:67], v226 offset:16384
    s_lshl_b32 s46, s46, 15
    v_mfma_f32_32x32x16_bf16 v[80:95], a[84:87], v[208:211], v[80:95]
    ds_read_b128 a[68:71], v226 offset:17408
    s_add_u32 m0, s35, s7
    v_mfma_f32_32x32x16_bf16 v[96:111], a[88:91], v[208:211], v[96:111]
    ds_read_b128 a[72:75], v226 offset:18432
    s_add_u32 s46, s46, s40
    v_mfma_f32_32x32x16_bf16 v[112:127], a[92:95], v[208:211], v[112:127]
    ds_read_b128 a[76:79], v226 offset:19456
    buffer_load_dwordx4 v224, s[12:15], s46 offen offset:0  lds
    s_waitcnt lgkmcnt(8)
    v_mfma_f32_32x32x16_bf16 v[0:15], a[96:99], v[212:215], v[0:15]
    ds_read_b128 a[80:83], v226 offset:20480
    buffer_load_dwordx4 v224, s[12:15], s46 offen offset:1024  lds
    v_mfma_f32_32x32x16_bf16 v[16:31], a[100:103], v[212:215], v[16:31]
    ds_read_b128 a[84:87], v226 offset:21504
    buffer_load_dwordx4 v224, s[12:15], s46 offen offset:2048  lds
    v_mfma_f32_32x32x16_bf16 v[32:47], a[104:107], v[212:215], v[32:47]
    ds_read_b128 a[88:91], v226 offset:22528
    buffer_load_dwordx4 v224, s[12:15], s46 offen offset:3072  lds
    v_mfma_f32_32x32x16_bf16 v[48:63], a[108:111], v[212:215], v[48:63]
    ds_read_b128 a[92:95], v226 offset:23552
    s_add_u32 m0, s35, s7
    s_waitcnt lgkmcnt(8)
    v_mfma_f32_32x32x16_bf16 v[64:79], a[112:115], v[212:215], v[64:79]
    ds_read_b128 a[96:99], v226 offset:24576
    s_add_u32 s46, s46, 4096
    v_mfma_f32_32x32x16_bf16 v[80:95], a[116:119], v[212:215], v[80:95]
    ds_read_b128 a[100:103], v226 offset:25600
    s_add_u32 m0, m0, 4096
    v_mfma_f32_32x32x16_bf16 v[96:111], a[120:123], v[212:215], v[96:111]
    ds_read_b128 a[104:107], v226 offset:26624
    s_nop 0
    v_mfma_f32_32x32x16_bf16 v[112:127], a[124:127], v[212:215], v[112:127]
    ds_read_b128 a[108:111], v226 offset:27648
    buffer_load_dwordx4 v224, s[12:15], s46 offen offset:0  lds
    s_waitcnt lgkmcnt(8)
    v_mfma_f32_32x32x16_bf16 v[0:15], a[64:67], v[216:219], v[0:15]
    ds_read_b128 a[112:115], v226 offset:28672
    buffer_load_dwordx4 v224, s[12:15], s46 offen offset:1024  lds
    v_mfma_f32_32x32x16_bf16 v[16:31], a[68:71], v[216:219], v[16:31]
    ds_read_b128 a[116:119], v226 offset:29696
    buffer_load_dwordx4 v224, s[12:15], s46 offen offset:2048  lds
    v_mfma_f32_32x32x16_bf16 v[32:47], a[72:75], v[216:219], v[32:47]
    ds_read_b128 a[120:123], v226 offset:30720
    buffer_load_dwordx4 v224, s[12:15], s46 offen offset:3072  lds
    v_mfma_f32_32x32x16_bf16 v[48:63], a[76:79], v[216:219], v[48:63]
    ds_read_b128 a[124:127], v226 offset:31744
    s_add_u32 s39, s39, 1
    s_waitcnt lgkmcnt(8)
    v_mfma_f32_32x32x16_bf16 v[64:79], a[80:83], v[216:219], v[64:79]
    s_add_u32 s35, s35, 32768
    s_add_u32 s37, s37, 32768
    s_cmp_eq_u32 s37, 98304
    s_cselect_b32 s37, 0, s37
    v_mfma_f32_32x32x16_bf16 v[80:95], a[84:87], v[216:219], v[80:95]
    s_cmp_eq_u32 s35, 98304
    s_cselect_b32 s35, 0, s35
    s_add_u32 s42, s37, 65536
    v_add_u32 v226, s42, v224
    v_mfma_f32_32x32x16_bf16 v[96:111], a[88:91], v[216:219], v[96:111]
    s_add_u32 s31, s31, 1
    v_mfma_f32_32x32x16_bf16 v[112:127], a[92:95], v[216:219], v[112:127]
    s_waitcnt vmcnt(8) lgkmcnt(0)
    s_barrier
    v_mfma_f32_32x32x16_bf16 v[0:15], a[96:99], v[220:223], v[0:15]
    ds_read_b128 a[64:67], v225 offset:0
    ds_read_b128 a[68:71], v225 offset:1024
    s_cmp_lt_u32 s38, s73
    s_cselect_b32 s10, 1048576, 0
    s_sub_u32 s45, s38, s74
    v_mfma_f32_32x32x16_bf16 v[16:31], a[100:103], v[220:223], v[16:31]
    ds_read_b128 a[72:75], v225 offset:2048
    ds_read_b128 a[76:79], v225 offset:3072
    s_add_u32 s44, s38, s75
    s_cmp_lt_u32 s38, s74
    s_cselect_b32 s45, s44, s45
    v_mfma_f32_32x32x16_bf16 v[32:47], a[104:107], v[220:223], v[32:47]
    ds_read_b128 a[80:83], v225 offset:4096
    ds_read_b128 a[84:87], v225 offset:5120
    s_lshl_b32 s45, s45, 15
    v_mfma_f32_32x32x16_bf16 v[48:63], a[108:111], v[220:223], v[48:63]
    ds_read_b128 a[88:91], v225 offset:6144
    ds_read_b128 a[92:95], v225 offset:7168
    s_add_u32 m0, s34, s40
    s_add_u32 s45, s45, s40
    v_mfma_f32_32x32x16_bf16 v[64:79], a[112:115], v[220:223], v[64:79]
    ds_read_b128 a[96:99], v225 offset:8192
    buffer_load_dwordx4 v224, s[8:11], s45 offen offset:0  lds
    v_mfma_f32_32x32x16_bf16 v[80:95], a[116:119], v[220:223], v[80:95]
    ds_read_b128 a[100:103], v225 offset:9216
    buffer_load_dwordx4 v224, s[8:11], s45 offen offset:1024  lds
    buffer_load_dwordx4 v224, s[8:11], s45 offen offset:2048  lds
    v_mfma_f32_32x32x16_bf16 v[96:111], a[120:123], v[220:223], v[96:111]
    ds_read_b128 a[104:107], v225 offset:10240
    buffer_load_dwordx4 v224, s[8:11], s45 offen offset:3072  lds
    v_mfma_f32_32x32x16_bf16 v[112:127], a[124:127], v[220:223], v[112:127]
    ds_read_b128 a[108:111], v225 offset:11264
    s_branch attn_kernel_chain1
attn_kernel_body_0_0_0:
    s_waitcnt lgkmcnt(0)
    ds_read_b128 a[64:67], v226 offset:0
    ds_read_b128 a[68:71], v226 offset:1024
    ds_read_b128 a[72:75], v226 offset:2048
    ds_read_b128 a[76:79], v226 offset:3072
    ds_read_b128 a[80:83], v226 offset:4096
    ds_read_b128 a[84:87], v226 offset:5120
    ds_read_b128 a[88:91], v226 offset:6144
    ds_read_b128 a[92:95], v226 offset:7168
    ds_read_b128 a[96:99], v226 offset:8192
    ds_read_b128 a[100:103], v226 offset:9216
    ds_read_b128 a[104:107], v226 offset:10240
    ds_read_b128 a[108:111], v226 offset:11264
    ds_read_b128 a[112:115], v226 offset:12288
    ds_read_b128 a[116:119], v226 offset:13312
    ds_read_b128 a[120:123], v226 offset:14336
    ds_read_b128 a[124:127], v226 offset:15360
    v_exp_f32 v234, v128
    v_exp_f32 v235, v129
    v_exp_f32 v236, v130
    v_exp_f32 v237, v131
    v_mov_b32 v229, v234
    v_mov_b32 v230, v235
    v_cvt_pk_bf16_f32 v208, v234, v235
    v_exp_f32 v238, v132
    v_exp_f32 v239, v133
    v_mov_b32 v231, v236
    v_mov_b32 v232, v237
    v_cvt_pk_bf16_f32 v209, v236, v237
    v_exp_f32 v240, v134
    v_exp_f32 v241, v135
    v_add_f32 v229, v229, v238
    v_add_f32 v230, v230, v239
    v_cvt_pk_bf16_f32 v210, v238, v239
    v_exp_f32 v234, v136
    v_exp_f32 v235, v137
    v_add_f32 v231, v231, v240
    v_add_f32 v232, v232, v241
    v_cvt_pk_bf16_f32 v211, v240, v241
    v_exp_f32 v236, v138
    v_exp_f32 v237, v139
    v_add_f32 v229, v229, v234
    v_add_f32 v230, v230, v235
    v_cvt_pk_bf16_f32 v212, v234, v235
    v_exp_f32 v238, v140
    v_exp_f32 v239, v141
    v_add_f32 v231, v231, v236
    v_add_f32 v232, v232, v237
    v_cvt_pk_bf16_f32 v213, v236, v237
    v_exp_f32 v240, v142
    v_exp_f32 v241, v143
    v_add_f32 v229, v229, v238
    v_add_f32 v230, v230, v239
    v_cvt_pk_bf16_f32 v214, v238, v239
    v_exp_f32 v234, v144
    v_exp_f32 v235, v145
    v_add_f32 v231, v231, v240
    v_add_f32 v232, v232, v241
    v_cvt_pk_bf16_f32 v215, v240, v241
    v_exp_f32 v236, v146
    v_exp_f32 v237, v147
    v_add_f32 v229, v229, v234
    v_add_f32 v230, v230, v235
    v_cvt_pk_bf16_f32 v216, v234, v235
    v_exp_f32 v238, v148
    v_exp_f32 v239, v149
    v_add_f32 v231, v231, v236
    v_add_f32 v232, v232, v237
    v_cvt_pk_bf16_f32 v217, v236, v237
    v_exp_f32 v240, v150
    v_exp_f32 v241, v151
    v_add_f32 v229, v229, v238
    v_add_f32 v230, v230, v239
    v_cvt_pk_bf16_f32 v218, v238, v239
    v_exp_f32 v234, v152
    v_exp_f32 v235, v153
    v_add_f32 v231, v231, v240
    v_add_f32 v232, v232, v241
    v_cvt_pk_bf16_f32 v219, v240, v241
    v_exp_f32 v236, v154
    v_exp_f32 v237, v155
    v_add_f32 v229, v229, v234
    v_add_f32 v230, v230, v235
    v_cvt_pk_bf16_f32 v220, v234, v235
    v_exp_f32 v238, v156
    v_exp_f32 v239, v157
    v_add_f32 v231, v231, v236
    v_add_f32 v232, v232, v237
    v_cvt_pk_bf16_f32 v221, v236, v237
    v_exp_f32 v240, v158
    v_exp_f32 v241, v159
    v_add_f32 v229, v229, v238
    v_add_f32 v230, v230, v239
    v_cvt_pk_bf16_f32 v222, v238, v239
    s_nop 0
    v_add_f32 v231, v231, v240
    v_add_f32 v232, v232, v241
    v_cvt_pk_bf16_f32 v223, v240, v241
    v_add_f32 v229, v229, v230
    v_add_f32 v231, v231, v232
    v_add_f32 v229, v229, v231
    v_cmp_lt_f32 vcc, s51, v229
    s_mov_b32 s49, 0
    s_cbranch_vccnz attn_kernel_slow0
attn_kernel_ret0:
    v_add_f32 v228, v228, v229
    s_waitcnt lgkmcnt(0)
    v_mfma_f32_32x32x16_bf16 v[0:15], a[64:67], v[208:211], v[0:15]
    ds_read_b128 a[64:67], v226 offset:16384
    v_mfma_f32_32x32x16_bf16 v[16:31], a[68:71], v[208:211], v[16:31]
    ds_read_b128 a[68:71], v226 offset:17408
    v_mfma_f32_32x32x16_bf16 v[32:47], a[72:75], v[208:211], v[32:47]
    ds_read_b128 a[72:75], v226 offset:18432
    v_mfma_f32_32x32x16_bf16 v[48:63], a[76:79], v[208:211], v[48:63]
    ds_read_b128 a[76:79], v226 offset:19456
    v_mfma_f32_32x32x16_bf16 v[64:79], a[80:83], v[208:211], v[64:79]
    ds_read_b128 a[80:83], v226 offset:20480
    v_mfma_f32_32x32x16_bf16 v[80:95], a[84:87], v[208:211], v[80:95]
    ds_read_b128 a[84:87], v226 offset:21504
    v_mfma_f32_32x32x16_bf16 v[96:111], a[88:91], v[208:211], v[96:111]
    ds_read_b128 a[88:91], v226 offset:22528
    v_mfma_f32_32x32x16_bf16 v[112:127], a[92:95], v[208:211], v[112:127]
    ds_read_b128 a[92:95], v226 offset:23552
    v_mfma_f32_32x32x16_bf16 v[0:15], a[96:99], v[212:215], v[0:15]
    ds_read_b128 a[96:99], v226 offset:24576
    v_mfma_f32_32x32x16_bf16 v[16:31], a[100:103], v[212:215], v[16:31]
    ds_read_b128 a[100:103], v226 offset:25600
    v_mfma_f32_32x32x16_bf16 v[32:47], a[104:107], v[212:215], v[32:47]
    ds_read_b128 a[104:107], v226 offset:26624
    v_mfma_f32_32x32x16_bf16 v[48:63], a[108:111], v[212:215], v[48:63]
    ds_read_b128 a[108:111], v226 offset:27648
    v_mfma_f32_32x32x16_bf16 v[64:79], a[112:115], v[212:215], v[64:79]
    ds_read_b128 a[112:115], v226 offset:28672
    v_mfma_f32_32x32x16_bf16 v[80:95], a[116:119], v[212:215], v[80:95]
    ds_read_b128 a[116:119], v226 offset:29696
    v_mfma_f32_32x32x16_bf16 v[96:111], a[120:123], v[212:215], v[96:111]
    ds_read_b128 a[120:123], v226 offset:30720
    v_mfma_f32_32x32x16_bf16 v[112:127], a[124:127], v[212:215], v[112:127]
    ds_read_b128 a[124:127], v226 offset:31744
    s_waitcnt lgkmcnt(8)
    v_mfma_f32_32x32x16_bf16 v[0:15], a[64:67], v[216:219], v[0:15]
    v_mfma_f32_32x32x16_bf16 v[16:31], a[68:71], v[216:219], v[16:31]
    v_mfma_f32_32x32x16_bf16 v[32:47], a[72:75], v[216:219], v[32:47]
    v_mfma_f32_32x32x16_bf16 v[48:63], a[76:79], v[216:219], v[48:63]
    v_mfma_f32_32x32x16_bf16 v[64:79], a[80:83], v[216:219], v[64:79]
    v_mfma_f32_32x32x16_bf16 v[80:95], a[84:87], v[216:219], v[80:95]
    v_mfma_f32_32x32x16_bf16 v[96:111], a[88:91], v[216:219], v[96:111]
    v_mfma_f32_32x32x16_bf16 v[112:127], a[92:95], v[216:219], v[112:127]
    s_waitcnt lgkmcnt(0)
    v_mfma_f32_32x32x16_bf16 v[0:15], a[96:99], v[220:223], v[0:15]
    v_mfma_f32_32x32x16_bf16 v[16:31], a[100:103], v[220:223], v[16:31]
    v_mfma_f32_32x32x16_bf16 v[32:47], a[104:107], v[220:223], v[32:47]
    v_mfma_f32_32x32x16_bf16 v[48:63], a[108:111], v[220:223], v[48:63]
    v_mfma_f32_32x32x16_bf16 v[64:79], a[112:115], v[220:223], v[64:79]
    v_mfma_f32_32x32x16_bf16 v[80:95], a[116:119], v[220:223], v[80:95]
    v_mfma_f32_32x32x16_bf16 v[96:111], a[120:123], v[220:223], v[96:111]
    v_mfma_f32_32x32x16_bf16 v[112:127], a[124:127], v[220:223], v[112:127]
    s_branch attn_kernel_epi
attn_kernel_body_0_1_0:
    s_waitcnt lgkmcnt(0)
    ds_read_b128 a[64:67], v226 offset:0
    ds_read_b128 a[68:71], v226 offset:1024
    ds_read_b128 a[72:75], v226 offset:2048
    ds_read_b128 a[76:79], v226 offset:3072
    ds_read_b128 a[80:83], v226 offset:4096
    ds_read_b128 a[84:87], v226 offset:5120
    ds_read_b128 a[88:91], v226 offset:6144
    ds_read_b128 a[92:95], v226 offset:7168
    ds_read_b128 a[96:99], v226 offset:8192
    ds_read_b128 a[100:103], v226 offset:9216
    ds_read_b128 a[104:107], v226 offset:10240
    ds_read_b128 a[108:111], v226 offset:11264
    ds_read_b128 a[112:115], v226 offset:12288
    ds_read_b128 a[116:119], v226 offset:13312
    ds_read_b128 a[120:123], v226 offset:14336
    ds_read_b128 a[124:127], v226 offset:15360
    s_lshl_b32 s41, s31, 6
    v_subrev_u32 v243, s41, v242
    v_subrev_u32 v244, 32, v243
    v_cmp_ge_i32 s[52:53], v243, 0
    v_cmp_ge_i32 s[54:55], v243, 1
    v_cmp_ge_i32 s[56:57], v243, 2
    v_cmp_ge_i32 s[58:59], v243, 3
    v_cndmask_b32 v128, v245, v128, s[52:53]
    v_cmp_ge_i32 s[52:53], v243, 8
    v_cndmask_b32 v129, v245, v129, s[54:55]
    v_cmp_ge_i32 s[54:55], v243, 9
    v_cndmask_b32 v130, v245, v130, s[56:57]
    v_cmp_ge_i32 s[56:57], v243, 10
    v_cndmask_b32 v131, v245, v131, s[58:59]
    v_cmp_ge_i32 s[58:59], v243, 11
    v_cndmask_b32 v132, v245, v132, s[52:53]
    v_cmp_ge_i32 s[52:53], v243, 16
    v_cndmask_b32 v133, v245, v133, s[54:55]
    v_cmp_ge_i32 s[54:55], v243, 17
    v_cndmask_b32 v134, v245, v134, s[56:57]
    v_cmp_ge_i32 s[56:57], v243, 18
    v_cndmask_b32 v135, v245, v135, s[58:59]
    v_cmp_ge_i32 s[58:59], v243, 19
    v_cndmask_b32 v136, v245, v136, s[52:53]
    v_cmp_ge_i32 s[52:53], v243, 24
    v_cndmask_b32 v137, v245, v137, s[54:55]
    v_cmp_ge_i32 s[54:55], v243, 25
    v_cndmask_b32 v138, v245, v138, s[56:57]
    v_cmp_ge_i32 s[56:57], v243, 26
    v_cndmask_b32 v139, v245, v139, s[58:59]
    v_cmp_ge_i32 s[58:59], v243, 27
    v_cndmask_b32 v140, v245, v140, s[52:53]
    v_cmp_ge_i32 s[52:53], v244, 0
    v_cndmask_b32 v141, v245, v141, s[54:55]
    v_cmp_ge_i32 s[54:55], v244, 1
    v_cndmask_b32 v142, v245, v142, s[56:57]
    v_cmp_ge_i32 s[56:57], v244, 2
    v_cndmask_b32 v143, v245, v143, s[58:59]
    v_cmp_ge_i32 s[58:59], v244, 3
    v_cndmask_b32 v144, v245, v144, s[52:53]
    v_cmp_ge_i32 s[52:53], v244, 8
    v_cndmask_b32 v145, v245, v145, s[54:55]
    v_cmp_ge_i32 s[54:55], v244, 9
    v_cndmask_b32 v146, v245, v146, s[56:57]
    v_cmp_ge_i32 s[56:57], v244, 10
    v_cndmask_b32 v147, v245, v147, s[58:59]
    v_cmp_ge_i32 s[58:59], v244, 11
    v_cndmask_b32 v148, v245, v148, s[52:53]
    v_cmp_ge_i32 s[52:53], v244, 16
    v_cndmask_b32 v149, v245, v149, s[54:55]
    v_cmp_ge_i32 s[54:55], v244, 17
    v_cndmask_b32 v150, v245, v150, s[56:57]
    v_cmp_ge_i32 s[56:57], v244, 18
    v_cndmask_b32 v151, v245, v151, s[58:59]
    v_cmp_ge_i32 s[58:59], v244, 19
    v_cndmask_b32 v152, v245, v152, s[52:53]
    v_cmp_ge_i32 s[52:53], v244, 24
    v_cndmask_b32 v153, v245, v153, s[54:55]
    v_cmp_ge_i32 s[54:55], v244, 25
    v_cndmask_b32 v154, v245, v154, s[56:57]
    v_cmp_ge_i32 s[56:57], v244, 26
    v_cndmask_b32 v155, v245, v155, s[58:59]
    v_cmp_ge_i32 s[58:59], v244, 27
    v_cndmask_b32 v156, v245, v156, s[52:53]
    s_nop 1
    v_cndmask_b32 v157, v245, v157, s[54:55]
    v_cndmask_b32 v158, v245, v158, s[56:57]
    v_cndmask_b32 v159, v245, v159, s[58:59]
    v_exp_f32 v234, v128
    v_exp_f32 v235, v129
    v_exp_f32 v236, v130
    v_exp_f32 v237, v131
    v_mov_b32 v229, v234
    v_mov_b32 v230, v235
    v_cvt_pk_bf16_f32 v208, v234, v235
    v_exp_f32 v238, v132
    v_exp_f32 v239, v133
    v_mov_b32 v231, v236
    v_mov_b32 v232, v237
    v_cvt_pk_bf16_f32 v209, v236, v237
    v_exp_f32 v240, v134
    v_exp_f32 v241, v135
    v_add_f32 v229, v229, v238
    v_add_f32 v230, v230, v239
    v_cvt_pk_bf16_f32 v210, v238, v239
    v_exp_f32 v234, v136
    v_exp_f32 v235, v137
    v_add_f32 v231, v231, v240
    v_add_f32 v232, v232, v241
    v_cvt_pk_bf16_f32 v211, v240, v241
    v_exp_f32 v236, v138
    v_exp_f32 v237, v139
    v_add_f32 v229, v229, v234
    v_add_f32 v230, v230, v235
    v_cvt_pk_bf16_f32 v212, v234, v235
    v_exp_f32 v238, v140
    v_exp_f32 v239, v141
    v_add_f32 v231, v231, v236
    v_add_f32 v232, v232, v237
    v_cvt_pk_bf16_f32 v213, v236, v237
    v_exp_f32 v240, v142
    v_exp_f32 v241, v143
    v_add_f32 v229, v229, v238
    v_add_f32 v230, v230, v239
    v_cvt_pk_bf16_f32 v214, v238, v239
    v_exp_f32 v234, v144
    v_exp_f32 v235, v145
    v_add_f32 v231, v231, v240
    v_add_f32 v232, v232, v241
    v_cvt_pk_bf16_f32 v215, v240, v241
    v_exp_f32 v236, v146
    v_exp_f32 v237, v147
    v_add_f32 v229, v229, v234
    v_add_f32 v230, v230, v235
    v_cvt_pk_bf16_f32 v216, v234, v235
    v_exp_f32 v238, v148
    v_exp_f32 v239, v149
    v_add_f32 v231, v231, v236
    v_add_f32 v232, v232, v237
    v_cvt_pk_bf16_f32 v217, v236, v237
    v_exp_f32 v240, v150
    v_exp_f32 v241, v151
    v_add_f32 v229, v229, v238
    v_add_f32 v230, v230, v239
    v_cvt_pk_bf16_f32 v218, v238, v239
    v_exp_f32 v234, v152
    v_exp_f32 v235, v153
    v_add_f32 v231, v231, v240
    v_add_f32 v232, v232, v241
    v_cvt_pk_bf16_f32 v219, v240, v241
    v_exp_f32 v236, v154
    v_exp_f32 v237, v155
    v_add_f32 v229, v229, v234
    v_add_f32 v230, v230, v235
    v_cvt_pk_bf16_f32 v220, v234, v235
    v_exp_f32 v238, v156
    v_exp_f32 v239, v157
    v_add_f32 v231, v231, v236
    v_add_f32 v232, v232, v237
    v_cvt_pk_bf16_f32 v221, v236, v237
    v_exp_f32 v240, v158
    v_exp_f32 v241, v159
    v_add_f32 v229, v229, v238
    v_add_f32 v230, v230, v239
    v_cvt_pk_bf16_f32 v222, v238, v239
    s_nop 0
    v_add_f32 v231, v231, v240
    v_add_f32 v232, v232, v241
    v_cvt_pk_bf16_f32 v223, v240, v241
    v_add_f32 v229, v229, v230
    v_add_f32 v231, v231, v232
    v_add_f32 v229, v229, v231
    v_cmp_lt_f32 vcc, s51, v229
    s_mov_b32 s49, 4
    s_cbranch_vccnz attn_kernel_slow0
attn_kernel_ret4:
    v_add_f32 v228, v228, v229
    s_waitcnt lgkmcnt(0)
    v_mfma_f32_32x32x16_bf16 v[0:15], a[64:67], v[208:211], v[0:15]
    ds_read_b128 a[64:67], v226 offset:16384
    v_mfma_f32_32x32x16_bf16 v[16:31], a[68:71], v[208:211], v[16:31]
    ds_read_b128 a[68:71], v226 offset:17408
    v_mfma_f32_32x32x16_bf16 v[32:47], a[72:75], v[208:211], v[32:47]
    ds_read_b128 a[72:75], v226 offset:18432
    v_mfma_f32_32x32x16_bf16 v[48:63], a[76:79], v[208:211], v[48:63]
    ds_read_b128 a[76:79], v226 offset:19456
    v_mfma_f32_32x32x16_bf16 v[64:79], a[80:83], v[208:211], v[64:79]
    ds_read_b128 a[80:83], v226 offset:20480
    v_mfma_f32_32x32x16_bf16 v[80:95], a[84:87], v[208:211], v[80:95]
    ds_read_b128 a[84:87], v226 offset:21504
    v_mfma_f32_32x32x16_bf16 v[96:111], a[88:91], v[208:211], v[96:111]
    ds_read_b128 a[88:91], v226 offset:22528
    v_mfma_f32_32x32x16_bf16 v[112:127], a[92:95], v[208:211], v[112:127]
    ds_read_b128 a[92:95], v226 offset:23552
    v_mfma_f32_32x32x16_bf16 v[0:15], a[96:99], v[212:215], v[0:15]
    ds_read_b128 a[96:99], v226 offset:24576
    v_mfma_f32_32x32x16_bf16 v[16:31], a[100:103], v[212:215], v[16:31]
    ds_read_b128 a[100:103], v226 offset:25600
    v_mfma_f32_32x32x16_bf16 v[32:47], a[104:107], v[212:215], v[32:47]
    ds_read_b128 a[104:107], v226 offset:26624
    v_mfma_f32_32x32x16_bf16 v[48:63], a[108:111], v[212:215], v[48:63]
    ds_read_b128 a[108:111], v226 offset:27648
    v_mfma_f32_32x32x16_bf16 v[64:79], a[112:115], v[212:215], v[64:79]
    ds_read_b128 a[112:115], v226 offset:28672
    v_mfma_f32_32x32x16_bf16 v[80:95], a[116:119], v[212:215], v[80:95]
    ds_read_b128 a[116:119], v226 offset:29696
    v_mfma_f32_32x32x16_bf16 v[96:111], a[120:123], v[212:215], v[96:111]
    ds_read_b128 a[120:123], v226 offset:30720
    v_mfma_f32_32x32x16_bf16 v[112:127], a[124:127], v[212:215], v[112:127]
    ds_read_b128 a[124:127], v226 offset:31744
    s_waitcnt lgkmcnt(8)
    v_mfma_f32_32x32x16_bf16 v[0:15], a[64:67], v[216:219], v[0:15]
    v_mfma_f32_32x32x16_bf16 v[16:31], a[68:71], v[216:219], v[16:31]
    v_mfma_f32_32x32x16_bf16 v[32:47], a[72:75], v[216:219], v[32:47]
    v_mfma_f32_32x32x16_bf16 v[48:63], a[76:79], v[216:219], v[48:63]
    v_mfma_f32_32x32x16_bf16 v[64:79], a[80:83], v[216:219], v[64:79]
    v_mfma_f32_32x32x16_bf16 v[80:95], a[84:87], v[216:219], v[80:95]
    v_mfma_f32_32x32x16_bf16 v[96:111], a[88:91], v[216:219], v[96:111]
    v_mfma_f32_32x32x16_bf16 v[112:127], a[92:95], v[216:219], v[112:127]
    s_waitcnt lgkmcnt(0)
    v_mfma_f32_32x32x16_bf16 v[0:15], a[96:99], v[220:223], v[0:15]
    v_mfma_f32_32x32x16_bf16 v[16:31], a[100:103], v[220:223], v[16:31]
    v_mfma_f32_32x32x16_bf16 v[32:47], a[104:107], v[220:223], v[32:47]
    v_mfma_f32_32x32x16_bf16 v[48:63], a[108:111], v[220:223], v[48:63]
    v_mfma_f32_32x32x16_bf16 v[64:79], a[112:115], v[220:223], v[64:79]
    v_mfma_f32_32x32x16_bf16 v[80:95], a[116:119], v[220:223], v[80:95]
    v_mfma_f32_32x32x16_bf16 v[96:111], a[120:123], v[220:223], v[96:111]
    v_mfma_f32_32x32x16_bf16 v[112:127], a[124:127], v[220:223], v[112:127]
    s_branch attn_kernel_epi
attn_kernel_body_1_0_1:
    s_waitcnt lgkmcnt(8)
    v_mfma_f32_32x32x16_bf16 v[128:143], a[64:67], a[0:3], v[192:207]
    ds_read_b128 a[112:115], v225 offset:12288
    v_exp_f32 v234, v160
    v_exp_f32 v235, v161
    v_mfma_f32_32x32x16_bf16 v[128:143], a[68:71], a[4:7], v[128:143]
    ds_read_b128 a[116:119], v225 offset:13312
    s_add_u32 m0, s34, s40
    v_exp_f32 v236, v162
    v_mfma_f32_32x32x16_bf16 v[128:143], a[72:75], a[8:11], v[128:143]
    ds_read_b128 a[120:123], v225 offset:14336
    s_add_u32 s45, s45, 4096
    v_exp_f32 v237, v163
    v_mov_b32 v229, v234
    v_mov_b32 v230, v235
    v_mfma_f32_32x32x16_bf16 v[128:143], a[76:79], a[12:15], v[128:143]
    ds_read_b128 a[124:127], v225 offset:15360
    s_add_u32 m0, m0, 4096
    v_cvt_pk_bf16_f32 v208, v234, v235
    v_exp_f32 v238, v164
    s_waitcnt lgkmcnt(8)
    v_mfma_f32_32x32x16_bf16 v[128:143], a[80:83], a[16:19], v[128:143]
    ds_read_b128 a[64:67], v225 offset:16384
    v_exp_f32 v239, v165
    v_mov_b32 v231, v236
    v_mov_b32 v232, v237
    v_mfma_f32_32x32x16_bf16 v[128:143], a[84:87], a[20:23], v[128:143]
    ds_read_b128 a[68:71], v225 offset:17408
    s_nop 0
    v_cvt_pk_bf16_f32 v209, v236, v237
    v_exp_f32 v240, v166
    v_mfma_f32_32x32x16_bf16 v[128:143], a[88:91], a[24:27], v[128:143]
    ds_read_b128 a[72:75], v225 offset:18432
    buffer_load_dwordx4 v224, s[8:11], s45 offen offset:0  lds
    v_exp_f32 v241, v167
    v_add_f32 v229, v229, v238
    v_mfma_f32_32x32x16_bf16 v[128:143], a[92:95], a[28:31], v[128:143]
    ds_read_b128 a[76:79], v225 offset:19456
    v_add_f32 v230, v230, v239
    v_cvt_pk_bf16_f32 v210, v238, v239
    v_exp_f32 v234, v168
    s_waitcnt lgkmcnt(8)
    v_mfma_f32_32x32x16_bf16 v[128:143], a[96:99], a[32:35], v[128:143]
    ds_read_b128 a[80:83], v225 offset:20480
    buffer_load_dwordx4 v224, s[8:11], s45 offen offset:1024  lds
    v_exp_f32 v235, v169
    v_add_f32 v231, v231, v240
    v_mfma_f32_32x32x16_bf16 v[128:143], a[100:103], a[36:39], v[128:143]
    ds_read_b128 a[84:87], v225 offset:21504
    buffer_load_dwordx4 v224, s[8:11], s45 offen offset:2048  lds
    v_add_f32 v232, v232, v241
    v_cvt_pk_bf16_f32 v211, v240, v241
    v_exp_f32 v236, v170
    v_mfma_f32_32x32x16_bf16 v[128:143], a[104:107], a[40:43], v[128:143]
    ds_read_b128 a[88:91], v225 offset:22528
    buffer_load_dwordx4 v224, s[8:11], s45 offen offset:3072  lds
    v_exp_f32 v237, v171
    v_add_f32 v229, v229, v234
    v_mfma_f32_32x32x16_bf16 v[128:143], a[108:111], a[44:47], v[128:143]
    ds_read_b128 a[92:95], v225 offset:23552
    v_add_f32 v230, v230, v235
    v_cvt_pk_bf16_f32 v212, v234, v235
    v_exp_f32 v238, v172
    s_waitcnt lgkmcnt(8)
    v_mfma_f32_32x32x16_bf16 v[128:143], a[112:115], a[48:51], v[128:143]
    ds_read_b128 a[96:99], v225 offset:24576
    s_add_u32 s38, s38, 1
    v_exp_f32 v239, v173
    v_mfma_f32_32x32x16_bf16 v[128:143], a[116:119], a[52:55], v[128:143]
    ds_read_b128 a[100:103], v225 offset:25600
    s_xor_b32 s34, s34, 32768
    v_add_f32 v231, v231, v236
    v_add_f32 v232, v232, v237
    v_cvt_pk_bf16_f32 v213, v236, v237
    v_mfma_f32_32x32x16_bf16 v[128:143], a[120:123], a[56:59], v[128:143]
    ds_read_b128 a[104:107], v225 offset:26624
    v_exp_f32 v240, v174
    v_exp_f32 v241, v175
    v_add_f32 v229, v229, v238
    v_mfma_f32_32x32x16_bf16 v[128:143], a[124:127], a[60:63], v[128:143]
    ds_read_b128 a[108:111], v225 offset:27648
    v_add_f32 v230, v230, v239
    v_cvt_pk_bf16_f32 v214, v238, v239
    v_exp_f32 v234, v176
    s_waitcnt lgkmcnt(8)
    v_mfma_f32_32x32x16_bf16 v[144:159], a[64:67], a[0:3], v[192:207]
    ds_read_b128 a[112:115], v225 offset:28672
    v_exp_f32 v235, v177
    v_add_f32 v231, v231, v240
    v_mfma_f32_32x32x16_bf16 v[144:159], a[68:71], a[4:7], v[144:159]
    ds_read_b128 a[116:119], v225 offset:29696
    v_add_f32 v232, v232, v241
    v_cvt_pk_bf16_f32 v215, v240, v241
    v_exp_f32 v236, v178
    v_mfma_f32_32x32x16_bf16 v[144:159], a[72:75], a[8:11], v[144:159]
    ds_read_b128 a[120:123], v225 offset:30720
    v_exp_f32 v237, v179
    v_add_f32 v229, v229, v234
    v_add_f32 v230, v230, v235
    v_cvt_pk_bf16_f32 v216, v234, v235
    v_mfma_f32_32x32x16_bf16 v[144:159], a[76:79], a[12:15], v[144:159]
    ds_read_b128 a[124:127], v225 offset:31744
    v_exp_f32 v238, v180
    v_exp_f32 v239, v181
    s_waitcnt lgkmcnt(8)
    v_mfma_f32_32x32x16_bf16 v[144:159], a[80:83], a[16:19], v[144:159]
    ds_read_b128 a[64:67], v226 offset:0
    v_add_f32 v231, v231, v236
    v_add_f32 v232, v232, v237
    v_cvt_pk_bf16_f32 v217, v236, v237
    v_mfma_f32_32x32x16_bf16 v[144:159], a[84:87], a[20:23], v[144:159]
    ds_read_b128 a[68:71], v226 offset:1024
    v_exp_f32 v240, v182
    v_exp_f32 v241, v183
    v_add_f32 v229, v229, v238
    v_mfma_f32_32x32x16_bf16 v[144:159], a[88:91], a[24:27], v[144:159]
    ds_read_b128 a[72:75], v226 offset:2048
    v_add_f32 v230, v230, v239
    v_cvt_pk_bf16_f32 v218, v238, v239
    v_exp_f32 v234, v184
    v_mfma_f32_32x32x16_bf16 v[144:159], a[92:95], a[28:31], v[144:159]
    ds_read_b128 a[76:79], v226 offset:3072
    v_exp_f32 v235, v185
    v_add_f32 v231, v231, v240
    v_add_f32 v232, v232, v241
    v_cvt_pk_bf16_f32 v219, v240, v241
    s_waitcnt lgkmcnt(8)
    v_mfma_f32_32x32x16_bf16 v[144:159], a[96:99], a[32:35], v[144:159]
    ds_read_b128 a[80:83], v226 offset:4096
    v_exp_f32 v236, v186
    v_exp_f32 v237, v187
    v_mfma_f32_32x32x16_bf16 v[144:159], a[100:103], a[36:39], v[144:159]
    ds_read_b128 a[84:87], v226 offset:5120
    v_add_f32 v229, v229, v234
    v_add_f32 v230, v230, v235
    v_cvt_pk_bf16_f32 v220, v234, v235
    v_mfma_f32_32x32x16_bf16 v[144:159], a[104:107], a[40:43], v[144:159]
    ds_read_b128 a[88:91], v226 offset:6144
    v_exp_f32 v238, v188
    v_exp_f32 v239, v189
    v_add_f32 v231, v231, v236
    v_mfma_f32_32x32x16_bf16 v[144:159], a[108:111], a[44:47], v[144:159]
    ds_read_b128 a[92:95], v226 offset:7168
    v_add_f32 v232, v232, v237
    v_cvt_pk_bf16_f32 v221, v236, v237
    v_exp_f32 v240, v190
    s_waitcnt lgkmcnt(8)
    v_mfma_f32_32x32x16_bf16 v[144:159], a[112:115], a[48:51], v[144:159]
    ds_read_b128 a[96:99], v226 offset:8192
    v_exp_f32 v241, v191
    v_add_f32 v229, v229, v238
    v_mfma_f32_32x32x16_bf16 v[144:159], a[116:119], a[52:55], v[144:159]
    ds_read_b128 a[100:103], v226 offset:9216
    v_add_f32 v230, v230, v239
    v_cvt_pk_bf16_f32 v222, v238, v239
    s_nop 0
    v_add_f32 v231, v231, v240
    v_add_f32 v232, v232, v241
    v_mfma_f32_32x32x16_bf16 v[144:159], a[120:123], a[56:59], v[144:159]
    ds_read_b128 a[104:107], v226 offset:10240
    v_cvt_pk_bf16_f32 v223, v240, v241
    v_add_f32 v229, v229, v230
    v_add_f32 v231, v231, v232
    v_add_f32 v229, v229, v231
    v_mfma_f32_32x32x16_bf16 v[144:159], a[124:127], a[60:63], v[144:159]
    ds_read_b128 a[108:111], v226 offset:11264
    s_waitcnt lgkmcnt(8)
    v_cmp_lt_f32 vcc, s51, v229
    s_mov_b32 s49, 9
    s_cbranch_vccnz attn_kernel_slow1
attn_kernel_ret9:
    v_add_f32 v228, v228, v229
    v_mfma_f32_32x32x16_bf16 v[0:15], a[64:67], v[208:211], v[0:15]
    ds_read_b128 a[112:115], v226 offset:12288
    s_cmp_lt_u32 s39, s73
    s_cselect_b32 s14, 1048576, 0
    v_mfma_f32_32x32x16_bf16 v[16:31], a[68:71], v[208:211], v[16:31]
    ds_read_b128 a[116:119], v226 offset:13312
    s_sub_u32 s46, s39, s74
    s_xor_b32 s36, s36, 32768
    v_mfma_f32_32x32x16_bf16 v[32:47], a[72:75], v[208:211], v[32:47]
    ds_read_b128 a[120:123], v226 offset:14336
    s_add_u32 s44, s39, s75
    v_add_u32 v225, s36, v224
    v_mfma_f32_32x32x16_bf16 v[48:63], a[76:79], v[208:211], v[48:63]
    ds_read_b128 a[124:127], v226 offset:15360
    s_cmp_lt_u32 s39, s74
    s_cselect_b32 s46, s44, s46
    s_waitcnt lgkmcnt(8)
    v_mfma_f32_32x32x16_bf16 v[64:79], a[80:83], v[208:211], v[64:79]
    ds_read_b128 a[64:67], v226 offset:16384
    s_lshl_b32 s46, s46, 15
    v_mfma_f32_32x32x16_bf16 v[80:95], a[84:87], v[208:211], v[80:95]
    ds_read_b128 a[68:71], v226 offset:17408
    s_add_u32 m0, s35, s7
    v_mfma_f32_32x32x16_bf16 v[96:111], a[88:91], v[208:211], v[96:111]
    ds_read_b128 a[72:75], v226 offset:18432
    s_add_u32 s46, s46, s40
    v_mfma_f32_32x32x16_bf16 v[112:127], a[92:95], v[208:211], v[112:127]
    ds_read_b128 a[76:79], v226 offset:19456
    buffer_load_dwordx4 v224, s[12:15], s46 offen offset:0  lds
    s_waitcnt lgkmcnt(8)
    v_mfma_f32_32x32x16_bf16 v[0:15], a[96:99], v[212:215], v[0:15]
    ds_read_b128 a[80:83], v226 offset:20480
    buffer_load_dwordx4 v224, s[12:15], s46 offen offset:1024  lds
    v_mfma_f32_32x32x16_bf16 v[16:31], a[100:103], v[212:215], v[16:31]
    ds_read_b128 a[84:87], v226 offset:21504
    buffer_load_dwordx4 v224, s[12:15], s46 offen offset:2048  lds
    v_mfma_f32_32x32x16_bf16 v[32:47], a[104:107], v[212:215], v[32:47]
    ds_read_b128 a[88:91], v226 offset:22528
    buffer_load_dwordx4 v224, s[12:15], s46 offen offset:3072  lds
    v_mfma_f32_32x32x16_bf16 v[48:63], a[108:111], v[212:215], v[48:63]
    ds_read_b128 a[92:95], v226 offset:23552
    s_add_u32 m0, s35, s7
    s_waitcnt lgkmcnt(8)
    v_mfma_f32_32x32x16_bf16 v[64:79], a[112:115], v[212:215], v[64:79]
    ds_read_b128 a[96:99], v226 offset:24576
    s_add_u32 s46, s46, 4096
    v_mfma_f32_32x32x16_bf16 v[80:95], a[116:119], v[212:215], v[80:95]
    ds_read_b128 a[100:103], v226 offset:25600
    s_add_u32 m0, m0, 4096
    v_mfma_f32_32x32x16_bf16 v[96:111], a[120:123], v[212:215], v[96:111]
    ds_read_b128 a[104:107], v226 offset:26624
    s_nop 0
    v_mfma_f32_32x32x16_bf16 v[112:127], a[124:127], v[212:215], v[112:127]
    ds_read_b128 a[108:111], v226 offset:27648
    buffer_load_dwordx4 v224, s[12:15], s46 offen offset:0  lds
    s_waitcnt lgkmcnt(8)
    v_mfma_f32_32x32x16_bf16 v[0:15], a[64:67], v[216:219], v[0:15]
    ds_read_b128 a[112:115], v226 offset:28672
    buffer_load_dwordx4 v224, s[12:15], s46 offen offset:1024  lds
    v_mfma_f32_32x32x16_bf16 v[16:31], a[68:71], v[216:219], v[16:31]
    ds_read_b128 a[116:119], v226 offset:29696
    buffer_load_dwordx4 v224, s[12:15], s46 offen offset:2048  lds
    v_mfma_f32_32x32x16_bf16 v[32:47], a[72:75], v[216:219], v[32:47]
    ds_read_b128 a[120:123], v226 offset:30720
    buffer_load_dwordx4 v224, s[12:15], s46 offen offset:3072  lds
    v_mfma_f32_32x32x16_bf16 v[48:63], a[76:79], v[216:219], v[48:63]
    ds_read_b128 a[124:127], v226 offset:31744
    s_add_u32 s39, s39, 1
    s_waitcnt lgkmcnt(8)
    v_mfma_f32_32x32x16_bf16 v[64:79], a[80:83], v[216:219], v[64:79]
    s_add_u32 s35, s35, 32768
    s_add_u32 s37, s37, 32768
    s_cmp_eq_u32 s37, 98304
    s_cselect_b32 s37, 0, s37
    v_mfma_f32_32x32x16_bf16 v[80:95], a[84:87], v[216:219], v[80:95]
    s_cmp_eq_u32 s35, 98304
    s_cselect_b32 s35, 0, s35
    s_add_u32 s42, s37, 65536
    v_add_u32 v226, s42, v224
    v_mfma_f32_32x32x16_bf16 v[96:111], a[88:91], v[216:219], v[96:111]
    s_add_u32 s31, s31, 1
    v_mfma_f32_32x32x16_bf16 v[112:127], a[92:95], v[216:219], v[112:127]
    s_waitcnt vmcnt(8) lgkmcnt(0)
    s_barrier
    v_mfma_f32_32x32x16_bf16 v[0:15], a[96:99], v[220:223], v[0:15]
    ds_read_b128 a[64:67], v225 offset:0
    ds_read_b128 a[68:71], v225 offset:1024
    s_cmp_lt_u32 s38, s73
    s_cselect_b32 s10, 1048576, 0
    s_sub_u32 s45, s38, s74
    v_mfma_f32_32x32x16_bf16 v[16:31], a[100:103], v[220:223], v[16:31]
    ds_read_b128 a[72:75], v225 offset:2048
    ds_read_b128 a[76:79], v225 offset:3072
    s_add_u32 s44, s38, s75
    s_cmp_lt_u32 s38, s74
    s_cselect_b32 s45, s44, s45
    v_mfma_f32_32x32x16_bf16 v[32:47], a[104:107], v[220:223], v[32:47]
    ds_read_b128 a[80:83], v225 offset:4096
    ds_read_b128 a[84:87], v225 offset:5120
    s_lshl_b32 s45, s45, 15
    v_mfma_f32_32x32x16_bf16 v[48:63], a[108:111], v[220:223], v[48:63]
    ds_read_b128 a[88:91], v225 offset:6144
    ds_read_b128 a[92:95], v225 offset:7168
    s_add_u32 m0, s34, s40
    s_add_u32 s45, s45, s40
    v_mfma_f32_32x32x16_bf16 v[64:79], a[112:115], v[220:223], v[64:79]
    ds_read_b128 a[96:99], v225 offset:8192
    buffer_load_dwordx4 v224, s[8:11], s45 offen offset:0  lds
    v_mfma_f32_32x32x16_bf16 v[80:95], a[116:119], v[220:223], v[80:95]
    ds_read_b128 a[100:103], v225 offset:9216
    buffer_load_dwordx4 v224, s[8:11], s45 offen offset:1024  lds
    buffer_load_dwordx4 v224, s[8:11], s45 offen offset:2048  lds
    v_mfma_f32_32x32x16_bf16 v[96:111], a[120:123], v[220:223], v[96:111]
    ds_read_b128 a[104:107], v225 offset:10240
    buffer_load_dwordx4 v224, s[8:11], s45 offen offset:3072  lds
    v_mfma_f32_32x32x16_bf16 v[112:127], a[124:127], v[220:223], v[112:127]
    ds_read_b128 a[108:111], v225 offset:11264
    s_cmp_lt_u32 s31, s6
    s_cbranch_scc1 attn_kernel_body_0_0_1
    s_branch attn_kernel_dispatch0
attn_kernel_body_1_1_1:
    s_waitcnt lgkmcnt(8)
    v_mfma_f32_32x32x16_bf16 v[128:143], a[64:67], a[0:3], v[192:207]
    ds_read_b128 a[112:115], v225 offset:12288
    s_lshl_b32 s41, s31, 6
    v_subrev_u32 v243, s41, v242
    v_subrev_u32 v244, 32, v243
    v_cmp_ge_i32 s[52:53], v243, 0
    v_cmp_ge_i32 s[54:55], v243, 1
    v_cmp_ge_i32 s[56:57], v243, 2
    v_mfma_f32_32x32x16_bf16 v[128:143], a[68:71], a[4:7], v[128:143]
    ds_read_b128 a[116:119], v225 offset:13312
    s_add_u32 m0, s34, s40
    v_cmp_ge_i32 s[58:59], v243, 3
    v_cndmask_b32 v160, v245, v160, s[52:53]
    v_cmp_ge_i32 s[52:53], v243, 8
    v_cndmask_b32 v161, v245, v161, s[54:55]
    v_cmp_ge_i32 s[54:55], v243, 9
    v_mfma_f32_32x32x16_bf16 v[128:143], a[72:75], a[8:11], v[128:143]
    ds_read_b128 a[120:123], v225 offset:14336
    s_add_u32 s45, s45, 4096
    v_cndmask_b32 v162, v245, v162, s[56:57]
    v_cmp_ge_i32 s[56:57], v243, 10
    v_cndmask_b32 v163, v245, v163, s[58:59]
    v_cmp_ge_i32 s[58:59], v243, 11
    v_cndmask_b32 v164, v245, v164, s[52:53]
    v_cmp_ge_i32 s[52:53], v243, 16
    v_mfma_f32_32x32x16_bf16 v[128:143], a[76:79], a[12:15], v[128:143]
    ds_read_b128 a[124:127], v225 offset:15360
    s_add_u32 m0, m0, 4096
    v_cndmask_b32 v165, v245, v165, s[54:55]
    v_cmp_ge_i32 s[54:55], v243, 17
    v_cndmask_b32 v166, v245, v166, s[56:57]
    v_cmp_ge_i32 s[56:57], v243, 18
    v_cndmask_b32 v167, v245, v167, s[58:59]
    s_waitcnt lgkmcnt(8)
    v_mfma_f32_32x32x16_bf16 v[128:143], a[80:83], a[16:19], v[128:143]
    ds_read_b128 a[64:67], v225 offset:16384
    v_cmp_ge_i32 s[58:59], v243, 19
    v_cndmask_b32 v168, v245, v168, s[52:53]
    v_cmp_ge_i32 s[52:53], v243, 24
    v_cndmask_b32 v169, v245, v169, s[54:55]
    v_cmp_ge_i32 s[54:55], v243, 25
    v_cndmask_b32 v170, v245, v170, s[56:57]
    v_mfma_f32_32x32x16_bf16 v[128:143], a[84:87], a[20:23], v[128:143]
    ds_read_b128 a[68:71], v225 offset:17408
    s_nop 0
    v_cmp_ge_i32 s[56:57], v243, 26
    v_cndmask_b32 v171, v245, v171, s[58:59]
    v_cmp_ge_i32 s[58:59], v243, 27
    v_cndmask_b32 v172, v245, v172, s[52:53]
    v_cmp_ge_i32 s[52:53], v244, 0
    v_mfma_f32_32x32x16_bf16 v[128:143], a[88:91], a[24:27], v[128:143]
    ds_read_b128 a[72:75], v225 offset:18432
    buffer_load_dwordx4 v224, s[8:11], s45 offen offset:0  lds
    v_cndmask_b32 v173, v245, v173, s[54:55]
    v_cmp_ge_i32 s[54:55], v244, 1
    v_cndmask_b32 v174, v245, v174, s[56:57]
    v_cmp_ge_i32 s[56:57], v244, 2
    v_cndmask_b32 v175, v245, v175, s[58:59]
    v_cmp_ge_i32 s[58:59], v244, 3
    v_mfma_f32_32x32x16_bf16 v[128:143], a[92:95], a[28:31], v[128:143]
    ds_read_b128 a[76:79], v225 offset:19456
    v_cndmask_b32 v176, v245, v176, s[52:53]
    v_cmp_ge_i32 s[52:53], v244, 8
    v_cndmask_b32 v177, v245, v177, s[54:55]
    v_cmp_ge_i32 s[54:55], v244, 9
    v_cndmask_b32 v178, v245, v178, s[56:57]
    v_cmp_ge_i32 s[56:57], v244, 10
    s_waitcnt lgkmcnt(8)
    v_mfma_f32_32x32x16_bf16 v[128:143], a[96:99], a[32:35], v[128:143]
    ds_read_b128 a[80:83], v225 offset:20480
    buffer_load_dwordx4 v224, s[8:11], s45 offen offset:1024  lds
    v_cndmask_b32 v179, v245, v179, s[58:59]
    v_cmp_ge_i32 s[58:59], v244, 11
    v_cndmask_b32 v180, v245, v180, s[52:53]
    v_cmp_ge_i32 s[52:53], v244, 16
    v_cndmask_b32 v181, v245, v181, s[54:55]
    v_mfma_f32_32x32x16_bf16 v[128:143], a[100:103], a[36:39], v[128:143]
    ds_read_b128 a[84:87], v225 offset:21504
    buffer_load_dwordx4 v224, s[8:11], s45 offen offset:2048  lds
    v_cmp_ge_i32 s[54:55], v244, 17
    v_cndmask_b32 v182, v245, v182, s[56:57]
    v_cmp_ge_i32 s[56:57], v244, 18
    v_cndmask_b32 v183, v245, v183, s[58:59]
    v_cmp_ge_i32 s[58:59], v244, 19
    v_mfma_f32_32x32x16_bf16 v[128:143], a[104:107], a[40:43], v[128:143]
    ds_read_b128 a[88:91], v225 offset:22528
    buffer_load_dwordx4 v224, s[8:11], s45 offen offset:3072  lds
    v_cndmask_b32 v184, v245, v184, s[52:53]
    v_cmp_ge_i32 s[52:53], v244, 24
    v_cndmask_b32 v185, v245, v185, s[54:55]
    v_cmp_ge_i32 s[54:55], v244, 25
    v_cndmask_b32 v186, v245, v186, s[56:57]
    v_cmp_ge_i32 s[56:57], v244, 26
    v_mfma_f32_32x32x16_bf16 v[128:143], a[108:111], a[44:47], v[128:143]
    ds_read_b128 a[92:95], v225 offset:23552
    v_cndmask_b32 v187, v245, v187, s[58:59]
    v_cmp_ge_i32 s[58:59], v244, 27
    v_cndmask_b32 v188, v245, v188, s[52:53]
    s_nop 1
    v_cndmask_b32 v189, v245, v189, s[54:55]
    v_cndmask_b32 v190, v245, v190, s[56:57]
    s_waitcnt lgkmcnt(8)
    v_mfma_f32_32x32x16_bf16 v[128:143], a[112:115], a[48:51], v[128:143]
    ds_read_b128 a[96:99], v225 offset:24576
    s_add_u32 s38, s38, 1
    v_cndmask_b32 v191, v245, v191, s[58:59]
    v_exp_f32 v234, v160
    v_exp_f32 v235, v161
    v_mfma_f32_32x32x16_bf16 v[128:143], a[116:119], a[52:55], v[128:143]
    ds_read_b128 a[100:103], v225 offset:25600
    s_xor_b32 s34, s34, 32768
    v_exp_f32 v236, v162
    v_exp_f32 v237, v163
    v_mov_b32 v229, v234
    v_mfma_f32_32x32x16_bf16 v[128:143], a[120:123], a[56:59], v[128:143]
    ds_read_b128 a[104:107], v225 offset:26624
    v_mov_b32 v230, v235
    v_cvt_pk_bf16_f32 v208, v234, v235
    v_exp_f32 v238, v164
    v_exp_f32 v239, v165
    v_mov_b32 v231, v236
    v_mfma_f32_32x32x16_bf16 v[128:143], a[124:127], a[60:63], v[128:143]
    ds_read_b128 a[108:111], v225 offset:27648
    v_mov_b32 v232, v237
    v_cvt_pk_bf16_f32 v209, v236, v237
    v_exp_f32 v240, v166
    v_exp_f32 v241, v167
    s_waitcnt lgkmcnt(8)
    v_mfma_f32_32x32x16_bf16 v[144:159], a[64:67], a[0:3], v[192:207]
    ds_read_b128 a[112:115], v225 offset:28672
    v_add_f32 v229, v229, v238
    v_add_f32 v230, v230, v239
    v_cvt_pk_bf16_f32 v210, v238, v239
    v_exp_f32 v234, v168
    v_mfma_f32_32x32x16_bf16 v[144:159], a[68:71], a[4:7], v[144:159]
    ds_read_b128 a[116:119], v225 offset:29696
    v_exp_f32 v235, v169
    v_add_f32 v231, v231, v240
    v_add_f32 v232, v232, v241
    v_cvt_pk_bf16_f32 v211, v240, v241
    v_exp_f32 v236, v170
    v_mfma_f32_32x32x16_bf16 v[144:159], a[72:75], a[8:11], v[144:159]
    ds_read_b128 a[120:123], v225 offset:30720
    v_exp_f32 v237, v171
    v_add_f32 v229, v229, v234
    v_add_f32 v230, v230, v235
    v_cvt_pk_bf16_f32 v212, v234, v235
    v_exp_f32 v238, v172
    v_mfma_f32_32x32x16_bf16 v[144:159], a[76:79], a[12:15], v[144:159]
    ds_read_b128 a[124:127], v225 offset:31744
    v_exp_f32 v239, v173
    v_add_f32 v231, v231, v236
    v_add_f32 v232, v232, v237
    v_cvt_pk_bf16_f32 v213, v236, v237
    v_exp_f32 v240, v174
    s_waitcnt lgkmcnt(8)
    v_mfma_f32_32x32x16_bf16 v[144:159], a[80:83], a[16:19], v[144:159]
    ds_read_b128 a[64:67], v226 offset:0
    v_exp_f32 v241, v175
    v_add_f32 v229, v229, v238
    v_add_f32 v230, v230, v239
    v_cvt_pk_bf16_f32 v214, v238, v239
    v_mfma_f32_32x32x16_bf16 v[144:159], a[84:87], a[20:23], v[144:159]
    ds_read_b128 a[68:71], v226 offset:1024
    v_exp_f32 v234, v176
    v_exp_f32 v235, v177
    v_add_f32 v231, v231, v240
    v_add_f32 v232, v232, v241
    v_mfma_f32_32x32x16_bf16 v[144:159], a[88:91], a[24:27], v[144:159]
    ds_read_b128 a[72:75], v226 offset:2048
    v_cvt_pk_bf16_f32 v215, v240, v241
    v_exp_f32 v236, v178
    v_exp_f32 v237, v179
    v_add_f32 v229, v229, v234
    v_add_f32 v230, v230, v235
    v_mfma_f32_32x32x16_bf16 v[144:159], a[92:95], a[28:31], v[144:159]
    ds_read_b128 a[76:79], v226 offset:3072
    v_cvt_pk_bf16_f32 v216, v234, v235
    v_exp_f32 v238, v180
    v_exp_f32 v239, v181
    v_add_f32 v231, v231, v236
    s_waitcnt lgkmcnt(8)
    v_mfma_f32_32x32x16_bf16 v[144:159], a[96:99], a[32:35], v[144:159]
    ds_read_b128 a[80:83], v226 offset:4096
    v_add_f32 v232, v232, v237
    v_cvt_pk_bf16_f32 v217, v236, v237
    v_exp_f32 v240, v182
    v_exp_f32 v241, v183
    v_mfma_f32_32x32x16_bf16 v[144:159], a[100:103], a[36:39], v[144:159]
    ds_read_b128 a[84:87], v226 offset:5120
    v_add_f32 v229, v229, v238
    v_add_f32 v230, v230, v239
    v_cvt_pk_bf16_f32 v218, v238, v239
    v_exp_f32 v234, v184
    v_exp_f32 v235, v185
    v_mfma_f32_32x32x16_bf16 v[144:159], a[104:107], a[40:43], v[144:159]
    ds_read_b128 a[88:91], v226 offset:6144
    v_add_f32 v231, v231, v240
    v_add_f32 v232, v232, v241
    v_cvt_pk_bf16_f32 v219, v240, v241
    v_exp_f32 v236, v186
    v_mfma_f32_32x32x16_bf16 v[144:159], a[108:111], a[44:47], v[144:159]
    ds_read_b128 a[92:95], v226 offset:7168
    v_exp_f32 v237, v187
    v_add_f32 v229, v229, v234
    v_add_f32 v230, v230, v235
    v_cvt_pk_bf16_f32 v220, v234, v235
    v_exp_f32 v238, v188
    s_waitcnt lgkmcnt(8)
    v_mfma_f32_32x32x16_bf16 v[144:159], a[112:115], a[48:51], v[144:159]
    ds_read_b128 a[96:99], v226 offset:8192
    v_exp_f32 v239, v189
    v_add_f32 v231, v231, v236
    v_add_f32 v232, v232, v237
    v_cvt_pk_bf16_f32 v221, v236, v237
    v_mfma_f32_32x32x16_bf16 v[144:159], a[116:119], a[52:55], v[144:159]
    ds_read_b128 a[100:103], v226 offset:9216
    v_exp_f32 v240, v190
    v_exp_f32 v241, v191
    v_add_f32 v229, v229, v238
    v_add_f32 v230, v230, v239
    v_cvt_pk_bf16_f32 v222, v238, v239
    v_mfma_f32_32x32x16_bf16 v[144:159], a[120:123], a[56:59], v[144:159]
    ds_read_b128 a[104:107], v226 offset:10240
    s_nop 0
    v_add_f32 v231, v231, v240
    v_add_f32 v232, v232, v241
    v_cvt_pk_bf16_f32 v223, v240, v241
    v_add_f32 v229, v229, v230
    v_add_f32 v231, v231, v232
    v_add_f32 v229, v229, v231
    v_mfma_f32_32x32x16_bf16 v[144:159], a[124:127], a[60:63], v[144:159]
    ds_read_b128 a[108:111], v226 offset:11264
    s_waitcnt lgkmcnt(8)
    v_cmp_lt_f32 vcc, s51, v229
    s_mov_b32 s49, 13
    s_cbranch_vccnz attn_kernel_slow1
attn_kernel_ret13:
    v_add_f32 v228, v228, v229
    v_mfma_f32_32x32x16_bf16 v[0:15], a[64:67], v[208:211], v[0:15]
    ds_read_b128 a[112:115], v226 offset:12288
    s_cmp_lt_u32 s39, s73
    s_cselect_b32 s14, 1048576, 0
    v_mfma_f32_32x32x16_bf16 v[16:31], a[68:71], v[208:211], v[16:31]
    ds_read_b128 a[116:119], v226 offset:13312
    s_sub_u32 s46, s39, s74
    s_xor_b32 s36, s36, 32768
    v_mfma_f32_32x32x16_bf16 v[32:47], a[72:75], v[208:211], v[32:47]
    ds_read_b128 a[120:123], v226 offset:14336
    s_add_u32 s44, s39, s75
    v_add_u32 v225, s36, v224
    v_mfma_f32_32x32x16_bf16 v[48:63], a[76:79], v[208:211], v[48:63]
    ds_read_b128 a[124:127], v226 offset:15360
    s_cmp_lt_u32 s39, s74
    s_cselect_b32 s46, s44, s46
    s_waitcnt lgkmcnt(8)
    v_mfma_f32_32x32x16_bf16 v[64:79], a[80:83], v[208:211], v[64:79]
    ds_read_b128 a[64:67], v226 offset:16384
    s_lshl_b32 s46, s46, 15
    v_mfma_f32_32x32x16_bf16 v[80:95], a[84:87], v[208:211], v[80:95]
    ds_read_b128 a[68:71], v226 offset:17408
    s_add_u32 m0, s35, s7
    v_mfma_f32_32x32x16_bf16 v[96:111], a[88:91], v[208:211], v[96:111]
    ds_read_b128 a[72:75], v226 offset:18432
    s_add_u32 s46, s46, s40
    v_mfma_f32_32x32x16_bf16 v[112:127], a[92:95], v[208:211], v[112:127]
    ds_read_b128 a[76:79], v226 offset:19456
    buffer_load_dwordx4 v224, s[12:15], s46 offen offset:0  lds
    s_waitcnt lgkmcnt(8)
    v_mfma_f32_32x32x16_bf16 v[0:15], a[96:99], v[212:215], v[0:15]
    ds_read_b128 a[80:83], v226 offset:20480
    buffer_load_dwordx4 v224, s[12:15], s46 offen offset:1024  lds
    v_mfma_f32_32x32x16_bf16 v[16:31], a[100:103], v[212:215], v[16:31]
    ds_read_b128 a[84:87], v226 offset:21504
    buffer_load_dwordx4 v224, s[12:15], s46 offen offset:2048  lds
    v_mfma_f32_32x32x16_bf16 v[32:47], a[104:107], v[212:215], v[32:47]
    ds_read_b128 a[88:91], v226 offset:22528
    buffer_load_dwordx4 v224, s[12:15], s46 offen offset:3072  lds
    v_mfma_f32_32x32x16_bf16 v[48:63], a[108:111], v[212:215], v[48:63]
    ds_read_b128 a[92:95], v226 offset:23552
    s_add_u32 m0, s35, s7
    s_waitcnt lgkmcnt(8)
    v_mfma_f32_32x32x16_bf16 v[64:79], a[112:115], v[212:215], v[64:79]
    ds_read_b128 a[96:99], v226 offset:24576
    s_add_u32 s46, s46, 4096
    v_mfma_f32_32x32x16_bf16 v[80:95], a[116:119], v[212:215], v[80:95]
    ds_read_b128 a[100:103], v226 offset:25600
    s_add_u32 m0, m0, 4096
    v_mfma_f32_32x32x16_bf16 v[96:111], a[120:123], v[212:215], v[96:111]
    ds_read_b128 a[104:107], v226 offset:26624
    s_nop 0
    v_mfma_f32_32x32x16_bf16 v[112:127], a[124:127], v[212:215], v[112:127]
    ds_read_b128 a[108:111], v226 offset:27648
    buffer_load_dwordx4 v224, s[12:15], s46 offen offset:0  lds
    s_waitcnt lgkmcnt(8)
    v_mfma_f32_32x32x16_bf16 v[0:15], a[64:67], v[216:219], v[0:15]
    ds_read_b128 a[112:115], v226 offset:28672
    buffer_load_dwordx4 v224, s[12:15], s46 offen offset:1024  lds
    v_mfma_f32_32x32x16_bf16 v[16:31], a[68:71], v[216:219], v[16:31]
    ds_read_b128 a[116:119], v226 offset:29696
    buffer_load_dwordx4 v224, s[12:15], s46 offen offset:2048  lds
    v_mfma_f32_32x32x16_bf16 v[32:47], a[72:75], v[216:219], v[32:47]
    ds_read_b128 a[120:123], v226 offset:30720
    buffer_load_dwordx4 v224, s[12:15], s46 offen offset:3072  lds
    v_mfma_f32_32x32x16_bf16 v[48:63], a[76:79], v[216:219], v[48:63]
    ds_read_b128 a[124:127], v226 offset:31744
    s_add_u32 s39, s39, 1
    s_waitcnt lgkmcnt(8)
    v_mfma_f32_32x32x16_bf16 v[64:79], a[80:83], v[216:219], v[64:79]
    s_add_u32 s35, s35, 32768
    s_add_u32 s37, s37, 32768
    s_cmp_eq_u32 s37, 98304
    s_cselect_b32 s37, 0, s37
    v_mfma_f32_32x32x16_bf16 v[80:95], a[84:87], v[216:219], v[80:95]
    s_cmp_eq_u32 s35, 98304
    s_cselect_b32 s35, 0, s35
    s_add_u32 s42, s37, 65536
    v_add_u32 v226, s42, v224
    v_mfma_f32_32x32x16_bf16 v[96:111], a[88:91], v[216:219], v[96:111]
    s_add_u32 s31, s31, 1
    v_mfma_f32_32x32x16_bf16 v[112:127], a[92:95], v[216:219], v[112:127]
    s_waitcnt vmcnt(8) lgkmcnt(0)
    s_barrier
    v_mfma_f32_32x32x16_bf16 v[0:15], a[96:99], v[220:223], v[0:15]
    ds_read_b128 a[64:67], v225 offset:0
    ds_read_b128 a[68:71], v225 offset:1024
    s_cmp_lt_u32 s38, s73
    s_cselect_b32 s10, 1048576, 0
    s_sub_u32 s45, s38, s74
    v_mfma_f32_32x32x16_bf16 v[16:31], a[100:103], v[220:223], v[16:31]
    ds_read_b128 a[72:75], v225 offset:2048
    ds_read_b128 a[76:79], v225 offset:3072
    s_add_u32 s44, s38, s75
    s_cmp_lt_u32 s38, s74
    s_cselect_b32 s45, s44, s45
    v_mfma_f32_32x32x16_bf16 v[32:47], a[104:107], v[220:223], v[32:47]
    ds_read_b128 a[80:83], v225 offset:4096
    ds_read_b128 a[84:87], v225 offset:5120
    s_lshl_b32 s45, s45, 15
    v_mfma_f32_32x32x16_bf16 v[48:63], a[108:111], v[220:223], v[48:63]
    ds_read_b128 a[88:91], v225 offset:6144
    ds_read_b128 a[92:95], v225 offset:7168
    s_add_u32 m0, s34, s40
    s_add_u32 s45, s45, s40
    v_mfma_f32_32x32x16_bf16 v[64:79], a[112:115], v[220:223], v[64:79]
    ds_read_b128 a[96:99], v225 offset:8192
    buffer_load_dwordx4 v224, s[8:11], s45 offen offset:0  lds
    v_mfma_f32_32x32x16_bf16 v[80:95], a[116:119], v[220:223], v[80:95]
    ds_read_b128 a[100:103], v225 offset:9216
    buffer_load_dwordx4 v224, s[8:11], s45 offen offset:1024  lds
    buffer_load_dwordx4 v224, s[8:11], s45 offen offset:2048  lds
    v_mfma_f32_32x32x16_bf16 v[96:111], a[120:123], v[220:223], v[96:111]
    ds_read_b128 a[104:107], v225 offset:10240
    buffer_load_dwordx4 v224, s[8:11], s45 offen offset:3072  lds
    v_mfma_f32_32x32x16_bf16 v[112:127], a[124:127], v[220:223], v[112:127]
    ds_read_b128 a[108:111], v225 offset:11264
    s_branch attn_kernel_dispatch0
attn_kernel_body_1_1_2:
    s_waitcnt lgkmcnt(8)
    v_mfma_f32_32x32x16_bf16 v[128:143], a[64:67], a[128:131], 0
    ds_read_b128 a[112:115], v225 offset:12288
    s_lshl_b32 s41, s31, 6
    v_subrev_u32 v243, s41, v242
    v_subrev_u32 v244, 32, v243
    v_cmp_ge_i32 s[52:53], v243, 0
    v_cmp_ge_i32 s[54:55], v243, 1
    v_cmp_ge_i32 s[56:57], v243, 2
    v_mfma_f32_32x32x16_bf16 v[128:143], a[68:71], a[132:135], v[128:143]
    ds_read_b128 a[116:119], v225 offset:13312
    s_add_u32 m0, s34, s40
    v_cmp_ge_i32 s[58:59], v243, 3
    v_cndmask_b32 v160, v245, v160, s[52:53]
    v_cmp_ge_i32 s[52:53], v243, 8
    v_cndmask_b32 v161, v245, v161, s[54:55]
    v_cmp_ge_i32 s[54:55], v243, 9
    v_mfma_f32_32x32x16_bf16 v[128:143], a[72:75], a[136:139], v[128:143]
    ds_read_b128 a[120:123], v225 offset:14336
    s_add_u32 s45, s45, 4096
    v_cndmask_b32 v162, v245, v162, s[56:57]
    v_cmp_ge_i32 s[56:57], v243, 10
    v_cndmask_b32 v163, v245, v163, s[58:59]
    v_cmp_ge_i32 s[58:59], v243, 11
    v_cndmask_b32 v164, v245, v164, s[52:53]
    v_cmp_ge_i32 s[52:53], v243, 16
    v_mfma_f32_32x32x16_bf16 v[128:143], a[76:79], a[140:143], v[128:143]
    ds_read_b128 a[124:127], v225 offset:15360
    s_add_u32 m0, m0, 4096
    v_cndmask_b32 v165, v245, v165, s[54:55]
    v_cmp_ge_i32 s[54:55], v243, 17
    v_cndmask_b32 v166, v245, v166, s[56:57]
    v_cmp_ge_i32 s[56:57], v243, 18
    v_cndmask_b32 v167, v245, v167, s[58:59]
    s_waitcnt lgkmcnt(8)
    v_mfma_f32_32x32x16_bf16 v[128:143], a[80:83], a[144:147], v[128:143]
    ds_read_b128 a[64:67], v225 offset:16384
    v_cmp_ge_i32 s[58:59], v243, 19
    v_cndmask_b32 v168, v245, v168, s[52:53]
    v_cmp_ge_i32 s[52:53], v243, 24
    v_cndmask_b32 v169, v245, v169, s[54:55]
    v_cmp_ge_i32 s[54:55], v243, 25
    v_cndmask_b32 v170, v245, v170, s[56:57]
    v_mfma_f32_32x32x16_bf16 v[128:143], a[84:87], a[148:151], v[128:143]
    ds_read_b128 a[68:71], v225 offset:17408
    s_nop 0
    v_cmp_ge_i32 s[56:57], v243, 26
    v_cndmask_b32 v171, v245, v171, s[58:59]
    v_cmp_ge_i32 s[58:59], v243, 27
    v_cndmask_b32 v172, v245, v172, s[52:53]
    v_cmp_ge_i32 s[52:53], v244, 0
    v_mfma_f32_32x32x16_bf16 v[128:143], a[88:91], a[152:155], v[128:143]
    ds_read_b128 a[72:75], v225 offset:18432
    buffer_load_dwordx4 v224, s[8:11], s45 offen offset:0  lds
    v_cndmask_b32 v173, v245, v173, s[54:55]
    v_cmp_ge_i32 s[54:55], v244, 1
    v_cndmask_b32 v174, v245, v174, s[56:57]
    v_cmp_ge_i32 s[56:57], v244, 2
    v_cndmask_b32 v175, v245, v175, s[58:59]
    v_cmp_ge_i32 s[58:59], v244, 3
    v_mfma_f32_32x32x16_bf16 v[128:143], a[92:95], a[156:159], v[128:143]
    ds_read_b128 a[76:79], v225 offset:19456
    v_cndmask_b32 v176, v245, v176, s[52:53]
    v_cmp_ge_i32 s[52:53], v244, 8
    v_cndmask_b32 v177, v245, v177, s[54:55]
    v_cmp_ge_i32 s[54:55], v244, 9
    v_cndmask_b32 v178, v245, v178, s[56:57]
    v_cmp_ge_i32 s[56:57], v244, 10
    s_waitcnt lgkmcnt(8)
    v_mfma_f32_32x32x16_bf16 v[128:143], a[96:99], a[160:163], v[128:143]
    ds_read_b128 a[80:83], v225 offset:20480
    buffer_load_dwordx4 v224, s[8:11], s45 offen offset:1024  lds
    v_cndmask_b32 v179, v245, v179, s[58:59]
    v_cmp_ge_i32 s[58:59], v244, 11
    v_cndmask_b32 v180, v245, v180, s[52:53]
    v_cmp_ge_i32 s[52:53], v244, 16
    v_cndmask_b32 v181, v245, v181, s[54:55]
    v_mfma_f32_32x32x16_bf16 v[128:143], a[100:103], a[164:167], v[128:143]
    ds_read_b128 a[84:87], v225 offset:21504
    buffer_load_dwordx4 v224, s[8:11], s45 offen offset:2048  lds
    v_cmp_ge_i32 s[54:55], v244, 17
    v_cndmask_b32 v182, v245, v182, s[56:57]
    v_cmp_ge_i32 s[56:57], v244, 18
    v_cndmask_b32 v183, v245, v183, s[58:59]
    v_cmp_ge_i32 s[58:59], v244, 19
    v_mfma_f32_32x32x16_bf16 v[128:143], a[104:107], a[168:171], v[128:143]
    ds_read_b128 a[88:91], v225 offset:22528
    buffer_load_dwordx4 v224, s[8:11], s45 offen offset:3072  lds
    v_cndmask_b32 v184, v245, v184, s[52:53]
    v_cmp_ge_i32 s[52:53], v244, 24
    v_cndmask_b32 v185, v245, v185, s[54:55]
    v_cmp_ge_i32 s[54:55], v244, 25
    v_cndmask_b32 v186, v245, v186, s[56:57]
    v_cmp_ge_i32 s[56:57], v244, 26
    v_mfma_f32_32x32x16_bf16 v[128:143], a[108:111], a[172:175], v[128:143]
    ds_read_b128 a[92:95], v225 offset:23552
    v_cndmask_b32 v187, v245, v187, s[58:59]
    v_cmp_ge_i32 s[58:59], v244, 27
    v_cndmask_b32 v188, v245, v188, s[52:53]
    s_nop 1
    v_cndmask_b32 v189, v245, v189, s[54:55]
    v_cndmask_b32 v190, v245, v190, s[56:57]
    s_waitcnt lgkmcnt(8)
    v_mfma_f32_32x32x16_bf16 v[128:143], a[112:115], a[176:179], v[128:143]
    ds_read_b128 a[96:99], v225 offset:24576
    s_add_u32 s38, s38, 1
    v_cndmask_b32 v191, v245, v191, s[58:59]
    v_exp_f32 v234, v160
    v_exp_f32 v235, v161
    v_mfma_f32_32x32x16_bf16 v[128:143], a[116:119], a[180:183], v[128:143]
    ds_read_b128 a[100:103], v225 offset:25600
    s_xor_b32 s34, s34, 32768
    v_exp_f32 v236, v162
    v_exp_f32 v237, v163
    v_mov_b32 v229, v234
    v_mfma_f32_32x32x16_bf16 v[128:143], a[120:123], a[184:187], v[128:143]
    ds_read_b128 a[104:107], v225 offset:26624
    v_mov_b32 v230, v235
    v_cvt_pk_bf16_f32 v208, v234, v235
    v_exp_f32 v238, v164
    v_exp_f32 v239, v165
    v_mov_b32 v231, v236
    v_mfma_f32_32x32x16_bf16 v[128:143], a[124:127], a[188:191], v[128:143]
    ds_read_b128 a[108:111], v225 offset:27648
    v_mov_b32 v232, v237
    v_cvt_pk_bf16_f32 v209, v236, v237
    v_exp_f32 v240, v166
    v_exp_f32 v241, v167
    s_waitcnt lgkmcnt(8)
    v_mfma_f32_32x32x16_bf16 v[144:159], a[64:67], a[128:131], 0
    ds_read_b128 a[112:115], v225 offset:28672
    v_add_f32 v229, v229, v238
    v_add_f32 v230, v230, v239
    v_cvt_pk_bf16_f32 v210, v238, v239
    v_exp_f32 v234, v168
    v_mfma_f32_32x32x16_bf16 v[144:159], a[68:71], a[132:135], v[144:159]
    ds_read_b128 a[116:119], v225 offset:29696
    v_exp_f32 v235, v169
    v_add_f32 v231, v231, v240
    v_add_f32 v232, v232, v241
    v_cvt_pk_bf16_f32 v211, v240, v241
    v_exp_f32 v236, v170
    v_mfma_f32_32x32x16_bf16 v[144:159], a[72:75], a[136:139], v[144:159]
    ds_read_b128 a[120:123], v225 offset:30720
    v_exp_f32 v237, v171
    v_add_f32 v229, v229, v234
    v_add_f32 v230, v230, v235
    v_cvt_pk_bf16_f32 v212, v234, v235
    v_exp_f32 v238, v172
    v_mfma_f32_32x32x16_bf16 v[144:159], a[76:79], a[140:143], v[144:159]
    ds_read_b128 a[124:127], v225 offset:31744
    v_exp_f32 v239, v173
    v_add_f32 v231, v231, v236
    v_add_f32 v232, v232, v237
    v_cvt_pk_bf16_f32 v213, v236, v237
    v_exp_f32 v240, v174
    s_waitcnt lgkmcnt(8)
    v_mfma_f32_32x32x16_bf16 v[144:159], a[80:83], a[144:147], v[144:159]
    ds_read_b128 a[64:67], v226 offset:0
    v_exp_f32 v241, v175
    v_add_f32 v229, v229, v238
    v_add_f32 v230, v230, v239
    v_cvt_pk_bf16_f32 v214, v238, v239
    v_mfma_f32_32x32x16_bf16 v[144:159], a[84:87], a[148:151], v[144:159]
    ds_read_b128 a[68:71], v226 offset:1024
    v_exp_f32 v234, v176
    v_exp_f32 v235, v177
    v_add_f32 v231, v231, v240
    v_add_f32 v232, v232, v241
    v_mfma_f32_32x32x16_bf16 v[144:159], a[88:91], a[152:155], v[144:159]
    ds_read_b128 a[72:75], v226 offset:2048
    v_cvt_pk_bf16_f32 v215, v240, v241
    v_exp_f32 v236, v178
    v_exp_f32 v237, v179
    v_add_f32 v229, v229, v234
    v_add_f32 v230, v230, v235
    v_mfma_f32_32x32x16_bf16 v[144:159], a[92:95], a[156:159], v[144:159]
    ds_read_b128 a[76:79], v226 offset:3072
    v_cvt_pk_bf16_f32 v216, v234, v235
    v_exp_f32 v238, v180
    v_exp_f32 v239, v181
    v_add_f32 v231, v231, v236
    s_waitcnt lgkmcnt(8)
    v_mfma_f32_32x32x16_bf16 v[144:159], a[96:99], a[160:163], v[144:159]
    ds_read_b128 a[80:83], v226 offset:4096
    v_add_f32 v232, v232, v237
    v_cvt_pk_bf16_f32 v217, v236, v237
    v_exp_f32 v240, v182
    v_exp_f32 v241, v183
    v_mfma_f32_32x32x16_bf16 v[144:159], a[100:103], a[164:167], v[144:159]
    ds_read_b128 a[84:87], v226 offset:5120
    v_add_f32 v229, v229, v238
    v_add_f32 v230, v230, v239
    v_cvt_pk_bf16_f32 v218, v238, v239
    v_exp_f32 v234, v184
    v_exp_f32 v235, v185
    v_mfma_f32_32x32x16_bf16 v[144:159], a[104:107], a[168:171], v[144:159]
    ds_read_b128 a[88:91], v226 offset:6144
    v_add_f32 v231, v231, v240
    v_add_f32 v232, v232, v241
    v_cvt_pk_bf16_f32 v219, v240, v241
    v_exp_f32 v236, v186
    v_mfma_f32_32x32x16_bf16 v[144:159], a[108:111], a[172:175], v[144:159]
    ds_read_b128 a[92:95], v226 offset:7168
    v_exp_f32 v237, v187
    v_add_f32 v229, v229, v234
    v_add_f32 v230, v230, v235
    v_cvt_pk_bf16_f32 v220, v234, v235
    v_exp_f32 v238, v188
    s_waitcnt lgkmcnt(8)
    v_mfma_f32_32x32x16_bf16 v[144:159], a[112:115], a[176:179], v[144:159]
    ds_read_b128 a[96:99], v226 offset:8192
    v_exp_f32 v239, v189
    v_add_f32 v231, v231, v236
    v_add_f32 v232, v232, v237
    v_cvt_pk_bf16_f32 v221, v236, v237
    v_mfma_f32_32x32x16_bf16 v[144:159], a[116:119], a[180:183], v[144:159]
    ds_read_b128 a[100:103], v226 offset:9216
    v_exp_f32 v240, v190
    v_exp_f32 v241, v191
    v_add_f32 v229, v229, v238
    v_add_f32 v230, v230, v239
    v_cvt_pk_bf16_f32 v222, v238, v239
    v_mfma_f32_32x32x16_bf16 v[144:159], a[120:123], a[184:187], v[144:159]
    ds_read_b128 a[104:107], v226 offset:10240
    s_nop 0
    v_add_f32 v231, v231, v240
    v_add_f32 v232, v232, v241
    v_cvt_pk_bf16_f32 v223, v240, v241
    v_add_f32 v229, v229, v230
    v_add_f32 v231, v231, v232
    v_add_f32 v229, v229, v231
    v_mfma_f32_32x32x16_bf16 v[144:159], a[124:127], a[188:191], v[144:159]
    ds_read_b128 a[108:111], v226 offset:11264
    s_waitcnt lgkmcnt(8)
    v_cmp_lt_f32 vcc, s51, v229
    s_mov_b32 s49, 14
    s_cbranch_vccnz attn_kernel_slow1
attn_kernel_ret14:
    v_add_f32 v228, v228, v229
    v_mfma_f32_32x32x16_bf16 v[0:15], a[64:67], v[208:211], v[0:15]
    ds_read_b128 a[112:115], v226 offset:12288
    s_cmp_lt_u32 s39, s73
    s_cselect_b32 s14, 1048576, 0
    v_mfma_f32_32x32x16_bf16 v[16:31], a[68:71], v[208:211], v[16:31]
    ds_read_b128 a[116:119], v226 offset:13312
    s_sub_u32 s46, s39, s74
    s_xor_b32 s36, s36, 32768
    v_mfma_f32_32x32x16_bf16 v[32:47], a[72:75], v[208:211], v[32:47]
    ds_read_b128 a[120:123], v226 offset:14336
    s_add_u32 s44, s39, s75
    v_add_u32 v225, s36, v224
    v_mfma_f32_32x32x16_bf16 v[48:63], a[76:79], v[208:211], v[48:63]
    ds_read_b128 a[124:127], v226 offset:15360
    s_cmp_lt_u32 s39, s74
    s_cselect_b32 s46, s44, s46
    s_waitcnt lgkmcnt(8)
    v_mfma_f32_32x32x16_bf16 v[64:79], a[80:83], v[208:211], v[64:79]
    ds_read_b128 a[64:67], v226 offset:16384
    s_lshl_b32 s46, s46, 15
    v_mfma_f32_32x32x16_bf16 v[80:95], a[84:87], v[208:211], v[80:95]
    ds_read_b128 a[68:71], v226 offset:17408
    s_add_u32 m0, s35, s7
    v_mfma_f32_32x32x16_bf16 v[96:111], a[88:91], v[208:211], v[96:111]
    ds_read_b128 a[72:75], v226 offset:18432
    s_add_u32 s46, s46, s40
    v_mfma_f32_32x32x16_bf16 v[112:127], a[92:95], v[208:211], v[112:127]
    ds_read_b128 a[76:79], v226 offset:19456
    buffer_load_dwordx4 v224, s[12:15], s46 offen offset:0  lds
    s_waitcnt lgkmcnt(8)
    v_mfma_f32_32x32x16_bf16 v[0:15], a[96:99], v[212:215], v[0:15]
    ds_read_b128 a[80:83], v226 offset:20480
    buffer_load_dwordx4 v224, s[12:15], s46 offen offset:1024  lds
    v_mfma_f32_32x32x16_bf16 v[16:31], a[100:103], v[212:215], v[16:31]
    ds_read_b128 a[84:87], v226 offset:21504
    buffer_load_dwordx4 v224, s[12:15], s46 offen offset:2048  lds
    v_mfma_f32_32x32x16_bf16 v[32:47], a[104:107], v[212:215], v[32:47]
    ds_read_b128 a[88:91], v226 offset:22528
    buffer_load_dwordx4 v224, s[12:15], s46 offen offset:3072  lds
    v_mfma_f32_32x32x16_bf16 v[48:63], a[108:111], v[212:215], v[48:63]
    ds_read_b128 a[92:95], v226 offset:23552
    s_add_u32 m0, s35, s7
    s_waitcnt lgkmcnt(8)
    v_mfma_f32_32x32x16_bf16 v[64:79], a[112:115], v[212:215], v[64:79]
    ds_read_b128 a[96:99], v226 offset:24576
    s_add_u32 s46, s46, 4096
    v_mfma_f32_32x32x16_bf16 v[80:95], a[116:119], v[212:215], v[80:95]
    ds_read_b128 a[100:103], v226 offset:25600
    s_add_u32 m0, m0, 4096
    v_mfma_f32_32x32x16_bf16 v[96:111], a[120:123], v[212:215], v[96:111]
    ds_read_b128 a[104:107], v226 offset:26624
    s_nop 0
    v_mfma_f32_32x32x16_bf16 v[112:127], a[124:127], v[212:215], v[112:127]
    ds_read_b128 a[108:111], v226 offset:27648
    buffer_load_dwordx4 v224, s[12:15], s46 offen offset:0  lds
    s_waitcnt lgkmcnt(8)
    v_mfma_f32_32x32x16_bf16 v[0:15], a[64:67], v[216:219], v[0:15]
    ds_read_b128 a[112:115], v226 offset:28672
    buffer_load_dwordx4 v224, s[12:15], s46 offen offset:1024  lds
    v_mfma_f32_32x32x16_bf16 v[16:31], a[68:71], v[216:219], v[16:31]
    ds_read_b128 a[116:119], v226 offset:29696
    buffer_load_dwordx4 v224, s[12:15], s46 offen offset:2048  lds
    v_mfma_f32_32x32x16_bf16 v[32:47], a[72:75], v[216:219], v[32:47]
    ds_read_b128 a[120:123], v226 offset:30720
    buffer_load_dwordx4 v224, s[12:15], s46 offen offset:3072  lds
    v_mfma_f32_32x32x16_bf16 v[48:63], a[76:79], v[216:219], v[48:63]
    ds_read_b128 a[124:127], v226 offset:31744
    s_add_u32 s39, s39, 1
    s_waitcnt lgkmcnt(8)
    v_mfma_f32_32x32x16_bf16 v[64:79], a[80:83], v[216:219], v[64:79]
    s_add_u32 s35, s35, 32768
    s_add_u32 s37, s37, 32768
    s_cmp_eq_u32 s37, 98304
    s_cselect_b32 s37, 0, s37
    v_mfma_f32_32x32x16_bf16 v[80:95], a[84:87], v[216:219], v[80:95]
    s_cmp_eq_u32 s35, 98304
    s_cselect_b32 s35, 0, s35
    s_add_u32 s42, s37, 65536
    v_add_u32 v226, s42, v224
    v_mfma_f32_32x32x16_bf16 v[96:111], a[88:91], v[216:219], v[96:111]
    s_add_u32 s31, s31, 1
    v_mfma_f32_32x32x16_bf16 v[112:127], a[92:95], v[216:219], v[112:127]
    s_waitcnt vmcnt(8) lgkmcnt(0)
    s_barrier
    v_mfma_f32_32x32x16_bf16 v[0:15], a[96:99], v[220:223], v[0:15]
    ds_read_b128 a[64:67], v225 offset:0
    ds_read_b128 a[68:71], v225 offset:1024
    s_cmp_lt_u32 s38, s73
    s_cselect_b32 s10, 1048576, 0
    s_sub_u32 s45, s38, s74
    v_mfma_f32_32x32x16_bf16 v[16:31], a[100:103], v[220:223], v[16:31]
    ds_read_b128 a[72:75], v225 offset:2048
    ds_read_b128 a[76:79], v225 offset:3072
    s_add_u32 s44, s38, s75
    s_cmp_lt_u32 s38, s74
    s_cselect_b32 s45, s44, s45
    v_mfma_f32_32x32x16_bf16 v[32:47], a[104:107], v[220:223], v[32:47]
    ds_read_b128 a[80:83], v225 offset:4096
    ds_read_b128 a[84:87], v225 offset:5120
    s_lshl_b32 s45, s45, 15
    v_mfma_f32_32x32x16_bf16 v[48:63], a[108:111], v[220:223], v[48:63]
    ds_read_b128 a[88:91], v225 offset:6144
    ds_read_b128 a[92:95], v225 offset:7168
    s_add_u32 m0, s34, s40
    s_add_u32 s45, s45, s40
    v_mfma_f32_32x32x16_bf16 v[64:79], a[112:115], v[220:223], v[64:79]
    ds_read_b128 a[96:99], v225 offset:8192
    buffer_load_dwordx4 v224, s[8:11], s45 offen offset:0  lds
    v_mfma_f32_32x32x16_bf16 v[80:95], a[116:119], v[220:223], v[80:95]
    ds_read_b128 a[100:103], v225 offset:9216
    buffer_load_dwordx4 v224, s[8:11], s45 offen offset:1024  lds
    buffer_load_dwordx4 v224, s[8:11], s45 offen offset:2048  lds
    v_mfma_f32_32x32x16_bf16 v[96:111], a[120:123], v[220:223], v[96:111]
    ds_read_b128 a[104:107], v225 offset:10240
    buffer_load_dwordx4 v224, s[8:11], s45 offen offset:3072  lds
    v_mfma_f32_32x32x16_bf16 v[112:127], a[124:127], v[220:223], v[112:127]
    ds_read_b128 a[108:111], v225 offset:11264
    s_branch attn_kernel_chain0
attn_kernel_body_1_0_0:
    s_waitcnt lgkmcnt(0)
    ds_read_b128 a[64:67], v226 offset:0
    ds_read_b128 a[68:71], v226 offset:1024
    ds_read_b128 a[72:75], v226 offset:2048
    ds_read_b128 a[76:79], v226 offset:3072
    ds_read_b128 a[80:83], v226 offset:4096
    ds_read_b128 a[84:87], v226 offset:5120
    ds_read_b128 a[88:91], v226 offset:6144
    ds_read_b128 a[92:95], v226 offset:7168
    ds_read_b128 a[96:99], v226 offset:8192
    ds_read_b128 a[100:103], v226 offset:9216
    ds_read_b128 a[104:107], v226 offset:10240
    ds_read_b128 a[108:111], v226 offset:11264
    ds_read_b128 a[112:115], v226 offset:12288
    ds_read_b128 a[116:119], v226 offset:13312
    ds_read_b128 a[120:123], v226 offset:14336
    ds_read_b128 a[124:127], v226 offset:15360
    v_exp_f32 v234, v160
    v_exp_f32 v235, v161
    v_exp_f32 v236, v162
    v_exp_f32 v237, v163
    v_mov_b32 v229, v234
    v_mov_b32 v230, v235
    v_cvt_pk_bf16_f32 v208, v234, v235
    v_exp_f32 v238, v164
    v_exp_f32 v239, v165
    v_mov_b32 v231, v236
    v_mov_b32 v232, v237
    v_cvt_pk_bf16_f32 v209, v236, v237
    v_exp_f32 v240, v166
    v_exp_f32 v241, v167
    v_add_f32 v229, v229, v238
    v_add_f32 v230, v230, v239
    v_cvt_pk_bf16_f32 v210, v238, v239
    v_exp_f32 v234, v168
    v_exp_f32 v235, v169
    v_add_f32 v231, v231, v240
    v_add_f32 v232, v232, v241
    v_cvt_pk_bf16_f32 v211, v240, v241
    v_exp_f32 v236, v170
    v_exp_f32 v237, v171
    v_add_f32 v229, v229, v234
    v_add_f32 v230, v230, v235
    v_cvt_pk_bf16_f32 v212, v234, v235
    v_exp_f32 v238, v172
    v_exp_f32 v239, v173
    v_add_f32 v231, v231, v236
    v_add_f32 v232, v232, v237
    v_cvt_pk_bf16_f32 v213, v236, v237
    v_exp_f32 v240, v174
    v_exp_f32 v241, v175
    v_add_f32 v229, v229, v238
    v_add_f32 v230, v230, v239
    v_cvt_pk_bf16_f32 v214, v238, v239
    v_exp_f32 v234, v176
    v_exp_f32 v235, v177
    v_add_f32 v231, v231, v240
    v_add_f32 v232, v232, v241
    v_cvt_pk_bf16_f32 v215, v240, v241
    v_exp_f32 v236, v178
    v_exp_f32 v237, v179
    v_add_f32 v229, v229, v234
    v_add_f32 v230, v230, v235
    v_cvt_pk_bf16_f32 v216, v234, v235
    v_exp_f32 v238, v180
    v_exp_f32 v239, v181
    v_add_f32 v231, v231, v236
    v_add_f32 v232, v232, v237
    v_cvt_pk_bf16_f32 v217, v236, v237
    v_exp_f32 v240, v182
    v_exp_f32 v241, v183
    v_add_f32 v229, v229, v238
    v_add_f32 v230, v230, v239
    v_cvt_pk_bf16_f32 v218, v238, v239
    v_exp_f32 v234, v184
    v_exp_f32 v235, v185
    v_add_f32 v231, v231, v240
    v_add_f32 v232, v232, v241
    v_cvt_pk_bf16_f32 v219, v240, v241
    v_exp_f32 v236, v186
    v_exp_f32 v237, v187
    v_add_f32 v229, v229, v234
    v_add_f32 v230, v230, v235
    v_cvt_pk_bf16_f32 v220, v234, v235
    v_exp_f32 v238, v188
    v_exp_f32 v239, v189
    v_add_f32 v231, v231, v236
    v_add_f32 v232, v232, v237
    v_cvt_pk_bf16_f32 v221, v236, v237
    v_exp_f32 v240, v190
    v_exp_f32 v241, v191
    v_add_f32 v229, v229, v238
    v_add_f32 v230, v230, v239
    v_cvt_pk_bf16_f32 v222, v238, v239
    s_nop 0
    v_add_f32 v231, v231, v240
    v_add_f32 v232, v232, v241
    v_cvt_pk_bf16_f32 v223, v240, v241
    v_add_f32 v229, v229, v230
    v_add_f32 v231, v231, v232
    v_add_f32 v229, v229, v231
    v_cmp_lt_f32 vcc, s51, v229
    s_mov_b32 s49, 8
    s_cbranch_vccnz attn_kernel_slow1
attn_kernel_ret8:
    v_add_f32 v228, v228, v229
    s_waitcnt lgkmcnt(0)
    v_mfma_f32_32x32x16_bf16 v[0:15], a[64:67], v[208:211], v[0:15]
    ds_read_b128 a[64:67], v226 offset:16384
    v_mfma_f32_32x32x16_bf16 v[16:31], a[68:71], v[208:211], v[16:31]
    ds_read_b128 a[68:71], v226 offset:17408
    v_mfma_f32_32x32x16_bf16 v[32:47], a[72:75], v[208:211], v[32:47]
    ds_read_b128 a[72:75], v226 offset:18432
    v_mfma_f32_32x32x16_bf16 v[48:63], a[76:79], v[208:211], v[48:63]
    ds_read_b128 a[76:79], v226 offset:19456
    v_mfma_f32_32x32x16_bf16 v[64:79], a[80:83], v[208:211], v[64:79]
    ds_read_b128 a[80:83], v226 offset:20480
    v_mfma_f32_32x32x16_bf16 v[80:95], a[84:87], v[208:211], v[80:95]
    ds_read_b128 a[84:87], v226 offset:21504
    v_mfma_f32_32x32x16_bf16 v[96:111], a[88:91], v[208:211], v[96:111]
    ds_read_b128 a[88:91], v226 offset:22528
    v_mfma_f32_32x32x16_bf16 v[112:127], a[92:95], v[208:211], v[112:127]
    ds_read_b128 a[92:95], v226 offset:23552
    v_mfma_f32_32x32x16_bf16 v[0:15], a[96:99], v[212:215], v[0:15]
    ds_read_b128 a[96:99], v226 offset:24576
    v_mfma_f32_32x32x16_bf16 v[16:31], a[100:103], v[212:215], v[16:31]
    ds_read_b128 a[100:103], v226 offset:25600
    v_mfma_f32_32x32x16_bf16 v[32:47], a[104:107], v[212:215], v[32:47]
    ds_read_b128 a[104:107], v226 offset:26624
    v_mfma_f32_32x32x16_bf16 v[48:63], a[108:111], v[212:215], v[48:63]
    ds_read_b128 a[108:111], v226 offset:27648
    v_mfma_f32_32x32x16_bf16 v[64:79], a[112:115], v[212:215], v[64:79]
    ds_read_b128 a[112:115], v226 offset:28672
    v_mfma_f32_32x32x16_bf16 v[80:95], a[116:119], v[212:215], v[80:95]
    ds_read_b128 a[116:119], v226 offset:29696
    v_mfma_f32_32x32x16_bf16 v[96:111], a[120:123], v[212:215], v[96:111]
    ds_read_b128 a[120:123], v226 offset:30720
    v_mfma_f32_32x32x16_bf16 v[112:127], a[124:127], v[212:215], v[112:127]
    ds_read_b128 a[124:127], v226 offset:31744
    s_waitcnt lgkmcnt(8)
    v_mfma_f32_32x32x16_bf16 v[0:15], a[64:67], v[216:219], v[0:15]
    v_mfma_f32_32x32x16_bf16 v[16:31], a[68:71], v[216:219], v[16:31]
    v_mfma_f32_32x32x16_bf16 v[32:47], a[72:75], v[216:219], v[32:47]
    v_mfma_f32_32x32x16_bf16 v[48:63], a[76:79], v[216:219], v[48:63]
    v_mfma_f32_32x32x16_bf16 v[64:79], a[80:83], v[216:219], v[64:79]
    v_mfma_f32_32x32x16_bf16 v[80:95], a[84:87], v[216:219], v[80:95]
    v_mfma_f32_32x32x16_bf16 v[96:111], a[88:91], v[216:219], v[96:111]
    v_mfma_f32_32x32x16_bf16 v[112:127], a[92:95], v[216:219], v[112:127]
    s_waitcnt lgkmcnt(0)
    v_mfma_f32_32x32x16_bf16 v[0:15], a[96:99], v[220:223], v[0:15]
    v_mfma_f32_32x32x16_bf16 v[16:31], a[100:103], v[220:223], v[16:31]
    v_mfma_f32_32x32x16_bf16 v[32:47], a[104:107], v[220:223], v[32:47]
    v_mfma_f32_32x32x16_bf16 v[48:63], a[108:111], v[220:223], v[48:63]
    v_mfma_f32_32x32x16_bf16 v[64:79], a[112:115], v[220:223], v[64:79]
    v_mfma_f32_32x32x16_bf16 v[80:95], a[116:119], v[220:223], v[80:95]
    v_mfma_f32_32x32x16_bf16 v[96:111], a[120:123], v[220:223], v[96:111]
    v_mfma_f32_32x32x16_bf16 v[112:127], a[124:127], v[220:223], v[112:127]
    s_branch attn_kernel_epi
attn_kernel_body_1_1_0:
    s_waitcnt lgkmcnt(0)
    ds_read_b128 a[64:67], v226 offset:0
    ds_read_b128 a[68:71], v226 offset:1024
    ds_read_b128 a[72:75], v226 offset:2048
    ds_read_b128 a[76:79], v226 offset:3072
    ds_read_b128 a[80:83], v226 offset:4096
    ds_read_b128 a[84:87], v226 offset:5120
    ds_read_b128 a[88:91], v226 offset:6144
    ds_read_b128 a[92:95], v226 offset:7168
    ds_read_b128 a[96:99], v226 offset:8192
    ds_read_b128 a[100:103], v226 offset:9216
    ds_read_b128 a[104:107], v226 offset:10240
    ds_read_b128 a[108:111], v226 offset:11264
    ds_read_b128 a[112:115], v226 offset:12288
    ds_read_b128 a[116:119], v226 offset:13312
    ds_read_b128 a[120:123], v226 offset:14336
    ds_read_b128 a[124:127], v226 offset:15360
    s_lshl_b32 s41, s31, 6
    v_subrev_u32 v243, s41, v242
    v_subrev_u32 v244, 32, v243
    v_cmp_ge_i32 s[52:53], v243, 0
    v_cmp_ge_i32 s[54:55], v243, 1
    v_cmp_ge_i32 s[56:57], v243, 2
    v_cmp_ge_i32 s[58:59], v243, 3
    v_cndmask_b32 v160, v245, v160, s[52:53]
    v_cmp_ge_i32 s[52:53], v243, 8
    v_cndmask_b32 v161, v245, v161, s[54:55]
    v_cmp_ge_i32 s[54:55], v243, 9
    v_cndmask_b32 v162, v245, v162, s[56:57]
    v_cmp_ge_i32 s[56:57], v243, 10
    v_cndmask_b32 v163, v245, v163, s[58:59]
    v_cmp_ge_i32 s[58:59], v243, 11
    v_cndmask_b32 v164, v245, v164, s[52:53]
    v_cmp_ge_i32 s[52:53], v243, 16
    v_cndmask_b32 v165, v245, v165, s[54:55]
    v_cmp_ge_i32 s[54:55], v243, 17
    v_cndmask_b32 v166, v245, v166, s[56:57]
    v_cmp_ge_i32 s[56:57], v243, 18
    v_cndmask_b32 v167, v245, v167, s[58:59]
    v_cmp_ge_i32 s[58:59], v243, 19
    v_cndmask_b32 v168, v245, v168, s[52:53]
    v_cmp_ge_i32 s[52:53], v243, 24
    v_cndmask_b32 v169, v245, v169, s[54:55]
    v_cmp_ge_i32 s[54:55], v243, 25
    v_cndmask_b32 v170, v245, v170, s[56:57]
    v_cmp_ge_i32 s[56:57], v243, 26
    v_cndmask_b32 v171, v245, v171, s[58:59]
    v_cmp_ge_i32 s[58:59], v243, 27
    v_cndmask_b32 v172, v245, v172, s[52:53]
    v_cmp_ge_i32 s[52:53], v244, 0
    v_cndmask_b32 v173, v245, v173, s[54:55]
    v_cmp_ge_i32 s[54:55], v244, 1
    v_cndmask_b32 v174, v245, v174, s[56:57]
    v_cmp_ge_i32 s[56:57], v244, 2
    v_cndmask_b32 v175, v245, v175, s[58:59]
    v_cmp_ge_i32 s[58:59], v244, 3
    v_cndmask_b32 v176, v245, v176, s[52:53]
    v_cmp_ge_i32 s[52:53], v244, 8
    v_cndmask_b32 v177, v245, v177, s[54:55]
    v_cmp_ge_i32 s[54:55], v244, 9
    v_cndmask_b32 v178, v245, v178, s[56:57]
    v_cmp_ge_i32 s[56:57], v244, 10
    v_cndmask_b32 v179, v245, v179, s[58:59]
    v_cmp_ge_i32 s[58:59], v244, 11
    v_cndmask_b32 v180, v245, v180, s[52:53]
    v_cmp_ge_i32 s[52:53], v244, 16
    v_cndmask_b32 v181, v245, v181, s[54:55]
    v_cmp_ge_i32 s[54:55], v244, 17
    v_cndmask_b32 v182, v245, v182, s[56:57]
    v_cmp_ge_i32 s[56:57], v244, 18
    v_cndmask_b32 v183, v245, v183, s[58:59]
    v_cmp_ge_i32 s[58:59], v244, 19
    v_cndmask_b32 v184, v245, v184, s[52:53]
    v_cmp_ge_i32 s[52:53], v244, 24
    v_cndmask_b32 v185, v245, v185, s[54:55]
    v_cmp_ge_i32 s[54:55], v244, 25
    v_cndmask_b32 v186, v245, v186, s[56:57]
    v_cmp_ge_i32 s[56:57], v244, 26
    v_cndmask_b32 v187, v245, v187, s[58:59]
    v_cmp_ge_i32 s[58:59], v244, 27
    v_cndmask_b32 v188, v245, v188, s[52:53]
    s_nop 1
    v_cndmask_b32 v189, v245, v189, s[54:55]
    v_cndmask_b32 v190, v245, v190, s[56:57]
    v_cndmask_b32 v191, v245, v191, s[58:59]
    v_exp_f32 v234, v160
    v_exp_f32 v235, v161
    v_exp_f32 v236, v162
    v_exp_f32 v237, v163
    v_mov_b32 v229, v234
    v_mov_b32 v230, v235
    v_cvt_pk_bf16_f32 v208, v234, v235
    v_exp_f32 v238, v164
    v_exp_f32 v239, v165
    v_mov_b32 v231, v236
    v_mov_b32 v232, v237
    v_cvt_pk_bf16_f32 v209, v236, v237
    v_exp_f32 v240, v166
    v_exp_f32 v241, v167
    v_add_f32 v229, v229, v238
    v_add_f32 v230, v230, v239
    v_cvt_pk_bf16_f32 v210, v238, v239
    v_exp_f32 v234, v168
    v_exp_f32 v235, v169
    v_add_f32 v231, v231, v240
    v_add_f32 v232, v232, v241
    v_cvt_pk_bf16_f32 v211, v240, v241
    v_exp_f32 v236, v170
    v_exp_f32 v237, v171
    v_add_f32 v229, v229, v234
    v_add_f32 v230, v230, v235
    v_cvt_pk_bf16_f32 v212, v234, v235
    v_exp_f32 v238, v172
    v_exp_f32 v239, v173
    v_add_f32 v231, v231, v236
    v_add_f32 v232, v232, v237
    v_cvt_pk_bf16_f32 v213, v236, v237
    v_exp_f32 v240, v174
    v_exp_f32 v241, v175
    v_add_f32 v229, v229, v238
    v_add_f32 v230, v230, v239
    v_cvt_pk_bf16_f32 v214, v238, v239
    v_exp_f32 v234, v176
    v_exp_f32 v235, v177
    v_add_f32 v231, v231, v240
    v_add_f32 v232, v232, v241
    v_cvt_pk_bf16_f32 v215, v240, v241
    v_exp_f32 v236, v178
    v_exp_f32 v237, v179
    v_add_f32 v229, v229, v234
    v_add_f32 v230, v230, v235
    v_cvt_pk_bf16_f32 v216, v234, v235
    v_exp_f32 v238, v180
    v_exp_f32 v239, v181
    v_add_f32 v231, v231, v236
    v_add_f32 v232, v232, v237
    v_cvt_pk_bf16_f32 v217, v236, v237
    v_exp_f32 v240, v182
    v_exp_f32 v241, v183
    v_add_f32 v229, v229, v238
    v_add_f32 v230, v230, v239
    v_cvt_pk_bf16_f32 v218, v238, v239
    v_exp_f32 v234, v184
    v_exp_f32 v235, v185
    v_add_f32 v231, v231, v240
    v_add_f32 v232, v232, v241
    v_cvt_pk_bf16_f32 v219, v240, v241
    v_exp_f32 v236, v186
    v_exp_f32 v237, v187
    v_add_f32 v229, v229, v234
    v_add_f32 v230, v230, v235
    v_cvt_pk_bf16_f32 v220, v234, v235
    v_exp_f32 v238, v188
    v_exp_f32 v239, v189
    v_add_f32 v231, v231, v236
    v_add_f32 v232, v232, v237
    v_cvt_pk_bf16_f32 v221, v236, v237
    v_exp_f32 v240, v190
    v_exp_f32 v241, v191
    v_add_f32 v229, v229, v238
    v_add_f32 v230, v230, v239
    v_cvt_pk_bf16_f32 v222, v238, v239
    s_nop 0
    v_add_f32 v231, v231, v240
    v_add_f32 v232, v232, v241
    v_cvt_pk_bf16_f32 v223, v240, v241
    v_add_f32 v229, v229, v230
    v_add_f32 v231, v231, v232
    v_add_f32 v229, v229, v231
    v_cmp_lt_f32 vcc, s51, v229
    s_mov_b32 s49, 12
    s_cbranch_vccnz attn_kernel_slow1
attn_kernel_ret12:
    v_add_f32 v228, v228, v229
    s_waitcnt lgkmcnt(0)
    v_mfma_f32_32x32x16_bf16 v[0:15], a[64:67], v[208:211], v[0:15]
    ds_read_b128 a[64:67], v226 offset:16384
    v_mfma_f32_32x32x16_bf16 v[16:31], a[68:71], v[208:211], v[16:31]
    ds_read_b128 a[68:71], v226 offset:17408
    v_mfma_f32_32x32x16_bf16 v[32:47], a[72:75], v[208:211], v[32:47]
    ds_read_b128 a[72:75], v226 offset:18432
    v_mfma_f32_32x32x16_bf16 v[48:63], a[76:79], v[208:211], v[48:63]
    ds_read_b128 a[76:79], v226 offset:19456
    v_mfma_f32_32x32x16_bf16 v[64:79], a[80:83], v[208:211], v[64:79]
    ds_read_b128 a[80:83], v226 offset:20480
    v_mfma_f32_32x32x16_bf16 v[80:95], a[84:87], v[208:211], v[80:95]
    ds_read_b128 a[84:87], v226 offset:21504
    v_mfma_f32_32x32x16_bf16 v[96:111], a[88:91], v[208:211], v[96:111]
    ds_read_b128 a[88:91], v226 offset:22528
    v_mfma_f32_32x32x16_bf16 v[112:127], a[92:95], v[208:211], v[112:127]
    ds_read_b128 a[92:95], v226 offset:23552
    v_mfma_f32_32x32x16_bf16 v[0:15], a[96:99], v[212:215], v[0:15]
    ds_read_b128 a[96:99], v226 offset:24576
    v_mfma_f32_32x32x16_bf16 v[16:31], a[100:103], v[212:215], v[16:31]
    ds_read_b128 a[100:103], v226 offset:25600
    v_mfma_f32_32x32x16_bf16 v[32:47], a[104:107], v[212:215], v[32:47]
    ds_read_b128 a[104:107], v226 offset:26624
    v_mfma_f32_32x32x16_bf16 v[48:63], a[108:111], v[212:215], v[48:63]
    ds_read_b128 a[108:111], v226 offset:27648
    v_mfma_f32_32x32x16_bf16 v[64:79], a[112:115], v[212:215], v[64:79]
    ds_read_b128 a[112:115], v226 offset:28672
    v_mfma_f32_32x32x16_bf16 v[80:95], a[116:119], v[212:215], v[80:95]
    ds_read_b128 a[116:119], v226 offset:29696
    v_mfma_f32_32x32x16_bf16 v[96:111], a[120:123], v[212:215], v[96:111]
    ds_read_b128 a[120:123], v226 offset:30720
    v_mfma_f32_32x32x16_bf16 v[112:127], a[124:127], v[212:215], v[112:127]
    ds_read_b128 a[124:127], v226 offset:31744
    s_waitcnt lgkmcnt(8)
    v_mfma_f32_32x32x16_bf16 v[0:15], a[64:67], v[216:219], v[0:15]
    v_mfma_f32_32x32x16_bf16 v[16:31], a[68:71], v[216:219], v[16:31]
    v_mfma_f32_32x32x16_bf16 v[32:47], a[72:75], v[216:219], v[32:47]
    v_mfma_f32_32x32x16_bf16 v[48:63], a[76:79], v[216:219], v[48:63]
    v_mfma_f32_32x32x16_bf16 v[64:79], a[80:83], v[216:219], v[64:79]
    v_mfma_f32_32x32x16_bf16 v[80:95], a[84:87], v[216:219], v[80:95]
    v_mfma_f32_32x32x16_bf16 v[96:111], a[88:91], v[216:219], v[96:111]
    v_mfma_f32_32x32x16_bf16 v[112:127], a[92:95], v[216:219], v[112:127]
    s_waitcnt lgkmcnt(0)
    v_mfma_f32_32x32x16_bf16 v[0:15], a[96:99], v[220:223], v[0:15]
    v_mfma_f32_32x32x16_bf16 v[16:31], a[100:103], v[220:223], v[16:31]
    v_mfma_f32_32x32x16_bf16 v[32:47], a[104:107], v[220:223], v[32:47]
    v_mfma_f32_32x32x16_bf16 v[48:63], a[108:111], v[220:223], v[48:63]
    v_mfma_f32_32x32x16_bf16 v[64:79], a[112:115], v[220:223], v[64:79]
    v_mfma_f32_32x32x16_bf16 v[80:95], a[116:119], v[220:223], v[80:95]
    v_mfma_f32_32x32x16_bf16 v[96:111], a[120:123], v[220:223], v[96:111]
    v_mfma_f32_32x32x16_bf16 v[112:127], a[124:127], v[220:223], v[112:127]
    s_branch attn_kernel_epi
attn_kernel_chain0:
    s_nop 7
    s_nop 7
    v_mov_b32 v246, v228
    v_mov_b32 v247, v228
    s_nop 1
    v_permlane32_swap_b32 v246, v247
    s_nop 1
    v_add_f32 v228, v246, v247
    v_mov_b32 v247, 0xf149f2ca
    v_cmp_lt_f32 vcc, 0, v228
    v_mov_b32 v235, v228
    v_lshrrev_b32 v248, 1, v224
    v_cndmask_b32 v234, v247, v250, vcc
    s_mov_b32 s42, 0
    v_cvt_pk_bf16_f32 v160, v0, v1
    v_cvt_pk_bf16_f32 v161, v2, v3
    v_cvt_pk_bf16_f32 v162, v4, v5
    v_cvt_pk_bf16_f32 v163, v6, v7
    buffer_store_dwordx4 v[160:163], v224, s[24:27], s42 offen offset:0 sc1
    v_cvt_pk_bf16_f32 v164, v8, v9
    v_cvt_pk_bf16_f32 v165, v10, v11
    v_cvt_pk_bf16_f32 v166, v12, v13
    v_cvt_pk_bf16_f32 v167, v14, v15
    buffer_store_dwordx4 v[164:167], v224, s[24:27], s42 offen offset:1024 sc1
    v_cvt_pk_bf16_f32 v168, v16, v17
    v_cvt_pk_bf16_f32 v169, v18, v19
    v_cvt_pk_bf16_f32 v170, v20, v21
    v_cvt_pk_bf16_f32 v171, v22, v23
    buffer_store_dwordx4 v[168:171], v224, s[24:27], s42 offen offset:2048 sc1
    v_cvt_pk_bf16_f32 v172, v24, v25
    v_cvt_pk_bf16_f32 v173, v26, v27
    v_cvt_pk_bf16_f32 v174, v28, v29
    v_cvt_pk_bf16_f32 v175, v30, v31
    buffer_store_dwordx4 v[172:175], v224, s[24:27], s42 offen offset:3072 sc1
    s_add_u32 s42, s42, 4096
    v_cvt_pk_bf16_f32 v176, v32, v33
    v_cvt_pk_bf16_f32 v177, v34, v35
    v_cvt_pk_bf16_f32 v178, v36, v37
    v_cvt_pk_bf16_f32 v179, v38, v39
    buffer_store_dwordx4 v[176:179], v224, s[24:27], s42 offen offset:0 sc1
    v_cvt_pk_bf16_f32 v180, v40, v41
    v_cvt_pk_bf16_f32 v181, v42, v43
    v_cvt_pk_bf16_f32 v182, v44, v45
    v_cvt_pk_bf16_f32 v183, v46, v47
    buffer_store_dwordx4 v[180:183], v224, s[24:27], s42 offen offset:1024 sc1
    v_cvt_pk_bf16_f32 v184, v48, v49
    v_cvt_pk_bf16_f32 v185, v50, v51
    v_cvt_pk_bf16_f32 v186, v52, v53
    v_cvt_pk_bf16_f32 v187, v54, v55
    buffer_store_dwordx4 v[184:187], v224, s[24:27], s42 offen offset:2048 sc1
    v_cvt_pk_bf16_f32 v188, v56, v57
    v_cvt_pk_bf16_f32 v189, v58, v59
    v_cvt_pk_bf16_f32 v190, v60, v61
    v_cvt_pk_bf16_f32 v191, v62, v63
    buffer_store_dwordx4 v[188:191], v224, s[24:27], s42 offen offset:3072 sc1
    s_add_u32 s42, s42, 4096
    v_cvt_pk_bf16_f32 v160, v64, v65
    v_cvt_pk_bf16_f32 v161, v66, v67
    v_cvt_pk_bf16_f32 v162, v68, v69
    v_cvt_pk_bf16_f32 v163, v70, v71
    buffer_store_dwordx4 v[160:163], v224, s[24:27], s42 offen offset:0 sc1
    v_cvt_pk_bf16_f32 v164, v72, v73
    v_cvt_pk_bf16_f32 v165, v74, v75
    v_cvt_pk_bf16_f32 v166, v76, v77
    v_cvt_pk_bf16_f32 v167, v78, v79
    buffer_store_dwordx4 v[164:167], v224, s[24:27], s42 offen offset:1024 sc1
    v_cvt_pk_bf16_f32 v168, v80, v81
    v_cvt_pk_bf16_f32 v169, v82, v83
    v_cvt_pk_bf16_f32 v170, v84, v85
    v_cvt_pk_bf16_f32 v171, v86, v87
    buffer_store_dwordx4 v[168:171], v224, s[24:27], s42 offen offset:2048 sc1
    v_cvt_pk_bf16_f32 v172, v88, v89
    v_cvt_pk_bf16_f32 v173, v90, v91
    v_cvt_pk_bf16_f32 v174, v92, v93
    v_cvt_pk_bf16_f32 v175, v94, v95
    buffer_store_dwordx4 v[172:175], v224, s[24:27], s42 offen offset:3072 sc1
    s_add_u32 s42, s42, 4096
    v_cvt_pk_bf16_f32 v176, v96, v97
    v_cvt_pk_bf16_f32 v177, v98, v99
    v_cvt_pk_bf16_f32 v178, v100, v101
    v_cvt_pk_bf16_f32 v179, v102, v103
    buffer_store_dwordx4 v[176:179], v224, s[24:27], s42 offen offset:0 sc1
    v_cvt_pk_bf16_f32 v180, v104, v105
    v_cvt_pk_bf16_f32 v181, v106, v107
    v_cvt_pk_bf16_f32 v182, v108, v109
    v_cvt_pk_bf16_f32 v183, v110, v111
    buffer_store_dwordx4 v[180:183], v224, s[24:27], s42 offen offset:1024 sc1
    v_cvt_pk_bf16_f32 v184, v112, v113
    v_cvt_pk_bf16_f32 v185, v114, v115
    v_cvt_pk_bf16_f32 v186, v116, v117
    v_cvt_pk_bf16_f32 v187, v118, v119
    buffer_store_dwordx4 v[184:187], v224, s[24:27], s42 offen offset:2048 sc1
    v_cvt_pk_bf16_f32 v188, v120, v121
    v_cvt_pk_bf16_f32 v189, v122, v123
    v_cvt_pk_bf16_f32 v190, v124, v125
    v_cvt_pk_bf16_f32 v191, v126, v127
    buffer_store_dwordx4 v[188:191], v224, s[24:27], s42 offen offset:3072 sc1
    s_add_u32 s42, s42, 4096
    buffer_store_dwordx2 v[234:235], v248, s[24:27], s42 offen sc1
    s_mov_b32 s76, 1
    s_mov_b32 s47, 2
    s_mov_b32 s30, s50
    s_mov_b32 s31, 0
    s_lshl_b32 s33, s30, 1
    s_add_u32 s32, s33, 2
    s_lshl_b32 s41, s30, 2
    s_add_u32 s41, s41, s28
    s_lshl_b32 s41, s41, 5
    v_add_u32 v242, s41, v252
    s_sub_u32 s6, s32, 2
    s_max_i32 s6, s6, 0
    s_min_u32 s6, s6, s33
    v_accvgpr_mov_b32 a0, a128
    v_accvgpr_mov_b32 a1, a129
    v_accvgpr_mov_b32 a2, a130
    v_accvgpr_mov_b32 a3, a131
    v_accvgpr_mov_b32 a4, a132
    v_accvgpr_mov_b32 a5, a133
    v_accvgpr_mov_b32 a6, a134
    v_accvgpr_mov_b32 a7, a135
    v_accvgpr_mov_b32 a8, a136
    v_accvgpr_mov_b32 a9, a137
    v_accvgpr_mov_b32 a10, a138
    v_accvgpr_mov_b32 a11, a139
    v_accvgpr_mov_b32 a12, a140
    v_accvgpr_mov_b32 a13, a141
    v_accvgpr_mov_b32 a14, a142
    v_accvgpr_mov_b32 a15, a143
    v_accvgpr_mov_b32 a16, a144
    v_accvgpr_mov_b32 a17, a145
    v_accvgpr_mov_b32 a18, a146
    v_accvgpr_mov_b32 a19, a147
    v_accvgpr_mov_b32 a20, a148
    v_accvgpr_mov_b32 a21, a149
    v_accvgpr_mov_b32 a22, a150
    v_accvgpr_mov_b32 a23, a151
    v_accvgpr_mov_b32 a24, a152
    v_accvgpr_mov_b32 a25, a153
    v_accvgpr_mov_b32 a26, a154
    v_accvgpr_mov_b32 a27, a155
    v_accvgpr_mov_b32 a28, a156
    v_accvgpr_mov_b32 a29, a157
    v_accvgpr_mov_b32 a30, a158
    v_accvgpr_mov_b32 a31, a159
    v_accvgpr_mov_b32 a32, a160
    v_accvgpr_mov_b32 a33, a161
    v_accvgpr_mov_b32 a34, a162
    v_accvgpr_mov_b32 a35, a163
    v_accvgpr_mov_b32 a36, a164
    v_accvgpr_mov_b32 a37, a165
    v_accvgpr_mov_b32 a38, a166
    v_accvgpr_mov_b32 a39, a167
    v_accvgpr_mov_b32 a40, a168
    v_accvgpr_mov_b32 a41, a169
    v_accvgpr_mov_b32 a42, a170
    v_accvgpr_mov_b32 a43, a171
    v_accvgpr_mov_b32 a44, a172
    v_accvgpr_mov_b32 a45, a173
    v_accvgpr_mov_b32 a46, a174
    v_accvgpr_mov_b32 a47, a175
    v_accvgpr_mov_b32 a48, a176
    v_accvgpr_mov_b32 a49, a177
    v_accvgpr_mov_b32 a50, a178
    v_accvgpr_mov_b32 a51, a179
    v_accvgpr_mov_b32 a52, a180
    v_accvgpr_mov_b32 a53, a181
    v_accvgpr_mov_b32 a54, a182
    v_accvgpr_mov_b32 a55, a183
    v_accvgpr_mov_b32 a56, a184
    v_accvgpr_mov_b32 a57, a185
    v_accvgpr_mov_b32 a58, a186
    v_accvgpr_mov_b32 a59, a187
    v_accvgpr_mov_b32 a60, a188
    v_accvgpr_mov_b32 a61, a189
    v_accvgpr_mov_b32 a62, a190
    v_accvgpr_mov_b32 a63, a191
    v_mov_b32 v0, 0
    v_mov_b32 v1, 0
    v_mov_b32 v2, 0
    v_mov_b32 v3, 0
    v_mov_b32 v4, 0
    v_mov_b32 v5, 0
    v_mov_b32 v6, 0
    v_mov_b32 v7, 0
    v_mov_b32 v8, 0
    v_mov_b32 v9, 0
    v_mov_b32 v10, 0
    v_mov_b32 v11, 0
    v_mov_b32 v12, 0
    v_mov_b32 v13, 0
    v_mov_b32 v14, 0
    v_mov_b32 v15, 0
    v_mov_b32 v16, 0
    v_mov_b32 v17, 0
    v_mov_b32 v18, 0
    v_mov_b32 v19, 0
    v_mov_b32 v20, 0
    v_mov_b32 v21, 0
    v_mov_b32 v22, 0
    v_mov_b32 v23, 0
    v_mov_b32 v24, 0
    v_mov_b32 v25, 0
    v_mov_b32 v26, 0
    v_mov_b32 v27, 0
    v_mov_b32 v28, 0
    v_mov_b32 v29, 0
    v_mov_b32 v30, 0
    v_mov_b32 v31, 0
    v_mov_b32 v32, 0
    v_mov_b32 v33, 0
    v_mov_b32 v34, 0
    v_mov_b32 v35, 0
    v_mov_b32 v36, 0
    v_mov_b32 v37, 0
    v_mov_b32 v38, 0
    v_mov_b32 v39, 0
    v_mov_b32 v40, 0
    v_mov_b32 v41, 0
    v_mov_b32 v42, 0
    v_mov_b32 v43, 0
    v_mov_b32 v44, 0
    v_mov_b32 v45, 0
    v_mov_b32 v46, 0
    v_mov_b32 v47, 0
    v_mov_b32 v48, 0
    v_mov_b32 v49, 0
    v_mov_b32 v50, 0
    v_mov_b32 v51, 0
    v_mov_b32 v52, 0
    v_mov_b32 v53, 0
    v_mov_b32 v54, 0
    v_mov_b32 v55, 0
    v_mov_b32 v56, 0
    v_mov_b32 v57, 0
    v_mov_b32 v58, 0
    v_mov_b32 v59, 0
    v_mov_b32 v60, 0
    v_mov_b32 v61, 0
    v_mov_b32 v62, 0
    v_mov_b32 v63, 0
    v_mov_b32 v64, 0
    v_mov_b32 v65, 0
    v_mov_b32 v66, 0
    v_mov_b32 v67, 0
    v_mov_b32 v68, 0
    v_mov_b32 v69, 0
    v_mov_b32 v70, 0
    v_mov_b32 v71, 0
    v_mov_b32 v72, 0
    v_mov_b32 v73, 0
    v_mov_b32 v74, 0
    v_mov_b32 v75, 0
    v_mov_b32 v76, 0
    v_mov_b32 v77, 0
    v_mov_b32 v78, 0
    v_mov_b32 v79, 0
    v_mov_b32 v80, 0
    v_mov_b32 v81, 0
    v_mov_b32 v82, 0
    v_mov_b32 v83, 0
    v_mov_b32 v84, 0
    v_mov_b32 v85, 0
    v_mov_b32 v86, 0
    v_mov_b32 v87, 0
    v_mov_b32 v88, 0
    v_mov_b32 v89, 0
    v_mov_b32 v90, 0
    v_mov_b32 v91, 0
    v_mov_b32 v92, 0
    v_mov_b32 v93, 0
    v_mov_b32 v94, 0
    v_mov_b32 v95, 0
    v_mov_b32 v96, 0
    v_mov_b32 v97, 0
    v_mov_b32 v98, 0
    v_mov_b32 v99, 0
    v_mov_b32 v100, 0
    v_mov_b32 v101, 0
    v_mov_b32 v102, 0
    v_mov_b32 v103, 0
    v_mov_b32 v104, 0
    v_mov_b32 v105, 0
    v_mov_b32 v106, 0
    v_mov_b32 v107, 0
    v_mov_b32 v108, 0
    v_mov_b32 v109, 0
    v_mov_b32 v110, 0
    v_mov_b32 v111, 0
    v_mov_b32 v112, 0
    v_mov_b32 v113, 0
    v_mov_b32 v114, 0
    v_mov_b32 v115, 0
    v_mov_b32 v116, 0
    v_mov_b32 v117, 0
    v_mov_b32 v118, 0
    v_mov_b32 v119, 0
    v_mov_b32 v120, 0
    v_mov_b32 v121, 0
    v_mov_b32 v122, 0
    v_mov_b32 v123, 0
    v_mov_b32 v124, 0
    v_mov_b32 v125, 0
    v_mov_b32 v126, 0
    v_mov_b32 v127, 0
    v_mov_b32 v228, 0
    s_lshl_b32 s41, s31, 6
    v_subrev_u32 v243, s41, v242
    v_subrev_u32 v244, 32, v243
    v_cmp_ge_i32 s[52:53], v243, 0
    v_cmp_ge_i32 s[54:55], v243, 1
    v_cmp_ge_i32 s[56:57], v243, 2
    v_cmp_ge_i32 s[58:59], v243, 3
    v_cndmask_b32 v128, v245, v128, s[52:53]
    v_cmp_ge_i32 s[52:53], v243, 8
    v_cndmask_b32 v129, v245, v129, s[54:55]
    v_cmp_ge_i32 s[54:55], v243, 9
    v_cndmask_b32 v130, v245, v130, s[56:57]
    v_cmp_ge_i32 s[56:57], v243, 10
    v_cndmask_b32 v131, v245, v131, s[58:59]
    v_cmp_ge_i32 s[58:59], v243, 11
    v_cndmask_b32 v132, v245, v132, s[52:53]
    v_cmp_ge_i32 s[52:53], v243, 16
    v_cndmask_b32 v133, v245, v133, s[54:55]
    v_cmp_ge_i32 s[54:55], v243, 17
    v_cndmask_b32 v134, v245, v134, s[56:57]
    v_cmp_ge_i32 s[56:57], v243, 18
    v_cndmask_b32 v135, v245, v135, s[58:59]
    v_cmp_ge_i32 s[58:59], v243, 19
    v_cndmask_b32 v136, v245, v136, s[52:53]
    v_cmp_ge_i32 s[52:53], v243, 24
    v_cndmask_b32 v137, v245, v137, s[54:55]
    v_cmp_ge_i32 s[54:55], v243, 25
    v_cndmask_b32 v138, v245, v138, s[56:57]
    v_cmp_ge_i32 s[56:57], v243, 26
    v_cndmask_b32 v139, v245, v139, s[58:59]
    v_cmp_ge_i32 s[58:59], v243, 27
    v_cndmask_b32 v140, v245, v140, s[52:53]
    v_cmp_ge_i32 s[52:53], v244, 0
    v_cndmask_b32 v141, v245, v141, s[54:55]
    v_cmp_ge_i32 s[54:55], v244, 1
    v_cndmask_b32 v142, v245, v142, s[56:57]
    v_cmp_ge_i32 s[56:57], v244, 2
    v_cndmask_b32 v143, v245, v143, s[58:59]
    v_cmp_ge_i32 s[58:59], v244, 3
    v_cndmask_b32 v144, v245, v144, s[52:53]
    v_cmp_ge_i32 s[52:53], v244, 8
    v_cndmask_b32 v145, v245, v145, s[54:55]
    v_cmp_ge_i32 s[54:55], v244, 9
    v_cndmask_b32 v146, v245, v146, s[56:57]
    v_cmp_ge_i32 s[56:57], v244, 10
    v_cndmask_b32 v147, v245, v147, s[58:59]
    v_cmp_ge_i32 s[58:59], v244, 11
    v_cndmask_b32 v148, v245, v148, s[52:53]
    v_cmp_ge_i32 s[52:53], v244, 16
    v_cndmask_b32 v149, v245, v149, s[54:55]
    v_cmp_ge_i32 s[54:55], v244, 17
    v_cndmask_b32 v150, v245, v150, s[56:57]
    v_cmp_ge_i32 s[56:57], v244, 18
    v_cndmask_b32 v151, v245, v151, s[58:59]
    v_cmp_ge_i32 s[58:59], v244, 19
    v_cndmask_b32 v152, v245, v152, s[52:53]
    v_cmp_ge_i32 s[52:53], v244, 24
    v_cndmask_b32 v153, v245, v153, s[54:55]
    v_cmp_ge_i32 s[54:55], v244, 25
    v_cndmask_b32 v154, v245, v154, s[56:57]
    v_cmp_ge_i32 s[56:57], v244, 26
    v_cndmask_b32 v155, v245, v155, s[58:59]
    v_cmp_ge_i32 s[58:59], v244, 27
    v_cndmask_b32 v156, v245, v156, s[52:53]
    s_nop 1
    v_cndmask_b32 v157, v245, v157, s[54:55]
    v_cndmask_b32 v158, v245, v158, s[56:57]
    v_cndmask_b32 v159, v245, v159, s[58:59]
    v_max3_f32 v246, v128, v129, v130
    v_max3_f32 v247, v131, v132, v133
    v_max3_f32 v246, v246, v134, v135
    v_max3_f32 v247, v247, v136, v137
    v_max3_f32 v246, v246, v138, v139
    v_max3_f32 v247, v247, v140, v141
    v_max3_f32 v246, v246, v142, v143
    v_max3_f32 v247, v247, v144, v145
    v_max3_f32 v246, v246, v146, v147
    v_max3_f32 v247, v247, v148, v149
    v_max3_f32 v246, v246, v150, v151
    v_max3_f32 v247, v247, v152, v153
    v_max3_f32 v246, v246, v154, v155
    v_max3_f32 v247, v247, v156, v157
    v_max3_f32 v246, v246, v158, v159
    v_max_f32 v246, v246, v247
    v_mov_b32 v247, v246
    s_nop 1
    v_permlane32_swap_b32 v246, v247
    s_nop 1
    v_max_f32 v246, v246, v247
    v_mov_b32 v247, 0xf149f2ca
    v_cmp_gt_f32 vcc, v246, v247
    s_nop 1
    v_cndmask_b32 v250, 0, v246, vcc
    v_sub_f32 v128, v128, v250
    v_sub_f32 v129, v129, v250
    v_sub_f32 v130, v130, v250
    v_sub_f32 v131, v131, v250
    v_sub_f32 v132, v132, v250
    v_sub_f32 v133, v133, v250
    v_sub_f32 v134, v134, v250
    v_sub_f32 v135, v135, v250
    v_sub_f32 v136, v136, v250
    v_sub_f32 v137, v137, v250
    v_sub_f32 v138, v138, v250
    v_sub_f32 v139, v139, v250
    v_sub_f32 v140, v140, v250
    v_sub_f32 v141, v141, v250
    v_sub_f32 v142, v142, v250
    v_sub_f32 v143, v143, v250
    v_sub_f32 v144, v144, v250
    v_sub_f32 v145, v145, v250
    v_sub_f32 v146, v146, v250
    v_sub_f32 v147, v147, v250
    v_sub_f32 v148, v148, v250
    v_sub_f32 v149, v149, v250
    v_sub_f32 v150, v150, v250
    v_sub_f32 v151, v151, v250
    v_sub_f32 v152, v152, v250
    v_sub_f32 v153, v153, v250
    v_sub_f32 v154, v154, v250
    v_sub_f32 v155, v155, v250
    v_sub_f32 v156, v156, v250
    v_sub_f32 v157, v157, v250
    v_sub_f32 v158, v158, v250
    v_sub_f32 v159, v159, v250
    v_sub_f32 v192, 0, v250
    v_sub_f32 v193, 0, v250
    v_sub_f32 v194, 0, v250
    v_sub_f32 v195, 0, v250
    v_sub_f32 v196, 0, v250
    v_sub_f32 v197, 0, v250
    v_sub_f32 v198, 0, v250
    v_sub_f32 v199, 0, v250
    v_sub_f32 v200, 0, v250
    v_sub_f32 v201, 0, v250
    v_sub_f32 v202, 0, v250
    v_sub_f32 v203, 0, v250
    v_sub_f32 v204, 0, v250
    v_sub_f32 v205, 0, v250
    v_sub_f32 v206, 0, v250
    v_sub_f32 v207, 0, v250
    s_waitcnt vmcnt(0)
    s_mov_b32 s76, 0
    s_mov_b64 exec, 1
    v_mov_b32 v246, s78
    v_mov_b32 v247, s79
    global_atomic_or v246, v247, s[60:61] sc1
    s_mov_b64 exec, -1
    s_branch attn_kernel_dispatch0
attn_kernel_chain1:
    s_nop 7
    s_nop 7
    v_mov_b32 v246, v228
    v_mov_b32 v247, v228
    s_nop 1
    v_permlane32_swap_b32 v246, v247
    s_nop 1
    v_add_f32 v228, v246, v247
    v_mov_b32 v247, 0xf149f2ca
    v_cmp_lt_f32 vcc, 0, v228
    v_mov_b32 v235, v228
    v_lshrrev_b32 v248, 1, v224
    v_cndmask_b32 v234, v247, v250, vcc
    s_mov_b32 s42, 0
    v_cvt_pk_bf16_f32 v128, v0, v1
    v_cvt_pk_bf16_f32 v129, v2, v3
    v_cvt_pk_bf16_f32 v130, v4, v5
    v_cvt_pk_bf16_f32 v131, v6, v7
    buffer_store_dwordx4 v[128:131], v224, s[24:27], s42 offen offset:0 sc1
    v_cvt_pk_bf16_f32 v132, v8, v9
    v_cvt_pk_bf16_f32 v133, v10, v11
    v_cvt_pk_bf16_f32 v134, v12, v13
    v_cvt_pk_bf16_f32 v135, v14, v15
    buffer_store_dwordx4 v[132:135], v224, s[24:27], s42 offen offset:1024 sc1
    v_cvt_pk_bf16_f32 v136, v16, v17
    v_cvt_pk_bf16_f32 v137, v18, v19
    v_cvt_pk_bf16_f32 v138, v20, v21
    v_cvt_pk_bf16_f32 v139, v22, v23
    buffer_store_dwordx4 v[136:139], v224, s[24:27], s42 offen offset:2048 sc1
    v_cvt_pk_bf16_f32 v140, v24, v25
    v_cvt_pk_bf16_f32 v141, v26, v27
    v_cvt_pk_bf16_f32 v142, v28, v29
    v_cvt_pk_bf16_f32 v143, v30, v31
    buffer_store_dwordx4 v[140:143], v224, s[24:27], s42 offen offset:3072 sc1
    s_add_u32 s42, s42, 4096
    v_cvt_pk_bf16_f32 v144, v32, v33
    v_cvt_pk_bf16_f32 v145, v34, v35
    v_cvt_pk_bf16_f32 v146, v36, v37
    v_cvt_pk_bf16_f32 v147, v38, v39
    buffer_store_dwordx4 v[144:147], v224, s[24:27], s42 offen offset:0 sc1
    v_cvt_pk_bf16_f32 v148, v40, v41
    v_cvt_pk_bf16_f32 v149, v42, v43
    v_cvt_pk_bf16_f32 v150, v44, v45
    v_cvt_pk_bf16_f32 v151, v46, v47
    buffer_store_dwordx4 v[148:151], v224, s[24:27], s42 offen offset:1024 sc1
    v_cvt_pk_bf16_f32 v152, v48, v49
    v_cvt_pk_bf16_f32 v153, v50, v51
    v_cvt_pk_bf16_f32 v154, v52, v53
    v_cvt_pk_bf16_f32 v155, v54, v55
    buffer_store_dwordx4 v[152:155], v224, s[24:27], s42 offen offset:2048 sc1
    v_cvt_pk_bf16_f32 v156, v56, v57
    v_cvt_pk_bf16_f32 v157, v58, v59
    v_cvt_pk_bf16_f32 v158, v60, v61
    v_cvt_pk_bf16_f32 v159, v62, v63
    buffer_store_dwordx4 v[156:159], v224, s[24:27], s42 offen offset:3072 sc1
    s_add_u32 s42, s42, 4096
    v_cvt_pk_bf16_f32 v128, v64, v65
    v_cvt_pk_bf16_f32 v129, v66, v67
    v_cvt_pk_bf16_f32 v130, v68, v69
    v_cvt_pk_bf16_f32 v131, v70, v71
    buffer_store_dwordx4 v[128:131], v224, s[24:27], s42 offen offset:0 sc1
    v_cvt_pk_bf16_f32 v132, v72, v73
    v_cvt_pk_bf16_f32 v133, v74, v75
    v_cvt_pk_bf16_f32 v134, v76, v77
    v_cvt_pk_bf16_f32 v135, v78, v79
    buffer_store_dwordx4 v[132:135], v224, s[24:27], s42 offen offset:1024 sc1
    v_cvt_pk_bf16_f32 v136, v80, v81
    v_cvt_pk_bf16_f32 v137, v82, v83
    v_cvt_pk_bf16_f32 v138, v84, v85
    v_cvt_pk_bf16_f32 v139, v86, v87
    buffer_store_dwordx4 v[136:139], v224, s[24:27], s42 offen offset:2048 sc1
    v_cvt_pk_bf16_f32 v140, v88, v89
    v_cvt_pk_bf16_f32 v141, v90, v91
    v_cvt_pk_bf16_f32 v142, v92, v93
    v_cvt_pk_bf16_f32 v143, v94, v95
    buffer_store_dwordx4 v[140:143], v224, s[24:27], s42 offen offset:3072 sc1
    s_add_u32 s42, s42, 4096
    v_cvt_pk_bf16_f32 v144, v96, v97
    v_cvt_pk_bf16_f32 v145, v98, v99
    v_cvt_pk_bf16_f32 v146, v100, v101
    v_cvt_pk_bf16_f32 v147, v102, v103
    buffer_store_dwordx4 v[144:147], v224, s[24:27], s42 offen offset:0 sc1
    v_cvt_pk_bf16_f32 v148, v104, v105
    v_cvt_pk_bf16_f32 v149, v106, v107
    v_cvt_pk_bf16_f32 v150, v108, v109
    v_cvt_pk_bf16_f32 v151, v110, v111
    buffer_store_dwordx4 v[148:151], v224, s[24:27], s42 offen offset:1024 sc1
    v_cvt_pk_bf16_f32 v152, v112, v113
    v_cvt_pk_bf16_f32 v153, v114, v115
    v_cvt_pk_bf16_f32 v154, v116, v117
    v_cvt_pk_bf16_f32 v155, v118, v119
    buffer_store_dwordx4 v[152:155], v224, s[24:27], s42 offen offset:2048 sc1
    v_cvt_pk_bf16_f32 v156, v120, v121
    v_cvt_pk_bf16_f32 v157, v122, v123
    v_cvt_pk_bf16_f32 v158, v124, v125
    v_cvt_pk_bf16_f32 v159, v126, v127
    buffer_store_dwordx4 v[156:159], v224, s[24:27], s42 offen offset:3072 sc1
    s_add_u32 s42, s42, 4096
    buffer_store_dwordx2 v[234:235], v248, s[24:27], s42 offen sc1
    s_mov_b32 s76, 1
    s_mov_b32 s47, 2
    s_mov_b32 s30, s50
    s_mov_b32 s31, 0
    s_lshl_b32 s33, s30, 1
    s_add_u32 s32, s33, 2
    s_lshl_b32 s41, s30, 2
    s_add_u32 s41, s41, s28
    s_lshl_b32 s41, s41, 5
    v_add_u32 v242, s41, v252
    s_sub_u32 s6, s32, 2
    s_max_i32 s6, s6, 0
    s_min_u32 s6, s6, s33
    v_accvgpr_mov_b32 a0, a128
    v_accvgpr_mov_b32 a1, a129
    v_accvgpr_mov_b32 a2, a130
    v_accvgpr_mov_b32 a3, a131
    v_accvgpr_mov_b32 a4, a132
    v_accvgpr_mov_b32 a5, a133
    v_accvgpr_mov_b32 a6, a134
    v_accvgpr_mov_b32 a7, a135
    v_accvgpr_mov_b32 a8, a136
    v_accvgpr_mov_b32 a9, a137
    v_accvgpr_mov_b32 a10, a138
    v_accvgpr_mov_b32 a11, a139
    v_accvgpr_mov_b32 a12, a140
    v_accvgpr_mov_b32 a13, a141
    v_accvgpr_mov_b32 a14, a142
    v_accvgpr_mov_b32 a15, a143
    v_accvgpr_mov_b32 a16, a144
    v_accvgpr_mov_b32 a17, a145
    v_accvgpr_mov_b32 a18, a146
    v_accvgpr_mov_b32 a19, a147
    v_accvgpr_mov_b32 a20, a148
    v_accvgpr_mov_b32 a21, a149
    v_accvgpr_mov_b32 a22, a150
    v_accvgpr_mov_b32 a23, a151
    v_accvgpr_mov_b32 a24, a152
    v_accvgpr_mov_b32 a25, a153
    v_accvgpr_mov_b32 a26, a154
    v_accvgpr_mov_b32 a27, a155
    v_accvgpr_mov_b32 a28, a156
    v_accvgpr_mov_b32 a29, a157
    v_accvgpr_mov_b32 a30, a158
    v_accvgpr_mov_b32 a31, a159
    v_accvgpr_mov_b32 a32, a160
    v_accvgpr_mov_b32 a33, a161
    v_accvgpr_mov_b32 a34, a162
    v_accvgpr_mov_b32 a35, a163
    v_accvgpr_mov_b32 a36, a164
    v_accvgpr_mov_b32 a37, a165
    v_accvgpr_mov_b32 a38, a166
    v_accvgpr_mov_b32 a39, a167
    v_accvgpr_mov_b32 a40, a168
    v_accvgpr_mov_b32 a41, a169
    v_accvgpr_mov_b32 a42, a170
    v_accvgpr_mov_b32 a43, a171
    v_accvgpr_mov_b32 a44, a172
    v_accvgpr_mov_b32 a45, a173
    v_accvgpr_mov_b32 a46, a174
    v_accvgpr_mov_b32 a47, a175
    v_accvgpr_mov_b32 a48, a176
    v_accvgpr_mov_b32 a49, a177
    v_accvgpr_mov_b32 a50, a178
    v_accvgpr_mov_b32 a51, a179
    v_accvgpr_mov_b32 a52, a180
    v_accvgpr_mov_b32 a53, a181
    v_accvgpr_mov_b32 a54, a182
    v_accvgpr_mov_b32 a55, a183
    v_accvgpr_mov_b32 a56, a184
    v_accvgpr_mov_b32 a57, a185
    v_accvgpr_mov_b32 a58, a186
    v_accvgpr_mov_b32 a59, a187
    v_accvgpr_mov_b32 a60, a188
    v_accvgpr_mov_b32 a61, a189
    v_accvgpr_mov_b32 a62, a190
    v_accvgpr_mov_b32 a63, a191
    v_mov_b32 v0, 0
    v_mov_b32 v1, 0
    v_mov_b32 v2, 0
    v_mov_b32 v3, 0
    v_mov_b32 v4, 0
    v_mov_b32 v5, 0
    v_mov_b32 v6, 0
    v_mov_b32 v7, 0
    v_mov_b32 v8, 0
    v_mov_b32 v9, 0
    v_mov_b32 v10, 0
    v_mov_b32 v11, 0
    v_mov_b32 v12, 0
    v_mov_b32 v13, 0
    v_mov_b32 v14, 0
    v_mov_b32 v15, 0
    v_mov_b32 v16, 0
    v_mov_b32 v17, 0
    v_mov_b32 v18, 0
    v_mov_b32 v19, 0
    v_mov_b32 v20, 0
    v_mov_b32 v21, 0
    v_mov_b32 v22, 0
    v_mov_b32 v23, 0
    v_mov_b32 v24, 0
    v_mov_b32 v25, 0
    v_mov_b32 v26, 0
    v_mov_b32 v27, 0
    v_mov_b32 v28, 0
    v_mov_b32 v29, 0
    v_mov_b32 v30, 0
    v_mov_b32 v31, 0
    v_mov_b32 v32, 0
    v_mov_b32 v33, 0
    v_mov_b32 v34, 0
    v_mov_b32 v35, 0
    v_mov_b32 v36, 0
    v_mov_b32 v37, 0
    v_mov_b32 v38, 0
    v_mov_b32 v39, 0
    v_mov_b32 v40, 0
    v_mov_b32 v41, 0
    v_mov_b32 v42, 0
    v_mov_b32 v43, 0
    v_mov_b32 v44, 0
    v_mov_b32 v45, 0
    v_mov_b32 v46, 0
    v_mov_b32 v47, 0
    v_mov_b32 v48, 0
    v_mov_b32 v49, 0
    v_mov_b32 v50, 0
    v_mov_b32 v51, 0
    v_mov_b32 v52, 0
    v_mov_b32 v53, 0
    v_mov_b32 v54, 0
    v_mov_b32 v55, 0
    v_mov_b32 v56, 0
    v_mov_b32 v57, 0
    v_mov_b32 v58, 0
    v_mov_b32 v59, 0
    v_mov_b32 v60, 0
    v_mov_b32 v61, 0
    v_mov_b32 v62, 0
    v_mov_b32 v63, 0
    v_mov_b32 v64, 0
    v_mov_b32 v65, 0
    v_mov_b32 v66, 0
    v_mov_b32 v67, 0
    v_mov_b32 v68, 0
    v_mov_b32 v69, 0
    v_mov_b32 v70, 0
    v_mov_b32 v71, 0
    v_mov_b32 v72, 0
    v_mov_b32 v73, 0
    v_mov_b32 v74, 0
    v_mov_b32 v75, 0
    v_mov_b32 v76, 0
    v_mov_b32 v77, 0
    v_mov_b32 v78, 0
    v_mov_b32 v79, 0
    v_mov_b32 v80, 0
    v_mov_b32 v81, 0
    v_mov_b32 v82, 0
    v_mov_b32 v83, 0
    v_mov_b32 v84, 0
    v_mov_b32 v85, 0
    v_mov_b32 v86, 0
    v_mov_b32 v87, 0
    v_mov_b32 v88, 0
    v_mov_b32 v89, 0
    v_mov_b32 v90, 0
    v_mov_b32 v91, 0
    v_mov_b32 v92, 0
    v_mov_b32 v93, 0
    v_mov_b32 v94, 0
    v_mov_b32 v95, 0
    v_mov_b32 v96, 0
    v_mov_b32 v97, 0
    v_mov_b32 v98, 0
    v_mov_b32 v99, 0
    v_mov_b32 v100, 0
    v_mov_b32 v101, 0
    v_mov_b32 v102, 0
    v_mov_b32 v103, 0
    v_mov_b32 v104, 0
    v_mov_b32 v105, 0
    v_mov_b32 v106, 0
    v_mov_b32 v107, 0
    v_mov_b32 v108, 0
    v_mov_b32 v109, 0
    v_mov_b32 v110, 0
    v_mov_b32 v111, 0
    v_mov_b32 v112, 0
    v_mov_b32 v113, 0
    v_mov_b32 v114, 0
    v_mov_b32 v115, 0
    v_mov_b32 v116, 0
    v_mov_b32 v117, 0
    v_mov_b32 v118, 0
    v_mov_b32 v119, 0
    v_mov_b32 v120, 0
    v_mov_b32 v121, 0
    v_mov_b32 v122, 0
    v_mov_b32 v123, 0
    v_mov_b32 v124, 0
    v_mov_b32 v125, 0
    v_mov_b32 v126, 0
    v_mov_b32 v127, 0
    v_mov_b32 v228, 0
    s_lshl_b32 s41, s31, 6
    v_subrev_u32 v243, s41, v242
    v_subrev_u32 v244, 32, v243
    v_cmp_ge_i32 s[52:53], v243, 0
    v_cmp_ge_i32 s[54:55], v243, 1
    v_cmp_ge_i32 s[56:57], v243, 2
    v_cmp_ge_i32 s[58:59], v243, 3
    v_cndmask_b32 v160, v245, v160, s[52:53]
    v_cmp_ge_i32 s[52:53], v243, 8
    v_cndmask_b32 v161, v245, v161, s[54:55]
    v_cmp_ge_i32 s[54:55], v243, 9
    v_cndmask_b32 v162, v245, v162, s[56:57]
    v_cmp_ge_i32 s[56:57], v243, 10
    v_cndmask_b32 v163, v245, v163, s[58:59]
    v_cmp_ge_i32 s[58:59], v243, 11
    v_cndmask_b32 v164, v245, v164, s[52:53]
    v_cmp_ge_i32 s[52:53], v243, 16
    v_cndmask_b32 v165, v245, v165, s[54:55]
    v_cmp_ge_i32 s[54:55], v243, 17
    v_cndmask_b32 v166, v245, v166, s[56:57]
    v_cmp_ge_i32 s[56:57], v243, 18
    v_cndmask_b32 v167, v245, v167, s[58:59]
    v_cmp_ge_i32 s[58:59], v243, 19
    v_cndmask_b32 v168, v245, v168, s[52:53]
    v_cmp_ge_i32 s[52:53], v243, 24
    v_cndmask_b32 v169, v245, v169, s[54:55]
    v_cmp_ge_i32 s[54:55], v243, 25
    v_cndmask_b32 v170, v245, v170, s[56:57]
    v_cmp_ge_i32 s[56:57], v243, 26
    v_cndmask_b32 v171, v245, v171, s[58:59]
    v_cmp_ge_i32 s[58:59], v243, 27
    v_cndmask_b32 v172, v245, v172, s[52:53]
    v_cmp_ge_i32 s[52:53], v244, 0
    v_cndmask_b32 v173, v245, v173, s[54:55]
    v_cmp_ge_i32 s[54:55], v244, 1
    v_cndmask_b32 v174, v245, v174, s[56:57]
    v_cmp_ge_i32 s[56:57], v244, 2
    v_cndmask_b32 v175, v245, v175, s[58:59]
    v_cmp_ge_i32 s[58:59], v244, 3
    v_cndmask_b32 v176, v245, v176, s[52:53]
    v_cmp_ge_i32 s[52:53], v244, 8
    v_cndmask_b32 v177, v245, v177, s[54:55]
    v_cmp_ge_i32 s[54:55], v244, 9
    v_cndmask_b32 v178, v245, v178, s[56:57]
    v_cmp_ge_i32 s[56:57], v244, 10
    v_cndmask_b32 v179, v245, v179, s[58:59]
    v_cmp_ge_i32 s[58:59], v244, 11
    v_cndmask_b32 v180, v245, v180, s[52:53]
    v_cmp_ge_i32 s[52:53], v244, 16
    v_cndmask_b32 v181, v245, v181, s[54:55]
    v_cmp_ge_i32 s[54:55], v244, 17
    v_cndmask_b32 v182, v245, v182, s[56:57]
    v_cmp_ge_i32 s[56:57], v244, 18
    v_cndmask_b32 v183, v245, v183, s[58:59]
    v_cmp_ge_i32 s[58:59], v244, 19
    v_cndmask_b32 v184, v245, v184, s[52:53]
    v_cmp_ge_i32 s[52:53], v244, 24
    v_cndmask_b32 v185, v245, v185, s[54:55]
    v_cmp_ge_i32 s[54:55], v244, 25
    v_cndmask_b32 v186, v245, v186, s[56:57]
    v_cmp_ge_i32 s[56:57], v244, 26
    v_cndmask_b32 v187, v245, v187, s[58:59]
    v_cmp_ge_i32 s[58:59], v244, 27
    v_cndmask_b32 v188, v245, v188, s[52:53]
    s_nop 1
    v_cndmask_b32 v189, v245, v189, s[54:55]
    v_cndmask_b32 v190, v245, v190, s[56:57]
    v_cndmask_b32 v191, v245, v191, s[58:59]
    v_max3_f32 v246, v160, v161, v162
    v_max3_f32 v247, v163, v164, v165
    v_max3_f32 v246, v246, v166, v167
    v_max3_f32 v247, v247, v168, v169
    v_max3_f32 v246, v246, v170, v171
    v_max3_f32 v247, v247, v172, v173
    v_max3_f32 v246, v246, v174, v175
    v_max3_f32 v247, v247, v176, v177
    v_max3_f32 v246, v246, v178, v179
    v_max3_f32 v247, v247, v180, v181
    v_max3_f32 v246, v246, v182, v183
    v_max3_f32 v247, v247, v184, v185
    v_max3_f32 v246, v246, v186, v187
    v_max3_f32 v247, v247, v188, v189
    v_max3_f32 v246, v246, v190, v191
    v_max_f32 v246, v246, v247
    v_mov_b32 v247, v246
    s_nop 1
    v_permlane32_swap_b32 v246, v247
    s_nop 1
    v_max_f32 v246, v246, v247
    v_mov_b32 v247, 0xf149f2ca
    v_cmp_gt_f32 vcc, v246, v247
    s_nop 1
    v_cndmask_b32 v250, 0, v246, vcc
    v_sub_f32 v160, v160, v250
    v_sub_f32 v161, v161, v250
    v_sub_f32 v162, v162, v250
    v_sub_f32 v163, v163, v250
    v_sub_f32 v164, v164, v250
    v_sub_f32 v165, v165, v250
    v_sub_f32 v166, v166, v250
    v_sub_f32 v167, v167, v250
    v_sub_f32 v168, v168, v250
    v_sub_f32 v169, v169, v250
    v_sub_f32 v170, v170, v250
    v_sub_f32 v171, v171, v250
    v_sub_f32 v172, v172, v250
    v_sub_f32 v173, v173, v250
    v_sub_f32 v174, v174, v250
    v_sub_f32 v175, v175, v250
    v_sub_f32 v176, v176, v250
    v_sub_f32 v177, v177, v250
    v_sub_f32 v178, v178, v250
    v_sub_f32 v179, v179, v250
    v_sub_f32 v180, v180, v250
    v_sub_f32 v181, v181, v250
    v_sub_f32 v182, v182, v250
    v_sub_f32 v183, v183, v250
    v_sub_f32 v184, v184, v250
    v_sub_f32 v185, v185, v250
    v_sub_f32 v186, v186, v250
    v_sub_f32 v187, v187, v250
    v_sub_f32 v188, v188, v250
    v_sub_f32 v189, v189, v250
    v_sub_f32 v190, v190, v250
    v_sub_f32 v191, v191, v250
    v_sub_f32 v192, 0, v250
    v_sub_f32 v193, 0, v250
    v_sub_f32 v194, 0, v250
    v_sub_f32 v195, 0, v250
    v_sub_f32 v196, 0, v250
    v_sub_f32 v197, 0, v250
    v_sub_f32 v198, 0, v250
    v_sub_f32 v199, 0, v250
    v_sub_f32 v200, 0, v250
    v_sub_f32 v201, 0, v250
    v_sub_f32 v202, 0, v250
    v_sub_f32 v203, 0, v250
    v_sub_f32 v204, 0, v250
    v_sub_f32 v205, 0, v250
    v_sub_f32 v206, 0, v250
    v_sub_f32 v207, 0, v250
    s_waitcnt vmcnt(0)
    s_mov_b32 s76, 0
    s_mov_b64 exec, 1
    v_mov_b32 v246, s78
    v_mov_b32 v247, s79
    global_atomic_or v246, v247, s[60:61] sc1
    s_mov_b64 exec, -1
    s_branch attn_kernel_dispatch1
attn_kernel_slow0:
    s_nop 7
    s_nop 7
    v_max3_f32 v246, v128, v129, v130
    v_max3_f32 v247, v131, v132, v133
    v_max3_f32 v246, v246, v134, v135
    v_max3_f32 v247, v247, v136, v137
    v_max3_f32 v246, v246, v138, v139
    v_max3_f32 v247, v247, v140, v141
    v_max3_f32 v246, v246, v142, v143
    v_max3_f32 v247, v247, v144, v145
    v_max3_f32 v246, v246, v146, v147
    v_max3_f32 v247, v247, v148, v149
    v_max3_f32 v246, v246, v150, v151
    v_max3_f32 v247, v247, v152, v153
    v_max3_f32 v246, v246, v154, v155
    v_max3_f32 v247, v247, v156, v157
    v_max3_f32 v246, v246, v158, v159
    v_max_f32 v246, v246, v247
    v_mov_b32 v247, v246
    s_nop 1
    v_permlane32_swap_b32 v246, v247
    s_nop 1
    v_max_f32 v246, v246, v247
    v_max_f32 v246, 0, v246
    v_sub_f32 v247, 0, v246
    v_exp_f32 v247, v247
    v_add_f32 v250, v250, v246
    v_sub_f32 v128, v128, v246
    v_sub_f32 v129, v129, v246
    v_sub_f32 v130, v130, v246
    v_sub_f32 v131, v131, v246
    v_sub_f32 v132, v132, v246
    v_sub_f32 v133, v133, v246
    v_sub_f32 v134, v134, v246
    v_sub_f32 v135, v135, v246
    v_sub_f32 v136, v136, v246
    v_sub_f32 v137, v137, v246
    v_sub_f32 v138, v138, v246
    v_sub_f32 v139, v139, v246
    v_sub_f32 v140, v140, v246
    v_sub_f32 v141, v141, v246
    v_sub_f32 v142, v142, v246
    v_sub_f32 v143, v143, v246
    v_sub_f32 v144, v144, v246
    v_sub_f32 v145, v145, v246
    v_sub_f32 v146, v146, v246
    v_sub_f32 v147, v147, v246
    v_sub_f32 v148, v148, v246
    v_sub_f32 v149, v149, v246
    v_sub_f32 v150, v150, v246
    v_sub_f32 v151, v151, v246
    v_sub_f32 v152, v152, v246
    v_sub_f32 v153, v153, v246
    v_sub_f32 v154, v154, v246
    v_sub_f32 v155, v155, v246
    v_sub_f32 v156, v156, v246
    v_sub_f32 v157, v157, v246
    v_sub_f32 v158, v158, v246
    v_sub_f32 v159, v159, v246
    s_cmp_eq_u32 s49, 6
    s_cbranch_scc1 attn_kernel_slow0_nq
    v_sub_f32 v160, v160, v246
    v_sub_f32 v161, v161, v246
    v_sub_f32 v162, v162, v246
    v_sub_f32 v163, v163, v246
    v_sub_f32 v164, v164, v246
    v_sub_f32 v165, v165, v246
    v_sub_f32 v166, v166, v246
    v_sub_f32 v167, v167, v246
    v_sub_f32 v168, v168, v246
    v_sub_f32 v169, v169, v246
    v_sub_f32 v170, v170, v246
    v_sub_f32 v171, v171, v246
    v_sub_f32 v172, v172, v246
    v_sub_f32 v173, v173, v246
    v_sub_f32 v174, v174, v246
    v_sub_f32 v175, v175, v246
    v_sub_f32 v176, v176, v246
    v_sub_f32 v177, v177, v246
    v_sub_f32 v178, v178, v246
    v_sub_f32 v179, v179, v246
    v_sub_f32 v180, v180, v246
    v_sub_f32 v181, v181, v246
    v_sub_f32 v182, v182, v246
    v_sub_f32 v183, v183, v246
    v_sub_f32 v184, v184, v246
    v_sub_f32 v185, v185, v246
    v_sub_f32 v186, v186, v246
    v_sub_f32 v187, v187, v246
    v_sub_f32 v188, v188, v246
    v_sub_f32 v189, v189, v246
    v_sub_f32 v190, v190, v246
    v_sub_f32 v191, v191, v246
attn_kernel_slow0_nq:
    v_sub_f32 v192, 0, v250
    v_sub_f32 v193, 0, v250
    v_sub_f32 v194, 0, v250
    v_sub_f32 v195, 0, v250
    v_sub_f32 v196, 0, v250
    v_sub_f32 v197, 0, v250
    v_sub_f32 v198, 0, v250
    v_sub_f32 v199, 0, v250
    v_sub_f32 v200, 0, v250
    v_sub_f32 v201, 0, v250
    v_sub_f32 v202, 0, v250
    v_sub_f32 v203, 0, v250
    v_sub_f32 v204, 0, v250
    v_sub_f32 v205, 0, v250
    v_sub_f32 v206, 0, v250
    v_sub_f32 v207, 0, v250
    v_mul_f32 v228, v228, v247
    v_mul_f32 v0, v0, v247
    v_mul_f32 v1, v1, v247
    v_mul_f32 v2, v2, v247
    v_mul_f32 v3, v3, v247
    v_mul_f32 v4, v4, v247
    v_mul_f32 v5, v5, v247
    v_mul_f32 v6, v6, v247
    v_mul_f32 v7, v7, v247
    v_mul_f32 v8, v8, v247
    v_mul_f32 v9, v9, v247
    v_mul_f32 v10, v10, v247
    v_mul_f32 v11, v11, v247
    v_mul_f32 v12, v12, v247
    v_mul_f32 v13, v13, v247
    v_mul_f32 v14, v14, v247
    v_mul_f32 v15, v15, v247
    v_mul_f32 v16, v16, v247
    v_mul_f32 v17, v17, v247
    v_mul_f32 v18, v18, v247
    v_mul_f32 v19, v19, v247
    v_mul_f32 v20, v20, v247
    v_mul_f32 v21, v21, v247
    v_mul_f32 v22, v22, v247
    v_mul_f32 v23, v23, v247
    v_mul_f32 v24, v24, v247
    v_mul_f32 v25, v25, v247
    v_mul_f32 v26, v26, v247
    v_mul_f32 v27, v27, v247
    v_mul_f32 v28, v28, v247
    v_mul_f32 v29, v29, v247
    v_mul_f32 v30, v30, v247
    v_mul_f32 v31, v31, v247
    v_mul_f32 v32, v32, v247
    v_mul_f32 v33, v33, v247
    v_mul_f32 v34, v34, v247
    v_mul_f32 v35, v35, v247
    v_mul_f32 v36, v36, v247
    v_mul_f32 v37, v37, v247
    v_mul_f32 v38, v38, v247
    v_mul_f32 v39, v39, v247
    v_mul_f32 v40, v40, v247
    v_mul_f32 v41, v41, v247
    v_mul_f32 v42, v42, v247
    v_mul_f32 v43, v43, v247
    v_mul_f32 v44, v44, v247
    v_mul_f32 v45, v45, v247
    v_mul_f32 v46, v46, v247
    v_mul_f32 v47, v47, v247
    v_mul_f32 v48, v48, v247
    v_mul_f32 v49, v49, v247
    v_mul_f32 v50, v50, v247
    v_mul_f32 v51, v51, v247
    v_mul_f32 v52, v52, v247
    v_mul_f32 v53, v53, v247
    v_mul_f32 v54, v54, v247
    v_mul_f32 v55, v55, v247
    v_mul_f32 v56, v56, v247
    v_mul_f32 v57, v57, v247
    v_mul_f32 v58, v58, v247
    v_mul_f32 v59, v59, v247
    v_mul_f32 v60, v60, v247
    v_mul_f32 v61, v61, v247
    v_mul_f32 v62, v62, v247
    v_mul_f32 v63, v63, v247
    v_mul_f32 v64, v64, v247
    v_mul_f32 v65, v65, v247
    v_mul_f32 v66, v66, v247
    v_mul_f32 v67, v67, v247
    v_mul_f32 v68, v68, v247
    v_mul_f32 v69, v69, v247
    v_mul_f32 v70, v70, v247
    v_mul_f32 v71, v71, v247
    v_mul_f32 v72, v72, v247
    v_mul_f32 v73, v73, v247
    v_mul_f32 v74, v74, v247
    v_mul_f32 v75, v75, v247
    v_mul_f32 v76, v76, v247
    v_mul_f32 v77, v77, v247
    v_mul_f32 v78, v78, v247
    v_mul_f32 v79, v79, v247
    v_mul_f32 v80, v80, v247
    v_mul_f32 v81, v81, v247
    v_mul_f32 v82, v82, v247
    v_mul_f32 v83, v83, v247
    v_mul_f32 v84, v84, v247
    v_mul_f32 v85, v85, v247
    v_mul_f32 v86, v86, v247
    v_mul_f32 v87, v87, v247
    v_mul_f32 v88, v88, v247
    v_mul_f32 v89, v89, v247
    v_mul_f32 v90, v90, v247
    v_mul_f32 v91, v91, v247
    v_mul_f32 v92, v92, v247
    v_mul_f32 v93, v93, v247
    v_mul_f32 v94, v94, v247
    v_mul_f32 v95, v95, v247
    v_mul_f32 v96, v96, v247
    v_mul_f32 v97, v97, v247
    v_mul_f32 v98, v98, v247
    v_mul_f32 v99, v99, v247
    v_mul_f32 v100, v100, v247
    v_mul_f32 v101, v101, v247
    v_mul_f32 v102, v102, v247
    v_mul_f32 v103, v103, v247
    v_mul_f32 v104, v104, v247
    v_mul_f32 v105, v105, v247
    v_mul_f32 v106, v106, v247
    v_mul_f32 v107, v107, v247
    v_mul_f32 v108, v108, v247
    v_mul_f32 v109, v109, v247
    v_mul_f32 v110, v110, v247
    v_mul_f32 v111, v111, v247
    v_mul_f32 v112, v112, v247
    v_mul_f32 v113, v113, v247
    v_mul_f32 v114, v114, v247
    v_mul_f32 v115, v115, v247
    v_mul_f32 v116, v116, v247
    v_mul_f32 v117, v117, v247
    v_mul_f32 v118, v118, v247
    v_mul_f32 v119, v119, v247
    v_mul_f32 v120, v120, v247
    v_mul_f32 v121, v121, v247
    v_mul_f32 v122, v122, v247
    v_mul_f32 v123, v123, v247
    v_mul_f32 v124, v124, v247
    v_mul_f32 v125, v125, v247
    v_mul_f32 v126, v126, v247
    v_mul_f32 v127, v127, v247
    v_exp_f32 v234, v128
    v_exp_f32 v235, v129
    v_exp_f32 v236, v130
    v_exp_f32 v237, v131
    v_mov_b32 v229, v234
    v_mov_b32 v230, v235
    v_cvt_pk_bf16_f32 v208, v234, v235
    v_exp_f32 v238, v132
    v_exp_f32 v239, v133
    v_mov_b32 v231, v236
    v_mov_b32 v232, v237
    v_cvt_pk_bf16_f32 v209, v236, v237
    v_exp_f32 v240, v134
    v_exp_f32 v241, v135
    v_add_f32 v229, v229, v238
    v_add_f32 v230, v230, v239
    v_cvt_pk_bf16_f32 v210, v238, v239
    v_exp_f32 v234, v136
    v_exp_f32 v235, v137
    v_add_f32 v231, v231, v240
    v_add_f32 v232, v232, v241
    v_cvt_pk_bf16_f32 v211, v240, v241
    v_exp_f32 v236, v138
    v_exp_f32 v237, v139
    v_add_f32 v229, v229, v234
    v_add_f32 v230, v230, v235
    v_cvt_pk_bf16_f32 v212, v234, v235
    v_exp_f32 v238, v140
    v_exp_f32 v239, v141
    v_add_f32 v231, v231, v236
    v_add_f32 v232, v232, v237
    v_cvt_pk_bf16_f32 v213, v236, v237
    v_exp_f32 v240, v142
    v_exp_f32 v241, v143
    v_add_f32 v229, v229, v238
    v_add_f32 v230, v230, v239
    v_cvt_pk_bf16_f32 v214, v238, v239
    v_exp_f32 v234, v144
    v_exp_f32 v235, v145
    v_add_f32 v231, v231, v240
    v_add_f32 v232, v232, v241
    v_cvt_pk_bf16_f32 v215, v240, v241
    v_exp_f32 v236, v146
    v_exp_f32 v237, v147
    v_add_f32 v229, v229, v234
    v_add_f32 v230, v230, v235
    v_cvt_pk_bf16_f32 v216, v234, v235
    v_exp_f32 v238, v148
    v_exp_f32 v239, v149
    v_add_f32 v231, v231, v236
    v_add_f32 v232, v232, v237
    v_cvt_pk_bf16_f32 v217, v236, v237
    v_exp_f32 v240, v150
    v_exp_f32 v241, v151
    v_add_f32 v229, v229, v238
    v_add_f32 v230, v230, v239
    v_cvt_pk_bf16_f32 v218, v238, v239
    v_exp_f32 v234, v152
    v_exp_f32 v235, v153
    v_add_f32 v231, v231, v240
    v_add_f32 v232, v232, v241
    v_cvt_pk_bf16_f32 v219, v240, v241
    v_exp_f32 v236, v154
    v_exp_f32 v237, v155
    v_add_f32 v229, v229, v234
    v_add_f32 v230, v230, v235
    v_cvt_pk_bf16_f32 v220, v234, v235
    v_exp_f32 v238, v156
    v_exp_f32 v239, v157
    v_add_f32 v231, v231, v236
    v_add_f32 v232, v232, v237
    v_cvt_pk_bf16_f32 v221, v236, v237
    v_exp_f32 v240, v158
    v_exp_f32 v241, v159
    v_add_f32 v229, v229, v238
    v_add_f32 v230, v230, v239
    v_cvt_pk_bf16_f32 v222, v238, v239
    s_nop 0
    v_add_f32 v231, v231, v240
    v_add_f32 v232, v232, v241
    v_cvt_pk_bf16_f32 v223, v240, v241
    v_add_f32 v229, v229, v230
    v_add_f32 v231, v231, v232
    v_add_f32 v229, v229, v231
    s_nop 1
    s_cmp_eq_u32 s49, 1
    s_cbranch_scc1 attn_kernel_ret1
    s_cmp_eq_u32 s49, 5
    s_cbranch_scc1 attn_kernel_ret5
    s_cmp_eq_u32 s49, 6
    s_cbranch_scc1 attn_kernel_ret6
    s_cmp_eq_u32 s49, 0
    s_cbranch_scc1 attn_kernel_ret0
    s_branch attn_kernel_ret4
attn_kernel_slow1:
    s_nop 7
    s_nop 7
    v_max3_f32 v246, v160, v161, v162
    v_max3_f32 v247, v163, v164, v165
    v_max3_f32 v246, v246, v166, v167
    v_max3_f32 v247, v247, v168, v169
    v_max3_f32 v246, v246, v170, v171
    v_max3_f32 v247, v247, v172, v173
    v_max3_f32 v246, v246, v174, v175
    v_max3_f32 v247, v247, v176, v177
    v_max3_f32 v246, v246, v178, v179
    v_max3_f32 v247, v247, v180, v181
    v_max3_f32 v246, v246, v182, v183
    v_max3_f32 v247, v247, v184, v185
    v_max3_f32 v246, v246, v186, v187
    v_max3_f32 v247, v247, v188, v189
    v_max3_f32 v246, v246, v190, v191
    v_max_f32 v246, v246, v247
    v_mov_b32 v247, v246
    s_nop 1
    v_permlane32_swap_b32 v246, v247
    s_nop 1
    v_max_f32 v246, v246, v247
    v_max_f32 v246, 0, v246
    v_sub_f32 v247, 0, v246
    v_exp_f32 v247, v247
    v_add_f32 v250, v250, v246
    v_sub_f32 v160, v160, v246
    v_sub_f32 v161, v161, v246
    v_sub_f32 v162, v162, v246
    v_sub_f32 v163, v163, v246
    v_sub_f32 v164, v164, v246
    v_sub_f32 v165, v165, v246
    v_sub_f32 v166, v166, v246
    v_sub_f32 v167, v167, v246
    v_sub_f32 v168, v168, v246
    v_sub_f32 v169, v169, v246
    v_sub_f32 v170, v170, v246
    v_sub_f32 v171, v171, v246
    v_sub_f32 v172, v172, v246
    v_sub_f32 v173, v173, v246
    v_sub_f32 v174, v174, v246
    v_sub_f32 v175, v175, v246
    v_sub_f32 v176, v176, v246
    v_sub_f32 v177, v177, v246
    v_sub_f32 v178, v178, v246
    v_sub_f32 v179, v179, v246
    v_sub_f32 v180, v180, v246
    v_sub_f32 v181, v181, v246
    v_sub_f32 v182, v182, v246
    v_sub_f32 v183, v183, v246
    v_sub_f32 v184, v184, v246
    v_sub_f32 v185, v185, v246
    v_sub_f32 v186, v186, v246
    v_sub_f32 v187, v187, v246
    v_sub_f32 v188, v188, v246
    v_sub_f32 v189, v189, v246
    v_sub_f32 v190, v190, v246
    v_sub_f32 v191, v191, v246
    s_cmp_eq_u32 s49, 14
    s_cbranch_scc1 attn_kernel_slow1_nq
    v_sub_f32 v128, v128, v246
    v_sub_f32 v129, v129, v246
    v_sub_f32 v130, v130, v246
    v_sub_f32 v131, v131, v246
    v_sub_f32 v132, v132, v246
    v_sub_f32 v133, v133, v246
    v_sub_f32 v134, v134, v246
    v_sub_f32 v135, v135, v246
    v_sub_f32 v136, v136, v246
    v_sub_f32 v137, v137, v246
    v_sub_f32 v138, v138, v246
    v_sub_f32 v139, v139, v246
    v_sub_f32 v140, v140, v246
    v_sub_f32 v141, v141, v246
    v_sub_f32 v142, v142, v246
    v_sub_f32 v143, v143, v246
    v_sub_f32 v144, v144, v246
    v_sub_f32 v145, v145, v246
    v_sub_f32 v146, v146, v246
    v_sub_f32 v147, v147, v246
    v_sub_f32 v148, v148, v246
    v_sub_f32 v149, v149, v246
    v_sub_f32 v150, v150, v246
    v_sub_f32 v151, v151, v246
    v_sub_f32 v152, v152, v246
    v_sub_f32 v153, v153, v246
    v_sub_f32 v154, v154, v246
    v_sub_f32 v155, v155, v246
    v_sub_f32 v156, v156, v246
    v_sub_f32 v157, v157, v246
    v_sub_f32 v158, v158, v246
    v_sub_f32 v159, v159, v246
attn_kernel_slow1_nq:
    v_sub_f32 v192, 0, v250
    v_sub_f32 v193, 0, v250
    v_sub_f32 v194, 0, v250
    v_sub_f32 v195, 0, v250
    v_sub_f32 v196, 0, v250
    v_sub_f32 v197, 0, v250
    v_sub_f32 v198, 0, v250
    v_sub_f32 v199, 0, v250
    v_sub_f32 v200, 0, v250
    v_sub_f32 v201, 0, v250
    v_sub_f32 v202, 0, v250
    v_sub_f32 v203, 0, v250
    v_sub_f32 v204, 0, v250
    v_sub_f32 v205, 0, v250
    v_sub_f32 v206, 0, v250
    v_sub_f32 v207, 0, v250
    v_mul_f32 v228, v228, v247
    v_mul_f32 v0, v0, v247
    v_mul_f32 v1, v1, v247
    v_mul_f32 v2, v2, v247
    v_mul_f32 v3, v3, v247
    v_mul_f32 v4, v4, v247
    v_mul_f32 v5, v5, v247
    v_mul_f32 v6, v6, v247
    v_mul_f32 v7, v7, v247
    v_mul_f32 v8, v8, v247
    v_mul_f32 v9, v9, v247
    v_mul_f32 v10, v10, v247
    v_mul_f32 v11, v11, v247
    v_mul_f32 v12, v12, v247
    v_mul_f32 v13, v13, v247
    v_mul_f32 v14, v14, v247
    v_mul_f32 v15, v15, v247
    v_mul_f32 v16, v16, v247
    v_mul_f32 v17, v17, v247
    v_mul_f32 v18, v18, v247
    v_mul_f32 v19, v19, v247
    v_mul_f32 v20, v20, v247
    v_mul_f32 v21, v21, v247
    v_mul_f32 v22, v22, v247
    v_mul_f32 v23, v23, v247
    v_mul_f32 v24, v24, v247
    v_mul_f32 v25, v25, v247
    v_mul_f32 v26, v26, v247
    v_mul_f32 v27, v27, v247
    v_mul_f32 v28, v28, v247
    v_mul_f32 v29, v29, v247
    v_mul_f32 v30, v30, v247
    v_mul_f32 v31, v31, v247
    v_mul_f32 v32, v32, v247
    v_mul_f32 v33, v33, v247
    v_mul_f32 v34, v34, v247
    v_mul_f32 v35, v35, v247
    v_mul_f32 v36, v36, v247
    v_mul_f32 v37, v37, v247
    v_mul_f32 v38, v38, v247
    v_mul_f32 v39, v39, v247
    v_mul_f32 v40, v40, v247
    v_mul_f32 v41, v41, v247
    v_mul_f32 v42, v42, v247
    v_mul_f32 v43, v43, v247
    v_mul_f32 v44, v44, v247
    v_mul_f32 v45, v45, v247
    v_mul_f32 v46, v46, v247
    v_mul_f32 v47, v47, v247
    v_mul_f32 v48, v48, v247
    v_mul_f32 v49, v49, v247
    v_mul_f32 v50, v50, v247
    v_mul_f32 v51, v51, v247
    v_mul_f32 v52, v52, v247
    v_mul_f32 v53, v53, v247
    v_mul_f32 v54, v54, v247
    v_mul_f32 v55, v55, v247
    v_mul_f32 v56, v56, v247
    v_mul_f32 v57, v57, v247
    v_mul_f32 v58, v58, v247
    v_mul_f32 v59, v59, v247
    v_mul_f32 v60, v60, v247
    v_mul_f32 v61, v61, v247
    v_mul_f32 v62, v62, v247
    v_mul_f32 v63, v63, v247
    v_mul_f32 v64, v64, v247
    v_mul_f32 v65, v65, v247
    v_mul_f32 v66, v66, v247
    v_mul_f32 v67, v67, v247
    v_mul_f32 v68, v68, v247
    v_mul_f32 v69, v69, v247
    v_mul_f32 v70, v70, v247
    v_mul_f32 v71, v71, v247
    v_mul_f32 v72, v72, v247
    v_mul_f32 v73, v73, v247
    v_mul_f32 v74, v74, v247
    v_mul_f32 v75, v75, v247
    v_mul_f32 v76, v76, v247
    v_mul_f32 v77, v77, v247
    v_mul_f32 v78, v78, v247
    v_mul_f32 v79, v79, v247
    v_mul_f32 v80, v80, v247
    v_mul_f32 v81, v81, v247
    v_mul_f32 v82, v82, v247
    v_mul_f32 v83, v83, v247
    v_mul_f32 v84, v84, v247
    v_mul_f32 v85, v85, v247
    v_mul_f32 v86, v86, v247
    v_mul_f32 v87, v87, v247
    v_mul_f32 v88, v88, v247
    v_mul_f32 v89, v89, v247
    v_mul_f32 v90, v90, v247
    v_mul_f32 v91, v91, v247
    v_mul_f32 v92, v92, v247
    v_mul_f32 v93, v93, v247
    v_mul_f32 v94, v94, v247
    v_mul_f32 v95, v95, v247
    v_mul_f32 v96, v96, v247
    v_mul_f32 v97, v97, v247
    v_mul_f32 v98, v98, v247
    v_mul_f32 v99, v99, v247
    v_mul_f32 v100, v100, v247
    v_mul_f32 v101, v101, v247
    v_mul_f32 v102, v102, v247
    v_mul_f32 v103, v103, v247
    v_mul_f32 v104, v104, v247
    v_mul_f32 v105, v105, v247
    v_mul_f32 v106, v106, v247
    v_mul_f32 v107, v107, v247
    v_mul_f32 v108, v108, v247
    v_mul_f32 v109, v109, v247
    v_mul_f32 v110, v110, v247
    v_mul_f32 v111, v111, v247
    v_mul_f32 v112, v112, v247
    v_mul_f32 v113, v113, v247
    v_mul_f32 v114, v114, v247
    v_mul_f32 v115, v115, v247
    v_mul_f32 v116, v116, v247
    v_mul_f32 v117, v117, v247
    v_mul_f32 v118, v118, v247
    v_mul_f32 v119, v119, v247
    v_mul_f32 v120, v120, v247
    v_mul_f32 v121, v121, v247
    v_mul_f32 v122, v122, v247
    v_mul_f32 v123, v123, v247
    v_mul_f32 v124, v124, v247
    v_mul_f32 v125, v125, v247
    v_mul_f32 v126, v126, v247
    v_mul_f32 v127, v127, v247
    v_exp_f32 v234, v160
    v_exp_f32 v235, v161
    v_exp_f32 v236, v162
    v_exp_f32 v237, v163
    v_mov_b32 v229, v234
    v_mov_b32 v230, v235
    v_cvt_pk_bf16_f32 v208, v234, v235
    v_exp_f32 v238, v164
    v_exp_f32 v239, v165
    v_mov_b32 v231, v236
    v_mov_b32 v232, v237
    v_cvt_pk_bf16_f32 v209, v236, v237
    v_exp_f32 v240, v166
    v_exp_f32 v241, v167
    v_add_f32 v229, v229, v238
    v_add_f32 v230, v230, v239
    v_cvt_pk_bf16_f32 v210, v238, v239
    v_exp_f32 v234, v168
    v_exp_f32 v235, v169
    v_add_f32 v231, v231, v240
    v_add_f32 v232, v232, v241
    v_cvt_pk_bf16_f32 v211, v240, v241
    v_exp_f32 v236, v170
    v_exp_f32 v237, v171
    v_add_f32 v229, v229, v234
    v_add_f32 v230, v230, v235
    v_cvt_pk_bf16_f32 v212, v234, v235
    v_exp_f32 v238, v172
    v_exp_f32 v239, v173
    v_add_f32 v231, v231, v236
    v_add_f32 v232, v232, v237
    v_cvt_pk_bf16_f32 v213, v236, v237
    v_exp_f32 v240, v174
    v_exp_f32 v241, v175
    v_add_f32 v229, v229, v238
    v_add_f32 v230, v230, v239
    v_cvt_pk_bf16_f32 v214, v238, v239
    v_exp_f32 v234, v176
    v_exp_f32 v235, v177
    v_add_f32 v231, v231, v240
    v_add_f32 v232, v232, v241
    v_cvt_pk_bf16_f32 v215, v240, v241
    v_exp_f32 v236, v178
    v_exp_f32 v237, v179
    v_add_f32 v229, v229, v234
    v_add_f32 v230, v230, v235
    v_cvt_pk_bf16_f32 v216, v234, v235
    v_exp_f32 v238, v180
    v_exp_f32 v239, v181
    v_add_f32 v231, v231, v236
    v_add_f32 v232, v232, v237
    v_cvt_pk_bf16_f32 v217, v236, v237
    v_exp_f32 v240, v182
    v_exp_f32 v241, v183
    v_add_f32 v229, v229, v238
    v_add_f32 v230, v230, v239
    v_cvt_pk_bf16_f32 v218, v238, v239
    v_exp_f32 v234, v184
    v_exp_f32 v235, v185
    v_add_f32 v231, v231, v240
    v_add_f32 v232, v232, v241
    v_cvt_pk_bf16_f32 v219, v240, v241
    v_exp_f32 v236, v186
    v_exp_f32 v237, v187
    v_add_f32 v229, v229, v234
    v_add_f32 v230, v230, v235
    v_cvt_pk_bf16_f32 v220, v234, v235
    v_exp_f32 v238, v188
    v_exp_f32 v239, v189
    v_add_f32 v231, v231, v236
    v_add_f32 v232, v232, v237
    v_cvt_pk_bf16_f32 v221, v236, v237
    v_exp_f32 v240, v190
    v_exp_f32 v241, v191
    v_add_f32 v229, v229, v238
    v_add_f32 v230, v230, v239
    v_cvt_pk_bf16_f32 v222, v238, v239
    s_nop 0
    v_add_f32 v231, v231, v240
    v_add_f32 v232, v232, v241
    v_cvt_pk_bf16_f32 v223, v240, v241
    v_add_f32 v229, v229, v230
    v_add_f32 v231, v231, v232
    v_add_f32 v229, v229, v231
    s_nop 1
    s_cmp_eq_u32 s49, 9
    s_cbranch_scc1 attn_kernel_ret9
    s_cmp_eq_u32 s49, 13
    s_cbranch_scc1 attn_kernel_ret13
    s_cmp_eq_u32 s49, 14
    s_cbranch_scc1 attn_kernel_ret14
    s_cmp_eq_u32 s49, 8
    s_cbranch_scc1 attn_kernel_ret8
    s_branch attn_kernel_ret12
attn_kernel_epi:
    s_nop 7
    s_nop 7
    v_mov_b32 v246, v228
    v_mov_b32 v247, v228
    s_nop 1
    v_permlane32_swap_b32 v246, v247
    s_nop 1
    v_add_f32 v228, v246, v247
    s_cmp_eq_u32 s47, 0
    s_cbranch_scc1 attn_kernel_merge
    s_cmp_eq_u32 s76, 0
    s_cbranch_scc1 attn_kernel_plain
    s_waitcnt vmcnt(0)
    s_mov_b32 s76, 0
    s_mov_b64 exec, 1
    v_mov_b32 v246, s78
    v_mov_b32 v247, s79
    global_atomic_or v246, v247, s[60:61] sc1
    s_mov_b64 exec, -1
attn_kernel_plain:
    v_rcp_f32 v246, v228
    s_branch attn_kernel_final
attn_kernel_merge:
    s_cmp_eq_u32 s77, 2
    s_cbranch_scc1 attn_kernel_have
    s_cmp_eq_u32 s77, 3
    s_cbranch_scc0 attn_kernel_spin
    s_waitcnt vmcnt(0)
    v_readfirstlane_b32 s41, v227
    s_nop 3
    s_and_b32 s41, s41, s79
    s_cbranch_scc1 attn_kernel_got
attn_kernel_spin:
    v_mov_b32 v246, s78
    global_load_dword v227, v246, s[60:61] sc1
    s_waitcnt vmcnt(0)
    v_readfirstlane_b32 s41, v227
    s_nop 3
    s_and_b32 s41, s41, s79
    s_cbranch_scc0 attn_kernel_spin
attn_kernel_got:
    s_mov_b32 s42, 0
    buffer_load_dwordx4 a[128:131], v224, s[24:27], s42 offen offset:0 sc1
    buffer_load_dwordx4 a[132:135], v224, s[24:27], s42 offen offset:1024 sc1
    buffer_load_dwordx4 a[136:139], v224, s[24:27], s42 offen offset:2048 sc1
    buffer_load_dwordx4 a[140:143], v224, s[24:27], s42 offen offset:3072 sc1
    s_add_u32 s42, s42, 4096
    buffer_load_dwordx4 a[144:147], v224, s[24:27], s42 offen offset:0 sc1
    buffer_load_dwordx4 a[148:151], v224, s[24:27], s42 offen offset:1024 sc1
    buffer_load_dwordx4 a[152:155], v224, s[24:27], s42 offen offset:2048 sc1
    buffer_load_dwordx4 a[156:159], v224, s[24:27], s42 offen offset:3072 sc1
    s_add_u32 s42, s42, 4096
    buffer_load_dwordx4 a[160:163], v224, s[24:27], s42 offen offset:0 sc1
    buffer_load_dwordx4 a[164:167], v224, s[24:27], s42 offen offset:1024 sc1
    buffer_load_dwordx4 a[168:171], v224, s[24:27], s42 offen offset:2048 sc1
    buffer_load_dwordx4 a[172:175], v224, s[24:27], s42 offen offset:3072 sc1
    s_add_u32 s42, s42, 4096
    buffer_load_dwordx4 a[176:179], v224, s[24:27], s42 offen offset:0 sc1
    buffer_load_dwordx4 a[180:183], v224, s[24:27], s42 offen offset:1024 sc1
    buffer_load_dwordx4 a[184:187], v224, s[24:27], s42 offen offset:2048 sc1
    buffer_load_dwordx4 a[188:191], v224, s[24:27], s42 offen offset:3072 sc1
    s_add_u32 s42, s42, 4096
    v_lshrrev_b32 v248, 1, v224
    buffer_load_dwordx2 v[254:255], v248, s[24:27], s42 offen sc1
attn_kernel_have:
    s_waitcnt vmcnt(0)
    v_max_f32 v246, v250, v254
    v_sub_f32 v247, v250, v246
    v_sub_f32 v249, v254, v246
    v_exp_f32 v247, v247
    v_exp_f32 v249, v249
    s_nop 0
    v_mul_f32 v228, v228, v247
    v_fma_f32 v228, v255, v249, v228
    v_rcp_f32 v248, v228
    s_nop 0
    v_mul_f32 v246, v247, v248
    v_mul_f32 v249, v249, v248
    s_lshl_b32 s41, s30, 2
    s_add_u32 s41, s41, s28
    s_lshl_b32 s41, s41, 18
    s_lshl_b32 s42, s29, 14
    s_add_u32 s41, s41, s42
    v_accvgpr_read_b32 v192, a128
    v_accvgpr_read_b32 v193, a129
    v_accvgpr_read_b32 v194, a130
    v_accvgpr_read_b32 v195, a131
    v_accvgpr_read_b32 v196, a132
    v_accvgpr_read_b32 v197, a133
    v_accvgpr_read_b32 v198, a134
    v_accvgpr_read_b32 v199, a135
    v_mul_f32 v0, v0, v246
    v_mul_f32 v1, v1, v246
    v_mul_f32 v2, v2, v246
    v_mul_f32 v3, v3, v246
    v_mul_f32 v4, v4, v246
    v_mul_f32 v5, v5, v246
    v_mul_f32 v6, v6, v246
    v_mul_f32 v7, v7, v246
    v_mul_f32 v8, v8, v246
    v_mul_f32 v9, v9, v246
    v_mul_f32 v10, v10, v246
    v_mul_f32 v11, v11, v246
    v_mul_f32 v12, v12, v246
    v_mul_f32 v13, v13, v246
    v_mul_f32 v14, v14, v246
    v_mul_f32 v15, v15, v246
    v_lshlrev_b32 v200, 16, v192
    v_and_b32 v201, 0xffff0000, v192
    v_lshlrev_b32 v202, 16, v193
    v_and_b32 v203, 0xffff0000, v193
    v_lshlrev_b32 v204, 16, v194
    v_and_b32 v205, 0xffff0000, v194
    v_lshlrev_b32 v206, 16, v195
    v_and_b32 v207, 0xffff0000, v195
    v_lshlrev_b32 v208, 16, v196
    v_and_b32 v209, 0xffff0000, v196
    v_lshlrev_b32 v210, 16, v197
    v_and_b32 v211, 0xffff0000, v197
    v_lshlrev_b32 v212, 16, v198
    v_and_b32 v213, 0xffff0000, v198
    v_lshlrev_b32 v214, 16, v199
    v_and_b32 v215, 0xffff0000, v199
    v_fma_f32 v0, v200, v249, v0
    v_fma_f32 v1, v201, v249, v1
    v_fma_f32 v2, v202, v249, v2
    v_fma_f32 v3, v203, v249, v3
    v_fma_f32 v4, v204, v249, v4
    v_fma_f32 v5, v205, v249, v5
    v_fma_f32 v6, v206, v249, v6
    v_fma_f32 v7, v207, v249, v7
    v_fma_f32 v8, v208, v249, v8
    v_fma_f32 v9, v209, v249, v9
    v_fma_f32 v10, v210, v249, v10
    v_fma_f32 v11, v211, v249, v11
    v_fma_f32 v12, v212, v249, v12
    v_fma_f32 v13, v213, v249, v13
    v_fma_f32 v14, v214, v249, v14
    v_fma_f32 v15, v215, v249, v15
    v_cvt_pk_bf16_f32 v128, v0, v1
    v_cvt_pk_bf16_f32 v129, v2, v3
    v_cvt_pk_bf16_f32 v130, v4, v5
    v_cvt_pk_bf16_f32 v131, v6, v7
    v_cvt_pk_bf16_f32 v132, v8, v9
    v_cvt_pk_bf16_f32 v133, v10, v11
    v_cvt_pk_bf16_f32 v134, v12, v13
    v_cvt_pk_bf16_f32 v135, v14, v15
    buffer_store_dwordx4 v[128:131], v224, s[20:23], s41 offen offset:0 sc1
    buffer_store_dwordx4 v[132:135], v224, s[20:23], s41 offen offset:1024 sc1
    v_accvgpr_read_b32 v192, a136
    v_accvgpr_read_b32 v193, a137
    v_accvgpr_read_b32 v194, a138
    v_accvgpr_read_b32 v195, a139
    v_accvgpr_read_b32 v196, a140
    v_accvgpr_read_b32 v197, a141
    v_accvgpr_read_b32 v198, a142
    v_accvgpr_read_b32 v199, a143
    v_mul_f32 v16, v16, v246
    v_mul_f32 v17, v17, v246
    v_mul_f32 v18, v18, v246
    v_mul_f32 v19, v19, v246
    v_mul_f32 v20, v20, v246
    v_mul_f32 v21, v21, v246
    v_mul_f32 v22, v22, v246
    v_mul_f32 v23, v23, v246
    v_mul_f32 v24, v24, v246
    v_mul_f32 v25, v25, v246
    v_mul_f32 v26, v26, v246
    v_mul_f32 v27, v27, v246
    v_mul_f32 v28, v28, v246
    v_mul_f32 v29, v29, v246
    v_mul_f32 v30, v30, v246
    v_mul_f32 v31, v31, v246
    v_lshlrev_b32 v200, 16, v192
    v_and_b32 v201, 0xffff0000, v192
    v_lshlrev_b32 v202, 16, v193
    v_and_b32 v203, 0xffff0000, v193
    v_lshlrev_b32 v204, 16, v194
    v_and_b32 v205, 0xffff0000, v194
    v_lshlrev_b32 v206, 16, v195
    v_and_b32 v207, 0xffff0000, v195
    v_lshlrev_b32 v208, 16, v196
    v_and_b32 v209, 0xffff0000, v196
    v_lshlrev_b32 v210, 16, v197
    v_and_b32 v211, 0xffff0000, v197
    v_lshlrev_b32 v212, 16, v198
    v_and_b32 v213, 0xffff0000, v198
    v_lshlrev_b32 v214, 16, v199
    v_and_b32 v215, 0xffff0000, v199
    v_fma_f32 v16, v200, v249, v16
    v_fma_f32 v17, v201, v249, v17
    v_fma_f32 v18, v202, v249, v18
    v_fma_f32 v19, v203, v249, v19
    v_fma_f32 v20, v204, v249, v20
    v_fma_f32 v21, v205, v249, v21
    v_fma_f32 v22, v206, v249, v22
    v_fma_f32 v23, v207, v249, v23
    v_fma_f32 v24, v208, v249, v24
    v_fma_f32 v25, v209, v249, v25
    v_fma_f32 v26, v210, v249, v26
    v_fma_f32 v27, v211, v249, v27
    v_fma_f32 v28, v212, v249, v28
    v_fma_f32 v29, v213, v249, v29
    v_fma_f32 v30, v214, v249, v30
    v_fma_f32 v31, v215, v249, v31
    v_cvt_pk_bf16_f32 v136, v16, v17
    v_cvt_pk_bf16_f32 v137, v18, v19
    v_cvt_pk_bf16_f32 v138, v20, v21
    v_cvt_pk_bf16_f32 v139, v22, v23
    v_cvt_pk_bf16_f32 v140, v24, v25
    v_cvt_pk_bf16_f32 v141, v26, v27
    v_cvt_pk_bf16_f32 v142, v28, v29
    v_cvt_pk_bf16_f32 v143, v30, v31
    buffer_store_dwordx4 v[136:139], v224, s[20:23], s41 offen offset:2048 sc1
    buffer_store_dwordx4 v[140:143], v224, s[20:23], s41 offen offset:3072 sc1
    s_add_u32 s41, s41, 4096
    v_accvgpr_read_b32 v192, a144
    v_accvgpr_read_b32 v193, a145
    v_accvgpr_read_b32 v194, a146
    v_accvgpr_read_b32 v195, a147
    v_accvgpr_read_b32 v196, a148
    v_accvgpr_read_b32 v197, a149
    v_accvgpr_read_b32 v198, a150
    v_accvgpr_read_b32 v199, a151
    v_mul_f32 v32, v32, v246
    v_mul_f32 v33, v33, v246
    v_mul_f32 v34, v34, v246
    v_mul_f32 v35, v35, v246
    v_mul_f32 v36, v36, v246
    v_mul_f32 v37, v37, v246
    v_mul_f32 v38, v38, v246
    v_mul_f32 v39, v39, v246
    v_mul_f32 v40, v40, v246
    v_mul_f32 v41, v41, v246
    v_mul_f32 v42, v42, v246
    v_mul_f32 v43, v43, v246
    v_mul_f32 v44, v44, v246
    v_mul_f32 v45, v45, v246
    v_mul_f32 v46, v46, v246
    v_mul_f32 v47, v47, v246
    v_lshlrev_b32 v200, 16, v192
    v_and_b32 v201, 0xffff0000, v192
    v_lshlrev_b32 v202, 16, v193
    v_and_b32 v203, 0xffff0000, v193
    v_lshlrev_b32 v204, 16, v194
    v_and_b32 v205, 0xffff0000, v194
    v_lshlrev_b32 v206, 16, v195
    v_and_b32 v207, 0xffff0000, v195
    v_lshlrev_b32 v208, 16, v196
    v_and_b32 v209, 0xffff0000, v196
    v_lshlrev_b32 v210, 16, v197
    v_and_b32 v211, 0xffff0000, v197
    v_lshlrev_b32 v212, 16, v198
    v_and_b32 v213, 0xffff0000, v198
    v_lshlrev_b32 v214, 16, v199
    v_and_b32 v215, 0xffff0000, v199
    v_fma_f32 v32, v200, v249, v32
    v_fma_f32 v33, v201, v249, v33
    v_fma_f32 v34, v202, v249, v34
    v_fma_f32 v35, v203, v249, v35
    v_fma_f32 v36, v204, v249, v36
    v_fma_f32 v37, v205, v249, v37
    v_fma_f32 v38, v206, v249, v38
    v_fma_f32 v39, v207, v249, v39
    v_fma_f32 v40, v208, v249, v40
    v_fma_f32 v41, v209, v249, v41
    v_fma_f32 v42, v210, v249, v42
    v_fma_f32 v43, v211, v249, v43
    v_fma_f32 v44, v212, v249, v44
    v_fma_f32 v45, v213, v249, v45
    v_fma_f32 v46, v214, v249, v46
    v_fma_f32 v47, v215, v249, v47
    v_cvt_pk_bf16_f32 v144, v32, v33
    v_cvt_pk_bf16_f32 v145, v34, v35
    v_cvt_pk_bf16_f32 v146, v36, v37
    v_cvt_pk_bf16_f32 v147, v38, v39
    v_cvt_pk_bf16_f32 v148, v40, v41
    v_cvt_pk_bf16_f32 v149, v42, v43
    v_cvt_pk_bf16_f32 v150, v44, v45
    v_cvt_pk_bf16_f32 v151, v46, v47
    buffer_store_dwordx4 v[144:147], v224, s[20:23], s41 offen offset:0 sc1
    buffer_store_dwordx4 v[148:151], v224, s[20:23], s41 offen offset:1024 sc1
    v_accvgpr_read_b32 v192, a152
    v_accvgpr_read_b32 v193, a153
    v_accvgpr_read_b32 v194, a154
    v_accvgpr_read_b32 v195, a155
    v_accvgpr_read_b32 v196, a156
    v_accvgpr_read_b32 v197, a157
    v_accvgpr_read_b32 v198, a158
    v_accvgpr_read_b32 v199, a159
    v_mul_f32 v48, v48, v246
    v_mul_f32 v49, v49, v246
    v_mul_f32 v50, v50, v246
    v_mul_f32 v51, v51, v246
    v_mul_f32 v52, v52, v246
    v_mul_f32 v53, v53, v246
    v_mul_f32 v54, v54, v246
    v_mul_f32 v55, v55, v246
    v_mul_f32 v56, v56, v246
    v_mul_f32 v57, v57, v246
    v_mul_f32 v58, v58, v246
    v_mul_f32 v59, v59, v246
    v_mul_f32 v60, v60, v246
    v_mul_f32 v61, v61, v246
    v_mul_f32 v62, v62, v246
    v_mul_f32 v63, v63, v246
    v_lshlrev_b32 v200, 16, v192
    v_and_b32 v201, 0xffff0000, v192
    v_lshlrev_b32 v202, 16, v193
    v_and_b32 v203, 0xffff0000, v193
    v_lshlrev_b32 v204, 16, v194
    v_and_b32 v205, 0xffff0000, v194
    v_lshlrev_b32 v206, 16, v195
    v_and_b32 v207, 0xffff0000, v195
    v_lshlrev_b32 v208, 16, v196
    v_and_b32 v209, 0xffff0000, v196
    v_lshlrev_b32 v210, 16, v197
    v_and_b32 v211, 0xffff0000, v197
    v_lshlrev_b32 v212, 16, v198
    v_and_b32 v213, 0xffff0000, v198
    v_lshlrev_b32 v214, 16, v199
    v_and_b32 v215, 0xffff0000, v199
    v_fma_f32 v48, v200, v249, v48
    v_fma_f32 v49, v201, v249, v49
    v_fma_f32 v50, v202, v249, v50
    v_fma_f32 v51, v203, v249, v51
    v_fma_f32 v52, v204, v249, v52
    v_fma_f32 v53, v205, v249, v53
    v_fma_f32 v54, v206, v249, v54
    v_fma_f32 v55, v207, v249, v55
    v_fma_f32 v56, v208, v249, v56
    v_fma_f32 v57, v209, v249, v57
    v_fma_f32 v58, v210, v249, v58
    v_fma_f32 v59, v211, v249, v59
    v_fma_f32 v60, v212, v249, v60
    v_fma_f32 v61, v213, v249, v61
    v_fma_f32 v62, v214, v249, v62
    v_fma_f32 v63, v215, v249, v63
    v_cvt_pk_bf16_f32 v152, v48, v49
    v_cvt_pk_bf16_f32 v153, v50, v51
    v_cvt_pk_bf16_f32 v154, v52, v53
    v_cvt_pk_bf16_f32 v155, v54, v55
    v_cvt_pk_bf16_f32 v156, v56, v57
    v_cvt_pk_bf16_f32 v157, v58, v59
    v_cvt_pk_bf16_f32 v158, v60, v61
    v_cvt_pk_bf16_f32 v159, v62, v63
    buffer_store_dwordx4 v[152:155], v224, s[20:23], s41 offen offset:2048 sc1
    buffer_store_dwordx4 v[156:159], v224, s[20:23], s41 offen offset:3072 sc1
    s_add_u32 s41, s41, 4096
    v_accvgpr_read_b32 v192, a160
    v_accvgpr_read_b32 v193, a161
    v_accvgpr_read_b32 v194, a162
    v_accvgpr_read_b32 v195, a163
    v_accvgpr_read_b32 v196, a164
    v_accvgpr_read_b32 v197, a165
    v_accvgpr_read_b32 v198, a166
    v_accvgpr_read_b32 v199, a167
    v_mul_f32 v64, v64, v246
    v_mul_f32 v65, v65, v246
    v_mul_f32 v66, v66, v246
    v_mul_f32 v67, v67, v246
    v_mul_f32 v68, v68, v246
    v_mul_f32 v69, v69, v246
    v_mul_f32 v70, v70, v246
    v_mul_f32 v71, v71, v246
    v_mul_f32 v72, v72, v246
    v_mul_f32 v73, v73, v246
    v_mul_f32 v74, v74, v246
    v_mul_f32 v75, v75, v246
    v_mul_f32 v76, v76, v246
    v_mul_f32 v77, v77, v246
    v_mul_f32 v78, v78, v246
    v_mul_f32 v79, v79, v246
    v_lshlrev_b32 v200, 16, v192
    v_and_b32 v201, 0xffff0000, v192
    v_lshlrev_b32 v202, 16, v193
    v_and_b32 v203, 0xffff0000, v193
    v_lshlrev_b32 v204, 16, v194
    v_and_b32 v205, 0xffff0000, v194
    v_lshlrev_b32 v206, 16, v195
    v_and_b32 v207, 0xffff0000, v195
    v_lshlrev_b32 v208, 16, v196
    v_and_b32 v209, 0xffff0000, v196
    v_lshlrev_b32 v210, 16, v197
    v_and_b32 v211, 0xffff0000, v197
    v_lshlrev_b32 v212, 16, v198
    v_and_b32 v213, 0xffff0000, v198
    v_lshlrev_b32 v214, 16, v199
    v_and_b32 v215, 0xffff0000, v199
    v_fma_f32 v64, v200, v249, v64
    v_fma_f32 v65, v201, v249, v65
    v_fma_f32 v66, v202, v249, v66
    v_fma_f32 v67, v203, v249, v67
    v_fma_f32 v68, v204, v249, v68
    v_fma_f32 v69, v205, v249, v69
    v_fma_f32 v70, v206, v249, v70
    v_fma_f32 v71, v207, v249, v71
    v_fma_f32 v72, v208, v249, v72
    v_fma_f32 v73, v209, v249, v73
    v_fma_f32 v74, v210, v249, v74
    v_fma_f32 v75, v211, v249, v75
    v_fma_f32 v76, v212, v249, v76
    v_fma_f32 v77, v213, v249, v77
    v_fma_f32 v78, v214, v249, v78
    v_fma_f32 v79, v215, v249, v79
    v_cvt_pk_bf16_f32 v128, v64, v65
    v_cvt_pk_bf16_f32 v129, v66, v67
    v_cvt_pk_bf16_f32 v130, v68, v69
    v_cvt_pk_bf16_f32 v131, v70, v71
    v_cvt_pk_bf16_f32 v132, v72, v73
    v_cvt_pk_bf16_f32 v133, v74, v75
    v_cvt_pk_bf16_f32 v134, v76, v77
    v_cvt_pk_bf16_f32 v135, v78, v79
    buffer_store_dwordx4 v[128:131], v224, s[20:23], s41 offen offset:0 sc1
    buffer_store_dwordx4 v[132:135], v224, s[20:23], s41 offen offset:1024 sc1
    v_accvgpr_read_b32 v192, a168
    v_accvgpr_read_b32 v193, a169
    v_accvgpr_read_b32 v194, a170
    v_accvgpr_read_b32 v195, a171
    v_accvgpr_read_b32 v196, a172
    v_accvgpr_read_b32 v197, a173
    v_accvgpr_read_b32 v198, a174
    v_accvgpr_read_b32 v199, a175
    v_mul_f32 v80, v80, v246
    v_mul_f32 v81, v81, v246
    v_mul_f32 v82, v82, v246
    v_mul_f32 v83, v83, v246
    v_mul_f32 v84, v84, v246
    v_mul_f32 v85, v85, v246
    v_mul_f32 v86, v86, v246
    v_mul_f32 v87, v87, v246
    v_mul_f32 v88, v88, v246
    v_mul_f32 v89, v89, v246
    v_mul_f32 v90, v90, v246
    v_mul_f32 v91, v91, v246
    v_mul_f32 v92, v92, v246
    v_mul_f32 v93, v93, v246
    v_mul_f32 v94, v94, v246
    v_mul_f32 v95, v95, v246
    v_lshlrev_b32 v200, 16, v192
    v_and_b32 v201, 0xffff0000, v192
    v_lshlrev_b32 v202, 16, v193
    v_and_b32 v203, 0xffff0000, v193
    v_lshlrev_b32 v204, 16, v194
    v_and_b32 v205, 0xffff0000, v194
    v_lshlrev_b32 v206, 16, v195
    v_and_b32 v207, 0xffff0000, v195
    v_lshlrev_b32 v208, 16, v196
    v_and_b32 v209, 0xffff0000, v196
    v_lshlrev_b32 v210, 16, v197
    v_and_b32 v211, 0xffff0000, v197
    v_lshlrev_b32 v212, 16, v198
    v_and_b32 v213, 0xffff0000, v198
    v_lshlrev_b32 v214, 16, v199
    v_and_b32 v215, 0xffff0000, v199
    v_fma_f32 v80, v200, v249, v80
    v_fma_f32 v81, v201, v249, v81
    v_fma_f32 v82, v202, v249, v82
    v_fma_f32 v83, v203, v249, v83
    v_fma_f32 v84, v204, v249, v84
    v_fma_f32 v85, v205, v249, v85
    v_fma_f32 v86, v206, v249, v86
    v_fma_f32 v87, v207, v249, v87
    v_fma_f32 v88, v208, v249, v88
    v_fma_f32 v89, v209, v249, v89
    v_fma_f32 v90, v210, v249, v90
    v_fma_f32 v91, v211, v249, v91
    v_fma_f32 v92, v212, v249, v92
    v_fma_f32 v93, v213, v249, v93
    v_fma_f32 v94, v214, v249, v94
    v_fma_f32 v95, v215, v249, v95
    v_cvt_pk_bf16_f32 v136, v80, v81
    v_cvt_pk_bf16_f32 v137, v82, v83
    v_cvt_pk_bf16_f32 v138, v84, v85
    v_cvt_pk_bf16_f32 v139, v86, v87
    v_cvt_pk_bf16_f32 v140, v88, v89
    v_cvt_pk_bf16_f32 v141, v90, v91
    v_cvt_pk_bf16_f32 v142, v92, v93
    v_cvt_pk_bf16_f32 v143, v94, v95
    buffer_store_dwordx4 v[136:139], v224, s[20:23], s41 offen offset:2048 sc1
    buffer_store_dwordx4 v[140:143], v224, s[20:23], s41 offen offset:3072 sc1
    s_add_u32 s41, s41, 4096
    v_accvgpr_read_b32 v192, a176
    v_accvgpr_read_b32 v193, a177
    v_accvgpr_read_b32 v194, a178
    v_accvgpr_read_b32 v195, a179
    v_accvgpr_read_b32 v196, a180
    v_accvgpr_read_b32 v197, a181
    v_accvgpr_read_b32 v198, a182
    v_accvgpr_read_b32 v199, a183
    v_mul_f32 v96, v96, v246
    v_mul_f32 v97, v97, v246
    v_mul_f32 v98, v98, v246
    v_mul_f32 v99, v99, v246
    v_mul_f32 v100, v100, v246
    v_mul_f32 v101, v101, v246
    v_mul_f32 v102, v102, v246
    v_mul_f32 v103, v103, v246
    v_mul_f32 v104, v104, v246
    v_mul_f32 v105, v105, v246
    v_mul_f32 v106, v106, v246
    v_mul_f32 v107, v107, v246
    v_mul_f32 v108, v108, v246
    v_mul_f32 v109, v109, v246
    v_mul_f32 v110, v110, v246
    v_mul_f32 v111, v111, v246
    v_lshlrev_b32 v200, 16, v192
    v_and_b32 v201, 0xffff0000, v192
    v_lshlrev_b32 v202, 16, v193
    v_and_b32 v203, 0xffff0000, v193
    v_lshlrev_b32 v204, 16, v194
    v_and_b32 v205, 0xffff0000, v194
    v_lshlrev_b32 v206, 16, v195
    v_and_b32 v207, 0xffff0000, v195
    v_lshlrev_b32 v208, 16, v196
    v_and_b32 v209, 0xffff0000, v196
    v_lshlrev_b32 v210, 16, v197
    v_and_b32 v211, 0xffff0000, v197
    v_lshlrev_b32 v212, 16, v198
    v_and_b32 v213, 0xffff0000, v198
    v_lshlrev_b32 v214, 16, v199
    v_and_b32 v215, 0xffff0000, v199
    v_fma_f32 v96, v200, v249, v96
    v_fma_f32 v97, v201, v249, v97
    v_fma_f32 v98, v202, v249, v98
    v_fma_f32 v99, v203, v249, v99
    v_fma_f32 v100, v204, v249, v100
    v_fma_f32 v101, v205, v249, v101
    v_fma_f32 v102, v206, v249, v102
    v_fma_f32 v103, v207, v249, v103
    v_fma_f32 v104, v208, v249, v104
    v_fma_f32 v105, v209, v249, v105
    v_fma_f32 v106, v210, v249, v106
    v_fma_f32 v107, v211, v249, v107
    v_fma_f32 v108, v212, v249, v108
    v_fma_f32 v109, v213, v249, v109
    v_fma_f32 v110, v214, v249, v110
    v_fma_f32 v111, v215, v249, v111
    v_cvt_pk_bf16_f32 v144, v96, v97
    v_cvt_pk_bf16_f32 v145, v98, v99
    v_cvt_pk_bf16_f32 v146, v100, v101
    v_cvt_pk_bf16_f32 v147, v102, v103
    v_cvt_pk_bf16_f32 v148, v104, v105
    v_cvt_pk_bf16_f32 v149, v106, v107
    v_cvt_pk_bf16_f32 v150, v108, v109
    v_cvt_pk_bf16_f32 v151, v110, v111
    buffer_store_dwordx4 v[144:147], v224, s[20:23], s41 offen offset:0 sc1
    buffer_store_dwordx4 v[148:151], v224, s[20:23], s41 offen offset:1024 sc1
    v_accvgpr_read_b32 v192, a184
    v_accvgpr_read_b32 v193, a185
    v_accvgpr_read_b32 v194, a186
    v_accvgpr_read_b32 v195, a187
    v_accvgpr_read_b32 v196, a188
    v_accvgpr_read_b32 v197, a189
    v_accvgpr_read_b32 v198, a190
    v_accvgpr_read_b32 v199, a191
    v_mul_f32 v112, v112, v246
    v_mul_f32 v113, v113, v246
    v_mul_f32 v114, v114, v246
    v_mul_f32 v115, v115, v246
    v_mul_f32 v116, v116, v246
    v_mul_f32 v117, v117, v246
    v_mul_f32 v118, v118, v246
    v_mul_f32 v119, v119, v246
    v_mul_f32 v120, v120, v246
    v_mul_f32 v121, v121, v246
    v_mul_f32 v122, v122, v246
    v_mul_f32 v123, v123, v246
    v_mul_f32 v124, v124, v246
    v_mul_f32 v125, v125, v246
    v_mul_f32 v126, v126, v246
    v_mul_f32 v127, v127, v246
    v_lshlrev_b32 v200, 16, v192
    v_and_b32 v201, 0xffff0000, v192
    v_lshlrev_b32 v202, 16, v193
    v_and_b32 v203, 0xffff0000, v193
    v_lshlrev_b32 v204, 16, v194
    v_and_b32 v205, 0xffff0000, v194
    v_lshlrev_b32 v206, 16, v195
    v_and_b32 v207, 0xffff0000, v195
    v_lshlrev_b32 v208, 16, v196
    v_and_b32 v209, 0xffff0000, v196
    v_lshlrev_b32 v210, 16, v197
    v_and_b32 v211, 0xffff0000, v197
    v_lshlrev_b32 v212, 16, v198
    v_and_b32 v213, 0xffff0000, v198
    v_lshlrev_b32 v214, 16, v199
    v_and_b32 v215, 0xffff0000, v199
    v_fma_f32 v112, v200, v249, v112
    v_fma_f32 v113, v201, v249, v113
    v_fma_f32 v114, v202, v249, v114
    v_fma_f32 v115, v203, v249, v115
    v_fma_f32 v116, v204, v249, v116
    v_fma_f32 v117, v205, v249, v117
    v_fma_f32 v118, v206, v249, v118
    v_fma_f32 v119, v207, v249, v119
    v_fma_f32 v120, v208, v249, v120
    v_fma_f32 v121, v209, v249, v121
    v_fma_f32 v122, v210, v249, v122
    v_fma_f32 v123, v211, v249, v123
    v_fma_f32 v124, v212, v249, v124
    v_fma_f32 v125, v213, v249, v125
    v_fma_f32 v126, v214, v249, v126
    v_fma_f32 v127, v215, v249, v127
    v_cvt_pk_bf16_f32 v152, v112, v113
    v_cvt_pk_bf16_f32 v153, v114, v115
    v_cvt_pk_bf16_f32 v154, v116, v117
    v_cvt_pk_bf16_f32 v155, v118, v119
    v_cvt_pk_bf16_f32 v156, v120, v121
    v_cvt_pk_bf16_f32 v157, v122, v123
    v_cvt_pk_bf16_f32 v158, v124, v125
    v_cvt_pk_bf16_f32 v159, v126, v127
    buffer_store_dwordx4 v[152:155], v224, s[20:23], s41 offen offset:2048 sc1
    buffer_store_dwordx4 v[156:159], v224, s[20:23], s41 offen offset:3072 sc1
    s_add_u32 s41, s41, 4096
    s_branch attn_kernel_fin
attn_kernel_final:
    s_lshl_b32 s41, s30, 2
    s_add_u32 s41, s41, s28
    s_lshl_b32 s41, s41, 18
    s_lshl_b32 s42, s29, 14
    s_add_u32 s41, s41, s42
    v_mul_f32 v0, v0, v246
    v_mul_f32 v1, v1, v246
    v_mul_f32 v2, v2, v246
    v_mul_f32 v3, v3, v246
    v_mul_f32 v4, v4, v246
    v_mul_f32 v5, v5, v246
    v_mul_f32 v6, v6, v246
    v_mul_f32 v7, v7, v246
    v_mul_f32 v8, v8, v246
    v_mul_f32 v9, v9, v246
    v_mul_f32 v10, v10, v246
    v_mul_f32 v11, v11, v246
    v_mul_f32 v12, v12, v246
    v_mul_f32 v13, v13, v246
    v_mul_f32 v14, v14, v246
    v_mul_f32 v15, v15, v246
    v_cvt_pk_bf16_f32 v128, v0, v1
    v_cvt_pk_bf16_f32 v129, v2, v3
    v_cvt_pk_bf16_f32 v130, v4, v5
    v_cvt_pk_bf16_f32 v131, v6, v7
    v_cvt_pk_bf16_f32 v132, v8, v9
    v_cvt_pk_bf16_f32 v133, v10, v11
    v_cvt_pk_bf16_f32 v134, v12, v13
    v_cvt_pk_bf16_f32 v135, v14, v15
    buffer_store_dwordx4 v[128:131], v224, s[20:23], s41 offen offset:0 sc1
    buffer_store_dwordx4 v[132:135], v224, s[20:23], s41 offen offset:1024 sc1
    v_mul_f32 v16, v16, v246
    v_mul_f32 v17, v17, v246
    v_mul_f32 v18, v18, v246
    v_mul_f32 v19, v19, v246
    v_mul_f32 v20, v20, v246
    v_mul_f32 v21, v21, v246
    v_mul_f32 v22, v22, v246
    v_mul_f32 v23, v23, v246
    v_mul_f32 v24, v24, v246
    v_mul_f32 v25, v25, v246
    v_mul_f32 v26, v26, v246
    v_mul_f32 v27, v27, v246
    v_mul_f32 v28, v28, v246
    v_mul_f32 v29, v29, v246
    v_mul_f32 v30, v30, v246
    v_mul_f32 v31, v31, v246
    v_cvt_pk_bf16_f32 v136, v16, v17
    v_cvt_pk_bf16_f32 v137, v18, v19
    v_cvt_pk_bf16_f32 v138, v20, v21
    v_cvt_pk_bf16_f32 v139, v22, v23
    v_cvt_pk_bf16_f32 v140, v24, v25
    v_cvt_pk_bf16_f32 v141, v26, v27
    v_cvt_pk_bf16_f32 v142, v28, v29
    v_cvt_pk_bf16_f32 v143, v30, v31
    buffer_store_dwordx4 v[136:139], v224, s[20:23], s41 offen offset:2048 sc1
    buffer_store_dwordx4 v[140:143], v224, s[20:23], s41 offen offset:3072 sc1
    s_add_u32 s41, s41, 4096
    v_mul_f32 v32, v32, v246
    v_mul_f32 v33, v33, v246
    v_mul_f32 v34, v34, v246
    v_mul_f32 v35, v35, v246
    v_mul_f32 v36, v36, v246
    v_mul_f32 v37, v37, v246
    v_mul_f32 v38, v38, v246
    v_mul_f32 v39, v39, v246
    v_mul_f32 v40, v40, v246
    v_mul_f32 v41, v41, v246
    v_mul_f32 v42, v42, v246
    v_mul_f32 v43, v43, v246
    v_mul_f32 v44, v44, v246
    v_mul_f32 v45, v45, v246
    v_mul_f32 v46, v46, v246
    v_mul_f32 v47, v47, v246
    v_cvt_pk_bf16_f32 v144, v32, v33
    v_cvt_pk_bf16_f32 v145, v34, v35
    v_cvt_pk_bf16_f32 v146, v36, v37
    v_cvt_pk_bf16_f32 v147, v38, v39
    v_cvt_pk_bf16_f32 v148, v40, v41
    v_cvt_pk_bf16_f32 v149, v42, v43
    v_cvt_pk_bf16_f32 v150, v44, v45
    v_cvt_pk_bf16_f32 v151, v46, v47
    buffer_store_dwordx4 v[144:147], v224, s[20:23], s41 offen offset:0 sc1
    buffer_store_dwordx4 v[148:151], v224, s[20:23], s41 offen offset:1024 sc1
    v_mul_f32 v48, v48, v246
    v_mul_f32 v49, v49, v246
    v_mul_f32 v50, v50, v246
    v_mul_f32 v51, v51, v246
    v_mul_f32 v52, v52, v246
    v_mul_f32 v53, v53, v246
    v_mul_f32 v54, v54, v246
    v_mul_f32 v55, v55, v246
    v_mul_f32 v56, v56, v246
    v_mul_f32 v57, v57, v246
    v_mul_f32 v58, v58, v246
    v_mul_f32 v59, v59, v246
    v_mul_f32 v60, v60, v246
    v_mul_f32 v61, v61, v246
    v_mul_f32 v62, v62, v246
    v_mul_f32 v63, v63, v246
    v_cvt_pk_bf16_f32 v152, v48, v49
    v_cvt_pk_bf16_f32 v153, v50, v51
    v_cvt_pk_bf16_f32 v154, v52, v53
    v_cvt_pk_bf16_f32 v155, v54, v55
    v_cvt_pk_bf16_f32 v156, v56, v57
    v_cvt_pk_bf16_f32 v157, v58, v59
    v_cvt_pk_bf16_f32 v158, v60, v61
    v_cvt_pk_bf16_f32 v159, v62, v63
    buffer_store_dwordx4 v[152:155], v224, s[20:23], s41 offen offset:2048 sc1
    buffer_store_dwordx4 v[156:159], v224, s[20:23], s41 offen offset:3072 sc1
    s_add_u32 s41, s41, 4096
    v_mul_f32 v64, v64, v246
    v_mul_f32 v65, v65, v246
    v_mul_f32 v66, v66, v246
    v_mul_f32 v67, v67, v246
    v_mul_f32 v68, v68, v246
    v_mul_f32 v69, v69, v246
    v_mul_f32 v70, v70, v246
    v_mul_f32 v71, v71, v246
    v_mul_f32 v72, v72, v246
    v_mul_f32 v73, v73, v246
    v_mul_f32 v74, v74, v246
    v_mul_f32 v75, v75, v246
    v_mul_f32 v76, v76, v246
    v_mul_f32 v77, v77, v246
    v_mul_f32 v78, v78, v246
    v_mul_f32 v79, v79, v246
    v_cvt_pk_bf16_f32 v128, v64, v65
    v_cvt_pk_bf16_f32 v129, v66, v67
    v_cvt_pk_bf16_f32 v130, v68, v69
    v_cvt_pk_bf16_f32 v131, v70, v71
    v_cvt_pk_bf16_f32 v132, v72, v73
    v_cvt_pk_bf16_f32 v133, v74, v75
    v_cvt_pk_bf16_f32 v134, v76, v77
    v_cvt_pk_bf16_f32 v135, v78, v79
    buffer_store_dwordx4 v[128:131], v224, s[20:23], s41 offen offset:0 sc1
    buffer_store_dwordx4 v[132:135], v224, s[20:23], s41 offen offset:1024 sc1
    v_mul_f32 v80, v80, v246
    v_mul_f32 v81, v81, v246
    v_mul_f32 v82, v82, v246
    v_mul_f32 v83, v83, v246
    v_mul_f32 v84, v84, v246
    v_mul_f32 v85, v85, v246
    v_mul_f32 v86, v86, v246
    v_mul_f32 v87, v87, v246
    v_mul_f32 v88, v88, v246
    v_mul_f32 v89, v89, v246
    v_mul_f32 v90, v90, v246
    v_mul_f32 v91, v91, v246
    v_mul_f32 v92, v92, v246
    v_mul_f32 v93, v93, v246
    v_mul_f32 v94, v94, v246
    v_mul_f32 v95, v95, v246
    v_cvt_pk_bf16_f32 v136, v80, v81
    v_cvt_pk_bf16_f32 v137, v82, v83
    v_cvt_pk_bf16_f32 v138, v84, v85
    v_cvt_pk_bf16_f32 v139, v86, v87
    v_cvt_pk_bf16_f32 v140, v88, v89
    v_cvt_pk_bf16_f32 v141, v90, v91
    v_cvt_pk_bf16_f32 v142, v92, v93
    v_cvt_pk_bf16_f32 v143, v94, v95
    buffer_store_dwordx4 v[136:139], v224, s[20:23], s41 offen offset:2048 sc1
    buffer_store_dwordx4 v[140:143], v224, s[20:23], s41 offen offset:3072 sc1
    s_add_u32 s41, s41, 4096
    v_mul_f32 v96, v96, v246
    v_mul_f32 v97, v97, v246
    v_mul_f32 v98, v98, v246
    v_mul_f32 v99, v99, v246
    v_mul_f32 v100, v100, v246
    v_mul_f32 v101, v101, v246
    v_mul_f32 v102, v102, v246
    v_mul_f32 v103, v103, v246
    v_mul_f32 v104, v104, v246
    v_mul_f32 v105, v105, v246
    v_mul_f32 v106, v106, v246
    v_mul_f32 v107, v107, v246
    v_mul_f32 v108, v108, v246
    v_mul_f32 v109, v109, v246
    v_mul_f32 v110, v110, v246
    v_mul_f32 v111, v111, v246
    v_cvt_pk_bf16_f32 v144, v96, v97
    v_cvt_pk_bf16_f32 v145, v98, v99
    v_cvt_pk_bf16_f32 v146, v100, v101
    v_cvt_pk_bf16_f32 v147, v102, v103
    v_cvt_pk_bf16_f32 v148, v104, v105
    v_cvt_pk_bf16_f32 v149, v106, v107
    v_cvt_pk_bf16_f32 v150, v108, v109
    v_cvt_pk_bf16_f32 v151, v110, v111
    buffer_store_dwordx4 v[144:147], v224, s[20:23], s41 offen offset:0 sc1
    buffer_store_dwordx4 v[148:151], v224, s[20:23], s41 offen offset:1024 sc1
    v_mul_f32 v112, v112, v246
    v_mul_f32 v113, v113, v246
    v_mul_f32 v114, v114, v246
    v_mul_f32 v115, v115, v246
    v_mul_f32 v116, v116, v246
    v_mul_f32 v117, v117, v246
    v_mul_f32 v118, v118, v246
    v_mul_f32 v119, v119, v246
    v_mul_f32 v120, v120, v246
    v_mul_f32 v121, v121, v246
    v_mul_f32 v122, v122, v246
    v_mul_f32 v123, v123, v246
    v_mul_f32 v124, v124, v246
    v_mul_f32 v125, v125, v246
    v_mul_f32 v126, v126, v246
    v_mul_f32 v127, v127, v246
    v_cvt_pk_bf16_f32 v152, v112, v113
    v_cvt_pk_bf16_f32 v153, v114, v115
    v_cvt_pk_bf16_f32 v154, v116, v117
    v_cvt_pk_bf16_f32 v155, v118, v119
    v_cvt_pk_bf16_f32 v156, v120, v121
    v_cvt_pk_bf16_f32 v157, v122, v123
    v_cvt_pk_bf16_f32 v158, v124, v125
    v_cvt_pk_bf16_f32 v159, v126, v127
    buffer_store_dwordx4 v[152:155], v224, s[20:23], s41 offen offset:2048 sc1
    buffer_store_dwordx4 v[156:159], v224, s[20:23], s41 offen offset:3072 sc1
    s_add_u32 s41, s41, 4096
attn_kernel_fin:
    s_load_dwordx2 s[68:69], s[0:1], 40
    s_load_dwordx4 s[72:75], s[0:1], 64
    s_add_u32 s64, s62, 132120576
    s_addc_u32 s65, s63, 0
    s_lshl_b32 s60, s30, 2
    s_add_u32 s60, s60, s28
    s_lshl_b32 s60, s60, 8
    s_cmp_ge_u32 s2, 224
    s_cbranch_scc1 attn_kernel_t_b
    s_and_b32 s42, s2, 7
    s_lshr_b32 s43, s2, 3
    s_lshl_b32 s21, s42, 2
    s_and_b32 s42, s43, 3
    s_add_u32 s21, s21, s42
    s_lshr_b32 s22, s43, 2
    s_mov_b32 s23, 0
    s_mov_b32 s35, 16777216
    s_mov_b32 s36, 3670016
    s_lshl_b32 s39, s21, 19
    s_lshl_b32 s42, s28, 16
    s_add_u32 s39, s39, s42
    s_mov_b32 s25, 262144
    s_mov_b32 s40, 8
    s_branch attn_kernel_t_d
attn_kernel_t_b:
    s_sub_u32 s21, s2, 224
    s_mov_b32 s22, s28
    s_mov_b32 s23, 1
    s_mov_b32 s35, 2097152
    s_mov_b32 s36, 401408
    s_lshl_b32 s39, s21, 16
    s_mov_b32 s25, 32768
    s_mov_b32 s40, 4
attn_kernel_t_d:
    s_lshl_b32 s27, s28, 15
    s_and_b32 s42, s21, 3
    s_lshl_b32 s42, s42, 1
    s_add_u32 s42, s42, s22
    s_mul_i32 s34, s42, 1
    s_cmp_eq_u32 s23, 1
    s_cselect_b32 s34, 0, s34
    s_cselect_b32 s31, 3584, 0
    s_add_u32 s42, s34, 0
    s_and_b32 s42, s42, 7
    s_lshl_b32 s44, s42, 10
    s_mul_i32 s52, s42, 14336
    s_lshr_b32 s42, s42, 1
    s_mul_i32 s42, s42, s31
    s_sub_u32 s52, s52, s42
    s_add_u32 s42, s34, 1
    s_and_b32 s42, s42, 7
    s_lshl_b32 s45, s42, 10
    s_mul_i32 s53, s42, 14336
    s_lshr_b32 s42, s42, 1
    s_mul_i32 s42, s42, s31
    s_sub_u32 s53, s53, s42
    s_add_u32 s42, s34, 2
    s_and_b32 s42, s42, 7
    s_lshl_b32 s46, s42, 10
    s_mul_i32 s54, s42, 14336
    s_lshr_b32 s42, s42, 1
    s_mul_i32 s42, s42, s31
    s_sub_u32 s54, s54, s42
    s_add_u32 s42, s34, 3
    s_and_b32 s42, s42, 7
    s_lshl_b32 s47, s42, 10
    s_mul_i32 s55, s42, 14336
    s_lshr_b32 s42, s42, 1
    s_mul_i32 s42, s42, s31
    s_sub_u32 s55, s55, s42
    s_add_u32 s42, s34, 4
    s_and_b32 s42, s42, 7
    s_lshl_b32 s48, s42, 10
    s_mul_i32 s56, s42, 14336
    s_lshr_b32 s42, s42, 1
    s_mul_i32 s42, s42, s31
    s_sub_u32 s56, s56, s42
    s_add_u32 s42, s34, 5
    s_and_b32 s42, s42, 7
    s_lshl_b32 s49, s42, 10
    s_mul_i32 s57, s42, 14336
    s_lshr_b32 s42, s42, 1
    s_mul_i32 s42, s42, s31
    s_sub_u32 s57, s57, s42
    s_add_u32 s42, s34, 6
    s_and_b32 s42, s42, 7
    s_lshl_b32 s50, s42, 10
    s_mul_i32 s58, s42, 14336
    s_lshr_b32 s42, s42, 1
    s_mul_i32 s42, s42, s31
    s_sub_u32 s58, s58, s42
    s_add_u32 s42, s34, 7
    s_and_b32 s42, s42, 7
    s_lshl_b32 s51, s42, 10
    s_mul_i32 s59, s42, 14336
    s_lshr_b32 s42, s42, 1
    s_mul_i32 s42, s42, s31
    s_sub_u32 s59, s59, s42
    s_lshl_b32 s31, s31, 2
    s_sub_u32 s37, 114688, s31
    v_bfe_u32 v115, v251, 2, 2
    v_lshrrev_b32 v116, 5, v251
    v_lshl_add_u32 v115, v116, 2, v115
    v_bfe_u32 v116, v251, 4, 1
    v_lshlrev_b32 v116, 1, v116
    v_bfe_u32 v117, v251, 1, 1
    v_add_u32 v116, v116, v117
    v_bfe_u32 v117, v115, 1, 1
    v_lshlrev_b32 v117, 2, v117
    v_xor_b32 v116, v116, v117
    v_lshlrev_b32 v116, 4, v116
    v_lshl_add_u32 v115, v115, 7, v116
    v_and_b32 v116, 1, v251
    v_lshl_add_u32 v118, v116, 3, v115
    s_waitcnt vmcnt(0)
    s_mov_b64 exec, 1
    v_mov_b32 v115, s60
    v_mov_b32 v116, 1
    global_atomic_add v115, v116, s[64:65] sc1
    s_mov_b64 exec, -1
    s_waitcnt lgkmcnt(0)
    s_cmp_eq_u32 s23, 1
    s_mov_b32 s41, 58720256
    s_cselect_b32 s41, 75497472, s41
    s_cselect_b32 s12, s72, s68
    s_cselect_b32 s13, s73, s69
    s_add_u32 s8, s62, s41
    s_addc_u32 s9, s63, 0
    s_mov_b32 s11, 0x20000
    s_mov_b32 s15, 0x20000
    s_mov_b32 s16, s74
    s_mov_b32 s17, s75
    s_mov_b32 s18, 3670016
    s_mov_b32 s19, 0x20000
    s_mov_b32 s76, s8
    s_mov_b32 s77, s9
    s_mov_b32 s78, 0
    s_mov_b32 s79, 0x20000
    s_mov_b32 s38, 0
    s_barrier
attn_kernel_t_round:
    s_mov_b32 s24, s39
    s_mul_i32 s26, s28, 917504
    s_cmp_eq_u32 s23, 1
    s_cselect_b32 s26, 0, s26
    s_mov_b32 s10, s35
    s_mov_b32 s14, s36
    v_lshrrev_b32 v115, 3, v251
    v_bfe_u32 v116, v251, 4, 1
    v_lshlrev_b32 v116, 2, v116
    v_and_b32 v117, 7, v251
    v_xor_b32 v116, v116, v117
    v_mul_u32_u24 v115, 896, v115
    v_lshl_add_u32 v112, v116, 4, v115
    s_lshl_b32 s41, s22, 7
    v_add_u32 v112, s41, v112
    s_add_u32 s41, s26, s52
    s_add_u32 m0, s27, 0
    s_add_u32 s42, s41, 7168
    buffer_load_dwordx4 v112, s[12:15], s41 offen lds
    s_add_u32 m0, s27, 1024
    s_nop 0
    buffer_load_dwordx4 v112, s[12:15], s42 offen lds
    s_add_u32 s41, s26, s53
    s_add_u32 m0, s27, 2048
    s_add_u32 s42, s41, 7168
    buffer_load_dwordx4 v112, s[12:15], s41 offen lds
    s_add_u32 m0, s27, 3072
    s_nop 0
    buffer_load_dwordx4 v112, s[12:15], s42 offen lds
    s_add_u32 s41, s26, s54
    s_add_u32 m0, s27, 4096
    s_add_u32 s42, s41, 7168
    buffer_load_dwordx4 v112, s[12:15], s41 offen lds
    s_add_u32 m0, s27, 5120
    s_nop 0
    buffer_load_dwordx4 v112, s[12:15], s42 offen lds
    s_add_u32 s41, s26, s55
    s_add_u32 m0, s27, 6144
    s_add_u32 s42, s41, 7168
    buffer_load_dwordx4 v112, s[12:15], s41 offen lds
    s_add_u32 m0, s27, 7168
    s_nop 0
    buffer_load_dwordx4 v112, s[12:15], s42 offen lds
    s_add_u32 s41, s26, s56
    s_add_u32 m0, s27, 8192
    s_add_u32 s42, s41, 7168
    buffer_load_dwordx4 v112, s[12:15], s41 offen lds
    s_add_u32 m0, s27, 9216
    s_nop 0
    buffer_load_dwordx4 v112, s[12:15], s42 offen lds
    s_add_u32 s41, s26, s57
    s_add_u32 m0, s27, 10240
    s_add_u32 s42, s41, 7168
    buffer_load_dwordx4 v112, s[12:15], s41 offen lds
    s_add_u32 m0, s27, 11264
    s_nop 0
    buffer_load_dwordx4 v112, s[12:15], s42 offen lds
    s_add_u32 s41, s26, s58
    s_add_u32 m0, s27, 12288
    s_add_u32 s42, s41, 7168
    buffer_load_dwordx4 v112, s[12:15], s41 offen lds
    s_add_u32 m0, s27, 13312
    s_nop 0
    buffer_load_dwordx4 v112, s[12:15], s42 offen lds
    s_add_u32 s41, s26, s59
    s_add_u32 m0, s27, 14336
    s_add_u32 s42, s41, 7168
    buffer_load_dwordx4 v112, s[12:15], s41 offen lds
    s_add_u32 m0, s27, 15360
    s_nop 0
    buffer_load_dwordx4 v112, s[12:15], s42 offen lds
    s_add_u32 s26, s26, s37
    s_add_u32 s41, s26, s52
    s_add_u32 m0, s27, 16384
    s_add_u32 s42, s41, 7168
    buffer_load_dwordx4 v112, s[12:15], s41 offen lds
    s_add_u32 m0, s27, 17408
    s_nop 0
    buffer_load_dwordx4 v112, s[12:15], s42 offen lds
    s_add_u32 s41, s26, s53
    s_add_u32 m0, s27, 18432
    s_add_u32 s42, s41, 7168
    buffer_load_dwordx4 v112, s[12:15], s41 offen lds
    s_add_u32 m0, s27, 19456
    s_nop 0
    buffer_load_dwordx4 v112, s[12:15], s42 offen lds
    s_add_u32 s41, s26, s54
    s_add_u32 m0, s27, 20480
    s_add_u32 s42, s41, 7168
    buffer_load_dwordx4 v112, s[12:15], s41 offen lds
    s_add_u32 m0, s27, 21504
    s_nop 0
    buffer_load_dwordx4 v112, s[12:15], s42 offen lds
    s_add_u32 s41, s26, s55
    s_add_u32 m0, s27, 22528
    s_add_u32 s42, s41, 7168
    buffer_load_dwordx4 v112, s[12:15], s41 offen lds
    s_add_u32 m0, s27, 23552
    s_nop 0
    buffer_load_dwordx4 v112, s[12:15], s42 offen lds
    s_add_u32 s41, s26, s56
    s_add_u32 m0, s27, 24576
    s_add_u32 s42, s41, 7168
    buffer_load_dwordx4 v112, s[12:15], s41 offen lds
    s_add_u32 m0, s27, 25600
    s_nop 0
    buffer_load_dwordx4 v112, s[12:15], s42 offen lds
    s_add_u32 s41, s26, s57
    s_add_u32 m0, s27, 26624
    s_add_u32 s42, s41, 7168
    buffer_load_dwordx4 v112, s[12:15], s41 offen lds
    s_add_u32 m0, s27, 27648
    s_nop 0
    buffer_load_dwordx4 v112, s[12:15], s42 offen lds
    s_add_u32 s41, s26, s58
    s_add_u32 m0, s27, 28672
    s_add_u32 s42, s41, 7168
    buffer_load_dwordx4 v112, s[12:15], s41 offen lds
    s_add_u32 m0, s27, 29696
    s_nop 0
    buffer_load_dwordx4 v112, s[12:15], s42 offen lds
    s_add_u32 s41, s26, s59
    s_add_u32 m0, s27, 30720
    s_add_u32 s42, s41, 7168
    buffer_load_dwordx4 v112, s[12:15], s41 offen lds
    s_add_u32 m0, s27, 31744
    s_nop 0
    buffer_load_dwordx4 v112, s[12:15], s42 offen lds
    s_add_u32 s26, s26, s37
    s_cmp_eq_u32 s38, 0
    s_cbranch_scc0 attn_kernel_t_ready
    s_cmp_eq_u32 s23, 1
    s_cbranch_scc1 attn_kernel_t_ready
    s_lshl_b32 s42, s21, 9
attn_kernel_t_spin:
    v_mov_b32 v115, s42
    global_load_dword v116, v115, s[64:65] sc1
    global_load_dword v117, v115, s[64:65] offset:256 sc1
    s_waitcnt vmcnt(0)
    v_min_u32 v116, v116, v117
    s_nop 0
    v_readfirstlane_b32 s43, v116
    s_nop 3
    s_cmp_ge_u32 s43, 16
    s_cbranch_scc0 attn_kernel_t_spin
attn_kernel_t_ready:
    s_add_u32 s42, s24, s44
    s_add_u32 s43, s42, s25
    buffer_load_dwordx4 v[64:67], v224, s[8:11], s42 offen sc1
    buffer_load_dwordx4 v[68:71], v224, s[8:11], s43 offen sc1
    buffer_load_dword v119, v224, s[76:79], 0 offen
    buffer_load_dword v119, v224, s[76:79], 0 offen
    s_add_u32 s42, s24, s45
    s_add_u32 s43, s42, s25
    buffer_load_dwordx4 v[72:75], v224, s[8:11], s42 offen sc1
    buffer_load_dwordx4 v[76:79], v224, s[8:11], s43 offen sc1
    buffer_load_dword v119, v224, s[76:79], 0 offen
    buffer_load_dword v119, v224, s[76:79], 0 offen
    s_add_u32 s42, s24, s46
    s_add_u32 s43, s42, s25
    buffer_load_dwordx4 v[80:83], v224, s[8:11], s42 offen sc1
    buffer_load_dwordx4 v[84:87], v224, s[8:11], s43 offen sc1
    buffer_load_dword v119, v224, s[76:79], 0 offen
    buffer_load_dword v119, v224, s[76:79], 0 offen
    v_mov_b32 v0, 0
    v_mov_b32 v1, 0
    v_mov_b32 v2, 0
    v_mov_b32 v3, 0
    v_mov_b32 v4, 0
    v_mov_b32 v5, 0
    v_mov_b32 v6, 0
    v_mov_b32 v7, 0
    v_mov_b32 v8, 0
    v_mov_b32 v9, 0
    v_mov_b32 v10, 0
    v_mov_b32 v11, 0
    v_mov_b32 v12, 0
    v_mov_b32 v13, 0
    v_mov_b32 v14, 0
    v_mov_b32 v15, 0
    v_mov_b32 v16, 0
    v_mov_b32 v17, 0
    v_mov_b32 v18, 0
    v_mov_b32 v19, 0
    v_mov_b32 v20, 0
    v_mov_b32 v21, 0
    v_mov_b32 v22, 0
    v_mov_b32 v23, 0
    v_mov_b32 v24, 0
    v_mov_b32 v25, 0
    v_mov_b32 v26, 0
    v_mov_b32 v27, 0
    v_mov_b32 v28, 0
    v_mov_b32 v29, 0
    v_mov_b32 v30, 0
    v_mov_b32 v31, 0
    v_mov_b32 v32, 0
    v_mov_b32 v33, 0
    v_mov_b32 v34, 0
    v_mov_b32 v35, 0
    v_mov_b32 v36, 0
    v_mov_b32 v37, 0
    v_mov_b32 v38, 0
    v_mov_b32 v39, 0
    v_mov_b32 v40, 0
    v_mov_b32 v41, 0
    v_mov_b32 v42, 0
    v_mov_b32 v43, 0
    v_mov_b32 v44, 0
    v_mov_b32 v45, 0
    v_mov_b32 v46, 0
    v_mov_b32 v47, 0
    v_mov_b32 v48, 0
    v_mov_b32 v49, 0
    v_mov_b32 v50, 0
    v_mov_b32 v51, 0
    v_mov_b32 v52, 0
    v_mov_b32 v53, 0
    v_mov_b32 v54, 0
    v_mov_b32 v55, 0
    v_mov_b32 v56, 0
    v_mov_b32 v57, 0
    v_mov_b32 v58, 0
    v_mov_b32 v59, 0
    v_mov_b32 v60, 0
    v_mov_b32 v61, 0
    v_mov_b32 v62, 0
    v_mov_b32 v63, 0
    v_add_u32 v113, s27, v118
    v_xor_b32 v114, 64, v113
    s_mov_b32 s33, s27
    s_waitcnt vmcnt(10)
    ds_read_b64_tr_b16 v[96:97], v113 offset:0
    ds_read_b64_tr_b16 v[98:99], v113 offset:1024
    ds_read_b64_tr_b16 v[100:101], v114 offset:0
    ds_read_b64_tr_b16 v[102:103], v114 offset:1024
    s_mov_b32 s32, s40
attn_kernel_t_loop:
    s_cmp_gt_u32 s32, 2
    s_cselect_b32 s14, s36, 0
    s_add_u32 s42, s24, s47
    s_add_u32 s43, s42, s25
    buffer_load_dwordx4 v[88:91], v224, s[8:11], s42 offen sc1
    buffer_load_dwordx4 v[92:95], v224, s[8:11], s43 offen sc1
    s_waitcnt vmcnt(8)
    ds_read_b64_tr_b16 v[104:105], v113 offset:2048
    ds_read_b64_tr_b16 v[106:107], v113 offset:3072
    ds_read_b64_tr_b16 v[108:109], v114 offset:2048
    ds_read_b64_tr_b16 v[110:111], v114 offset:3072
    s_waitcnt lgkmcnt(4)
    s_add_u32 s41, s26, s52
    s_add_u32 m0, s33, 0
    s_add_u32 s42, s41, 7168
    buffer_load_dwordx4 v112, s[12:15], s41 offen lds
    s_add_u32 m0, s33, 1024
    s_nop 0
    buffer_load_dwordx4 v112, s[12:15], s42 offen lds
    v_mfma_f32_32x32x16_bf16 v[0:15], v[96:99], v[64:67], v[0:15]
    v_mfma_f32_32x32x16_bf16 v[16:31], v[96:99], v[68:71], v[16:31]
    v_mfma_f32_32x32x16_bf16 v[32:47], v[100:103], v[64:67], v[32:47]
    v_mfma_f32_32x32x16_bf16 v[48:63], v[100:103], v[68:71], v[48:63]
    s_add_u32 s42, s24, s48
    s_add_u32 s43, s42, s25
    buffer_load_dwordx4 v[64:67], v224, s[8:11], s42 offen sc1
    buffer_load_dwordx4 v[68:71], v224, s[8:11], s43 offen sc1
    s_waitcnt vmcnt(8)
    ds_read_b64_tr_b16 v[96:97], v113 offset:4096
    ds_read_b64_tr_b16 v[98:99], v113 offset:5120
    ds_read_b64_tr_b16 v[100:101], v114 offset:4096
    ds_read_b64_tr_b16 v[102:103], v114 offset:5120
    s_waitcnt lgkmcnt(4)
    s_add_u32 s41, s26, s53
    s_add_u32 m0, s33, 2048
    s_add_u32 s42, s41, 7168
    buffer_load_dwordx4 v112, s[12:15], s41 offen lds
    s_add_u32 m0, s33, 3072
    s_nop 0
    buffer_load_dwordx4 v112, s[12:15], s42 offen lds
    v_mfma_f32_32x32x16_bf16 v[0:15], v[104:107], v[72:75], v[0:15]
    v_mfma_f32_32x32x16_bf16 v[16:31], v[104:107], v[76:79], v[16:31]
    v_mfma_f32_32x32x16_bf16 v[32:47], v[108:111], v[72:75], v[32:47]
    v_mfma_f32_32x32x16_bf16 v[48:63], v[108:111], v[76:79], v[48:63]
    s_add_u32 s42, s24, s49
    s_add_u32 s43, s42, s25
    buffer_load_dwordx4 v[72:75], v224, s[8:11], s42 offen sc1
    buffer_load_dwordx4 v[76:79], v224, s[8:11], s43 offen sc1
    s_waitcnt vmcnt(8)
    ds_read_b64_tr_b16 v[104:105], v113 offset:6144
    ds_read_b64_tr_b16 v[106:107], v113 offset:7168
    ds_read_b64_tr_b16 v[108:109], v114 offset:6144
    ds_read_b64_tr_b16 v[110:111], v114 offset:7168
    s_waitcnt lgkmcnt(4)
    s_add_u32 s41, s26, s54
    s_add_u32 m0, s33, 4096
    s_add_u32 s42, s41, 7168
    buffer_load_dwordx4 v112, s[12:15], s41 offen lds
    s_add_u32 m0, s33, 5120
    s_nop 0
    buffer_load_dwordx4 v112, s[12:15], s42 offen lds
    v_mfma_f32_32x32x16_bf16 v[0:15], v[96:99], v[80:83], v[0:15]
    v_mfma_f32_32x32x16_bf16 v[16:31], v[96:99], v[84:87], v[16:31]
    v_mfma_f32_32x32x16_bf16 v[32:47], v[100:103], v[80:83], v[32:47]
    v_mfma_f32_32x32x16_bf16 v[48:63], v[100:103], v[84:87], v[48:63]
    s_add_u32 s42, s24, s50
    s_add_u32 s43, s42, s25
    buffer_load_dwordx4 v[80:83], v224, s[8:11], s42 offen sc1
    buffer_load_dwordx4 v[84:87], v224, s[8:11], s43 offen sc1
    s_waitcnt vmcnt(8)
    ds_read_b64_tr_b16 v[96:97], v113 offset:8192
    ds_read_b64_tr_b16 v[98:99], v113 offset:9216
    ds_read_b64_tr_b16 v[100:101], v114 offset:8192
    ds_read_b64_tr_b16 v[102:103], v114 offset:9216
    s_waitcnt lgkmcnt(4)
    s_add_u32 s41, s26, s55
    s_add_u32 m0, s33, 6144
    s_add_u32 s42, s41, 7168
    buffer_load_dwordx4 v112, s[12:15], s41 offen lds
    s_add_u32 m0, s33, 7168
    s_nop 0
    buffer_load_dwordx4 v112, s[12:15], s42 offen lds
    v_mfma_f32_32x32x16_bf16 v[0:15], v[104:107], v[88:91], v[0:15]
    v_mfma_f32_32x32x16_bf16 v[16:31], v[104:107], v[92:95], v[16:31]
    v_mfma_f32_32x32x16_bf16 v[32:47], v[108:111], v[88:91], v[32:47]
    v_mfma_f32_32x32x16_bf16 v[48:63], v[108:111], v[92:95], v[48:63]
    s_add_u32 s42, s24, s51
    s_add_u32 s43, s42, s25
    buffer_load_dwordx4 v[88:91], v224, s[8:11], s42 offen sc1
    buffer_load_dwordx4 v[92:95], v224, s[8:11], s43 offen sc1
    s_waitcnt vmcnt(8)
    ds_read_b64_tr_b16 v[104:105], v113 offset:10240
    ds_read_b64_tr_b16 v[106:107], v113 offset:11264
    ds_read_b64_tr_b16 v[108:109], v114 offset:10240
    ds_read_b64_tr_b16 v[110:111], v114 offset:11264
    s_waitcnt lgkmcnt(4)
    s_add_u32 s41, s26, s56
    s_add_u32 m0, s33, 8192
    s_add_u32 s42, s41, 7168
    buffer_load_dwordx4 v112, s[12:15], s41 offen lds
    s_add_u32 m0, s33, 9216
    s_nop 0
    buffer_load_dwordx4 v112, s[12:15], s42 offen lds
    v_mfma_f32_32x32x16_bf16 v[0:15], v[96:99], v[64:67], v[0:15]
    v_mfma_f32_32x32x16_bf16 v[16:31], v[96:99], v[68:71], v[16:31]
    v_mfma_f32_32x32x16_bf16 v[32:47], v[100:103], v[64:67], v[32:47]
    v_mfma_f32_32x32x16_bf16 v[48:63], v[100:103], v[68:71], v[48:63]
    s_add_u32 s24, s24, 8192
    s_cmp_eq_u32 s32, 1
    s_cselect_b32 s10, 0, s35
    s_add_u32 s42, s24, s44
    s_add_u32 s43, s42, s25
    buffer_load_dwordx4 v[64:67], v224, s[8:11], s42 offen sc1
    buffer_load_dwordx4 v[68:71], v224, s[8:11], s43 offen sc1
    s_waitcnt vmcnt(8)
    ds_read_b64_tr_b16 v[96:97], v113 offset:12288
    ds_read_b64_tr_b16 v[98:99], v113 offset:13312
    ds_read_b64_tr_b16 v[100:101], v114 offset:12288
    ds_read_b64_tr_b16 v[102:103], v114 offset:13312
    s_waitcnt lgkmcnt(4)
    s_add_u32 s41, s26, s57
    s_add_u32 m0, s33, 10240
    s_add_u32 s42, s41, 7168
    buffer_load_dwordx4 v112, s[12:15], s41 offen lds
    s_add_u32 m0, s33, 11264
    s_nop 0
    buffer_load_dwordx4 v112, s[12:15], s42 offen lds
    v_mfma_f32_32x32x16_bf16 v[0:15], v[104:107], v[72:75], v[0:15]
    v_mfma_f32_32x32x16_bf16 v[16:31], v[104:107], v[76:79], v[16:31]
    v_mfma_f32_32x32x16_bf16 v[32:47], v[108:111], v[72:75], v[32:47]
    v_mfma_f32_32x32x16_bf16 v[48:63], v[108:111], v[76:79], v[48:63]
    s_add_u32 s42, s24, s45
    s_add_u32 s43, s42, s25
    buffer_load_dwordx4 v[72:75], v224, s[8:11], s42 offen sc1
    buffer_load_dwordx4 v[76:79], v224, s[8:11], s43 offen sc1
    s_waitcnt vmcnt(8)
    ds_read_b64_tr_b16 v[104:105], v113 offset:14336
    ds_read_b64_tr_b16 v[106:107], v113 offset:15360
    ds_read_b64_tr_b16 v[108:109], v114 offset:14336
    ds_read_b64_tr_b16 v[110:111], v114 offset:15360
    s_waitcnt lgkmcnt(4)
    s_add_u32 s41, s26, s58
    s_add_u32 m0, s33, 12288
    s_add_u32 s42, s41, 7168
    buffer_load_dwordx4 v112, s[12:15], s41 offen lds
    s_add_u32 m0, s33, 13312
    s_nop 0
    buffer_load_dwordx4 v112, s[12:15], s42 offen lds
    v_mfma_f32_32x32x16_bf16 v[0:15], v[96:99], v[80:83], v[0:15]
    v_mfma_f32_32x32x16_bf16 v[16:31], v[96:99], v[84:87], v[16:31]
    v_mfma_f32_32x32x16_bf16 v[32:47], v[100:103], v[80:83], v[32:47]
    v_mfma_f32_32x32x16_bf16 v[48:63], v[100:103], v[84:87], v[48:63]
    s_add_u32 s42, s24, s46
    s_add_u32 s43, s42, s25
    buffer_load_dwordx4 v[80:83], v224, s[8:11], s42 offen sc1
    buffer_load_dwordx4 v[84:87], v224, s[8:11], s43 offen sc1
    s_waitcnt vmcnt(8)
    v_xor_b32 v113, 16384, v113
    v_xor_b32 v114, 16384, v114
    ds_read_b64_tr_b16 v[96:97], v113 offset:0
    ds_read_b64_tr_b16 v[98:99], v113 offset:1024
    ds_read_b64_tr_b16 v[100:101], v114 offset:0
    ds_read_b64_tr_b16 v[102:103], v114 offset:1024
    s_waitcnt lgkmcnt(4)
    s_add_u32 s41, s26, s59
    s_add_u32 m0, s33, 14336
    s_add_u32 s42, s41, 7168
    buffer_load_dwordx4 v112, s[12:15], s41 offen lds
    s_add_u32 m0, s33, 15360
    s_nop 0
    buffer_load_dwordx4 v112, s[12:15], s42 offen lds
    v_mfma_f32_32x32x16_bf16 v[0:15], v[104:107], v[88:91], v[0:15]
    v_mfma_f32_32x32x16_bf16 v[16:31], v[104:107], v[92:95], v[16:31]
    v_mfma_f32_32x32x16_bf16 v[32:47], v[108:111], v[88:91], v[32:47]
    v_mfma_f32_32x32x16_bf16 v[48:63], v[108:111], v[92:95], v[48:63]
    s_add_u32 s26, s26, s37
    s_xor_b32 s33, s33, 16384
    s_sub_u32 s32, s32, 1
    s_cmp_lg_u32 s32, 0
    s_cbranch_scc1 attn_kernel_t_loop
    s_waitcnt vmcnt(0) lgkmcnt(0)
    s_nop 7
    s_nop 7
    v_and_b32 v115, 31, v251
    s_lshl_b32 s41, s21, 6
    v_add_u32 v115, s41, v115
    v_mul_u32_u24 v115, 1792, v115
    v_lshrrev_b32 v116, 5, v251
    v_lshl_add_u32 v117, v116, 4, v115
    s_mul_i32 s42, s23, 896
    s_lshl_b32 s43, s22, 7
    s_add_u32 s42, s42, s43
    s_cmp_eq_u32 s23, 1
    s_cbranch_scc1 attn_kernel_t_epib
    s_barrier
    s_lshl_b32 s41, s28, 14
    v_add_u32 v115, s41, v224
    ds_write_b128 v115, v[0:3] offset:0
    ds_write_b128 v115, v[4:7] offset:1024
    ds_write_b128 v115, v[8:11] offset:2048
    ds_write_b128 v115, v[12:15] offset:3072
    ds_write_b128 v115, v[16:19] offset:4096
    ds_write_b128 v115, v[20:23] offset:5120
    ds_write_b128 v115, v[24:27] offset:6144
    ds_write_b128 v115, v[28:31] offset:7168
    ds_write_b128 v115, v[32:35] offset:8192
    ds_write_b128 v115, v[36:39] offset:9216
    ds_write_b128 v115, v[40:43] offset:10240
    ds_write_b128 v115, v[44:47] offset:11264
    ds_write_b128 v115, v[48:51] offset:12288
    ds_write_b128 v115, v[52:55] offset:13312
    ds_write_b128 v115, v[56:59] offset:14336
    ds_write_b128 v115, v[60:63] offset:15360
    s_waitcnt lgkmcnt(0)
    s_barrier
    s_lshl_b32 s41, s28, 12
    v_add_u32 v115, s41, v224
    ds_read_b128 v[0:3], v115 offset:0
    ds_read_b128 v[4:7], v115 offset:1024
    ds_read_b128 v[8:11], v115 offset:2048
    ds_read_b128 v[12:15], v115 offset:3072
    ds_read_b128 v[16:19], v115 offset:16384
    ds_read_b128 v[20:23], v115 offset:17408
    ds_read_b128 v[24:27], v115 offset:18432
    ds_read_b128 v[28:31], v115 offset:19456
    ds_read_b128 v[32:35], v115 offset:32768
    ds_read_b128 v[36:39], v115 offset:33792
    ds_read_b128 v[40:43], v115 offset:34816
    ds_read_b128 v[44:47], v115 offset:35840
    ds_read_b128 v[48:51], v115 offset:49152
    ds_read_b128 v[52:55], v115 offset:50176
    ds_read_b128 v[56:59], v115 offset:51200
    ds_read_b128 v[60:63], v115 offset:52224
    s_waitcnt lgkmcnt(0)
    v_add_f32 v0, v0, v16
    v_add_f32 v1, v1, v17
    v_add_f32 v2, v2, v18
    v_add_f32 v3, v3, v19
    v_add_f32 v4, v4, v20
    v_add_f32 v5, v5, v21
    v_add_f32 v6, v6, v22
    v_add_f32 v7, v7, v23
    v_add_f32 v8, v8, v24
    v_add_f32 v9, v9, v25
    v_add_f32 v10, v10, v26
    v_add_f32 v11, v11, v27
    v_add_f32 v12, v12, v28
    v_add_f32 v13, v13, v29
    v_add_f32 v14, v14, v30
    v_add_f32 v15, v15, v31
    v_add_f32 v0, v0, v32
    v_add_f32 v1, v1, v33
    v_add_f32 v2, v2, v34
    v_add_f32 v3, v3, v35
    v_add_f32 v4, v4, v36
    v_add_f32 v5, v5, v37
    v_add_f32 v6, v6, v38
    v_add_f32 v7, v7, v39
    v_add_f32 v8, v8, v40
    v_add_f32 v9, v9, v41
    v_add_f32 v10, v10, v42
    v_add_f32 v11, v11, v43
    v_add_f32 v12, v12, v44
    v_add_f32 v13, v13, v45
    v_add_f32 v14, v14, v46
    v_add_f32 v15, v15, v47
    v_add_f32 v0, v0, v48
    v_add_f32 v1, v1, v49
    v_add_f32 v2, v2, v50
    v_add_f32 v3, v3, v51
    v_add_f32 v4, v4, v52
    v_add_f32 v5, v5, v53
    v_add_f32 v6, v6, v54
    v_add_f32 v7, v7, v55
    v_add_f32 v8, v8, v56
    v_add_f32 v9, v9, v57
    v_add_f32 v10, v10, v58
    v_add_f32 v11, v11, v59
    v_add_f32 v12, v12, v60
    v_add_f32 v13, v13, v61
    v_add_f32 v14, v14, v62
    v_add_f32 v15, v15, v63
    s_lshr_b32 s41, s28, 1
    s_lshl_b32 s41, s41, 6
    s_add_u32 s42, s42, s41
    s_and_b32 s41, s28, 1
    s_mul_i32 s41, s41, 57344
    s_add_u32 s42, s42, s41
    v_cvt_pk_bf16_f32 v96, v0, v1
    v_cvt_pk_bf16_f32 v97, v2, v3
    v_cvt_pk_bf16_f32 v98, v4, v5
    v_cvt_pk_bf16_f32 v99, v6, v7
    s_nop 1
    v_permlane32_swap_b32 v96, v98
    v_permlane32_swap_b32 v97, v99
    s_nop 1
    buffer_store_dwordx4 v[96:99], v117, s[16:19], s42 offen offset:0
    s_nop 1
    v_cvt_pk_bf16_f32 v96, v8, v9
    v_cvt_pk_bf16_f32 v97, v10, v11
    v_cvt_pk_bf16_f32 v98, v12, v13
    v_cvt_pk_bf16_f32 v99, v14, v15
    s_nop 1
    v_permlane32_swap_b32 v96, v98
    v_permlane32_swap_b32 v97, v99
    s_nop 1
    buffer_store_dwordx4 v[96:99], v117, s[16:19], s42 offen offset:32
    s_nop 1
    s_branch attn_kernel_t_end
attn_kernel_t_epib:
    s_add_u32 s43, s42, 57344
    v_cvt_pk_bf16_f32 v96, v0, v1
    v_cvt_pk_bf16_f32 v97, v2, v3
    v_cvt_pk_bf16_f32 v98, v4, v5
    v_cvt_pk_bf16_f32 v99, v6, v7
    s_nop 1
    v_permlane32_swap_b32 v96, v98
    v_permlane32_swap_b32 v97, v99
    s_nop 1
    buffer_store_dwordx4 v[96:99], v117, s[16:19], s42 offen offset:0
    s_nop 1
    v_cvt_pk_bf16_f32 v96, v8, v9
    v_cvt_pk_bf16_f32 v97, v10, v11
    v_cvt_pk_bf16_f32 v98, v12, v13
    v_cvt_pk_bf16_f32 v99, v14, v15
    s_nop 1
    v_permlane32_swap_b32 v96, v98
    v_permlane32_swap_b32 v97, v99
    s_nop 1
    buffer_store_dwordx4 v[96:99], v117, s[16:19], s42 offen offset:32
    s_nop 1
    v_cvt_pk_bf16_f32 v96, v16, v17
    v_cvt_pk_bf16_f32 v97, v18, v19
    v_cvt_pk_bf16_f32 v98, v20, v21
    v_cvt_pk_bf16_f32 v99, v22, v23
    s_nop 1
    v_permlane32_swap_b32 v96, v98
    v_permlane32_swap_b32 v97, v99
    s_nop 1
    buffer_store_dwordx4 v[96:99], v117, s[16:19], s43 offen offset:0
    s_nop 1
    v_cvt_pk_bf16_f32 v96, v24, v25
    v_cvt_pk_bf16_f32 v97, v26, v27
    v_cvt_pk_bf16_f32 v98, v28, v29
    v_cvt_pk_bf16_f32 v99, v30, v31
    s_nop 1
    v_permlane32_swap_b32 v96, v98
    v_permlane32_swap_b32 v97, v99
    s_nop 1
    buffer_store_dwordx4 v[96:99], v117, s[16:19], s43 offen offset:32
    s_nop 1
    v_cvt_pk_bf16_f32 v96, v32, v33
    v_cvt_pk_bf16_f32 v97, v34, v35
    v_cvt_pk_bf16_f32 v98, v36, v37
    v_cvt_pk_bf16_f32 v99, v38, v39
    s_nop 1
    v_permlane32_swap_b32 v96, v98
    v_permlane32_swap_b32 v97, v99
    s_nop 1
    buffer_store_dwordx4 v[96:99], v117, s[16:19], s42 offen offset:64
    s_nop 1
    v_cvt_pk_bf16_f32 v96, v40, v41
    v_cvt_pk_bf16_f32 v97, v42, v43
    v_cvt_pk_bf16_f32 v98, v44, v45
    v_cvt_pk_bf16_f32 v99, v46, v47
    s_nop 1
    v_permlane32_swap_b32 v96, v98
    v_permlane32_swap_b32 v97, v99
    s_nop 1
    buffer_store_dwordx4 v[96:99], v117, s[16:19], s42 offen offset:96
    s_nop 1
    v_cvt_pk_bf16_f32 v96, v48, v49
    v_cvt_pk_bf16_f32 v97, v50, v51
    v_cvt_pk_bf16_f32 v98, v52, v53
    v_cvt_pk_bf16_f32 v99, v54, v55
    s_nop 1
    v_permlane32_swap_b32 v96, v98
    v_permlane32_swap_b32 v97, v99
    s_nop 1
    buffer_store_dwordx4 v[96:99], v117, s[16:19], s43 offen offset:64
    s_nop 1
    v_cvt_pk_bf16_f32 v96, v56, v57
    v_cvt_pk_bf16_f32 v97, v58, v59
    v_cvt_pk_bf16_f32 v98, v60, v61
    v_cvt_pk_bf16_f32 v99, v62, v63
    s_nop 1
    v_permlane32_swap_b32 v96, v98
    v_permlane32_swap_b32 v97, v99
    s_nop 1
    buffer_store_dwordx4 v[96:99], v117, s[16:19], s43 offen offset:96
    s_nop 1
    s_cmp_eq_u32 s38, 0
    s_cbranch_scc0 attn_kernel_t_end
    s_mov_b32 s38, 1
    s_add_u32 s22, s22, 4
    s_cmp_lt_u32 s22, 7
    s_cbranch_scc1 attn_kernel_t_round
attn_kernel_t_end:
attn_kernel_end:
    s_endpgm
.section .rodata,"a"
.p2align 6
.amdhsa_kernel proj_kernel
  .amdhsa_next_free_vgpr 256
  .amdhsa_next_free_sgpr 102
  .amdhsa_accum_offset 256
  .amdhsa_group_segment_fixed_size 0
  .amdhsa_kernarg_size 96
  .amdhsa_user_sgpr_count 2
  .amdhsa_user_sgpr_kernarg_segment_ptr 1
  .amdhsa_system_sgpr_workgroup_id_x 1
.end_amdhsa_kernel
.section .rodata,"a"
.p2align 6
.amdhsa_kernel attn_kernel
  .amdhsa_next_free_vgpr 448
  .amdhsa_next_free_sgpr 102
  .amdhsa_accum_offset 256
  .amdhsa_group_segment_fixed_size 0
  .amdhsa_kernarg_size 96
  .amdhsa_user_sgpr_count 2
  .amdhsa_user_sgpr_kernarg_segment_ptr 1
  .amdhsa_system_sgpr_workgroup_id_x 1
.end_amdhsa_kernel
```
